```python
import torch

def _softmax(x, axis=-1):
    return torch.softmax(x, dim=axis)
def _gelu(x):
    return torch.nn.functional.gelu(x, approximate="tanh")
def _silu(x):
    return torch.nn.functional.silu(x)
def _sigmoid(x):
    return torch.sigmoid(x)
def _layernorm(x, axis=-1, eps=1e-5):
    m = x.mean(dim=axis, keepdim=True)
    v = x.var(dim=axis, keepdim=True, unbiased=False)
    return (x - m) / torch.sqrt(v + eps)
def _scatter_add(tgt, idx, src, axis=0):
    return tgt.clone().index_add_(axis, idx, src)
def _segment_sum(src, seg, n):
    out = torch.zeros((n,) + src.shape[1:], dtype=src.dtype)
    return out.index_add_(0, seg, src)
def _pad(x, pw):
    flat = tuple(v for pair in reversed(pw) for v in pair)
    return torch.nn.functional.pad(x, flat)

kernel_name = 'parallel_sum__ssm_conv_s5__geglu_ffn__prompt'

def setup_inputs():

    _w = (lambda a: (lambda t: t.to(torch.bfloat16) if t.is_floating_point() else t)(torch.as_tensor(a)))
    def _A_setup():
        B, S, D = 1, 2048, 640
        P = D
        Lambda_re = -0.5 * (lambda _x: torch.exp(torch.as_tensor(_x)))((lambda *s: torch.randn(*s, dtype=torch.bfloat16) * 0.8)(P))
        Lambda_im = (lambda *s: torch.randn(*s, dtype=torch.bfloat16) * 0.8)(P) * 1.0
        B_re = (lambda *s: torch.randn(*s, dtype=torch.bfloat16) * 0.8)(P, D) * (D ** -0.5)
        B_im = (lambda *s: torch.randn(*s, dtype=torch.bfloat16) * 0.8)(P, D) * (D ** -0.5)
        C_re = (lambda *s: torch.randn(*s, dtype=torch.bfloat16) * 0.8)(D, P) * (P ** -0.5)
        C_im = (lambda *s: torch.randn(*s, dtype=torch.bfloat16) * 0.8)(D, P) * (P ** -0.5)
        log_dt = (lambda *s: torch.randn(*s, dtype=torch.bfloat16) * 0.8)(P) * 0.3 - 2.0
        Dskip = (lambda *s: torch.randn(*s, dtype=torch.bfloat16) * 0.8)(D)
        return {
            "x": _w((lambda *s: torch.randn(*s, dtype=torch.bfloat16) * 0.05)(B, S, D)),
            "Lambda_re": _w(Lambda_re),
            "Lambda_im": _w(Lambda_im),
            "B_re": _w(B_re),
            "B_im": _w(B_im),
            "C_re": _w(C_re),
            "C_im": _w(C_im),
            "log_dt": _w(log_dt),
            "Dskip": _w(Dskip),
        }
    _A_in = _A_setup()

    def _B_setup():
        B, S, D, F = 1, 2048, 640, 1536
        return {
            "x": _w((lambda *s: torch.randn(*s, dtype=torch.bfloat16) * 0.05)(B, S, D)),
            "w_gate": _w((lambda *s: torch.randn(*s, dtype=torch.bfloat16) * 0.05)(D, F)),
            "w_up": _w((lambda *s: torch.randn(*s, dtype=torch.bfloat16) * 0.05)(D, F)),
            "w_down": _w((lambda *s: torch.randn(*s, dtype=torch.bfloat16) * 0.05)(F, D)),
        }
    _B_in = _B_setup()

    return {
        "A_x": _A_in["x"],
        "A_Lambda_re": _A_in["Lambda_re"],
        "A_Lambda_im": _A_in["Lambda_im"],
        "A_B_re": _A_in["B_re"],
        "A_B_im": _A_in["B_im"],
        "A_C_re": _A_in["C_re"],
        "A_C_im": _A_in["C_im"],
        "A_log_dt": _A_in["log_dt"],
        "A_Dskip": _A_in["Dskip"],
        "B_x": _B_in["x"],
        "B_w_gate": _B_in["w_gate"],
        "B_w_up": _B_in["w_up"],
        "B_w_down": _B_in["w_down"],
    }

def reference(A_x, A_Lambda_re, A_Lambda_im, A_B_re, A_B_im, A_C_re, A_C_im, A_log_dt, A_Dskip, B_x, B_w_gate, B_w_up, B_w_down):
    def _A_ref(x, Lambda_re, Lambda_im, B_re, B_im, C_re, C_im, log_dt, Dskip):
        Bsz, L, H = x.shape
        Lam = Lambda_re + 1j * Lambda_im
        Bmat = B_re + 1j * B_im
        Cmat = C_re + 1j * C_im
        dt = torch.exp(log_dt)
        Lam_bar = torch.exp(dt * Lam)
        B_bar = ((Lam_bar - 1.0) / Lam)[:, None] * Bmat
        Bu = torch.einsum("bld,pd->blp", x + 0j, B_bar)
        h = torch.zeros_like(Bu[:, 0, :])
        hs = []
        for t in range(L):
            h = Lam_bar[None, :] * h + Bu[:, t, :]
            hs.append(h)
        hseq = torch.stack(hs, 1)
        y = 2.0 * torch.einsum("blp,dp->bld", hseq, Cmat).real + x * Dskip[None, None, :]
        return y

    def _B_ref(x, w_gate, w_up, w_down):
        return (_gelu(x @ w_gate) * (x @ w_up)) @ w_down

    x = A_x
    xn = _layernorm(x, axis=-1)
    return x + _A_ref(xn, A_Lambda_re, A_Lambda_im, A_B_re, A_B_im, A_C_re, A_C_im, A_log_dt, A_Dskip) + _B_ref(xn, B_w_gate, B_w_up, B_w_down)
```

```asm
; @launch grid=(256,1,1) block=(512,1,1) lds=163840
.amdgcn_target "amdgcn-amd-amdhsa--gfx950"
.text
.globl parallel_sum__ssm_conv_s5__geglu_ffn__prompt_kernel
.p2align 8
.type parallel_sum__ssm_conv_s5__geglu_ffn__prompt_kernel,@function
parallel_sum__ssm_conv_s5__geglu_ffn__prompt_kernel:
    s_cmp_ge_u32 s2, 256
    s_cbranch_scc1 L_k1_end
    s_load_dwordx16 s[16:31], s[0:1], 0
    s_load_dwordx16 s[32:47], s[0:1], 64
    v_lshrrev_b32 v6, 6, v0
    v_and_b32 v1, 63, v0
    v_readfirstlane_b32 s3, v6
    s_nop 0
    s_cmp_ge_u32 s3, 6
    s_cbranch_scc1 L_k1_D
    s_cmp_lt_u32 s3, 4
    s_cbranch_scc1 L_k1_C
    v_and_b32 v2, 15, v0
    v_lshrrev_b32 v3, 4, v1
    v_lshrrev_b32 v4, 3, v1
    v_and_b32 v5, 7, v0
    s_bfe_u32 s6, s2, 0x10002
    s_lshl_b32 s6, s6, 3
    s_bfe_u32 s11, s2, 0x30003
    s_add_u32 s6, s6, s11
    s_and_b32 s7, s2, 3
    s_lshl_b32 s7, s7, 1
    s_lshr_b32 s11, s2, 7
    s_add_u32 s7, s7, s11
    s_bfe_u32 s8, s2, 0x10006
    s_mov_b32 s13, 0xffff0000
    s_and_b32 s4, s3, 1
    s_bfe_u32 s5, s3, 0x10001
    s_lshl_b32 s9, s7, 7
    s_lshl_b32 s10, s7, 6
    s_add_u32 s10, s10, 1024
    s_cmp_eq_u32 s8, 0
    s_cselect_b32 s83, s9, s10
    s_lshl_b32 s11, s6, 7
    s_lshl_b32 s12, s4, 5
    s_add_u32 s11, s11, s12
    v_lshrrev_b32 v6, 2, v4
    v_lshlrev_b32 v6, 4, v6
    v_and_b32 v7, 3, v4
    v_add3_u32 v6, v6, v7, s11
    v_mul_u32_u24 v6, 1280, v6
    s_lshl_b32 s12, s4, 2
    v_lshrrev_b32 v7, 1, v4
    v_or_b32 v7, s12, v7
    v_xor_b32 v7, v7, v5
    v_lshl_add_u32 v12, v7, 4, v6
    s_mul_i32 s9, s7, 80
    v_add_u32 v8, s9, v4
    v_mul_u32_u24 v8, 1280, v8
    v_lshl_add_u32 v14, v7, 4, v8
    s_lshl_b32 s9, s4, 3
    v_add_u32 v6, s9, v4
    v_mul_u32_u24 v6, 3072, v6
    v_and_b32 v7, 2, v4
    v_or_b32 v7, s12, v7
    v_xor_b32 v7, v7, v5
    v_lshl_add_u32 v6, v7, 4, v6
    s_lshl_b32 s9, s83, 1
    v_add_u32 v13, s9, v6
    s_mov_b32 s72, 0
    s_mov_b32 s73, 0
    s_lshl_b32 s74, s4, 10
    s_mov_b32 s76, 0
    s_mov_b32 s77, 0
    v_mov_b32 v18, 162304
    v_mov_b32 v24, 4
    s_getpc_b64 s[68:69]
L_k1_tbL:
    s_add_u32 s68, s68, L_k1_tab-L_k1_tbL
    s_addc_u32 s69, s69, 0
    s_lshl_b32 s70, s4, 2
    s_add_u32 s70, s70, 163728
    s_lshl_b32 s9, s4, 2
    s_add_u32 s9, s9, 163728
    v_mov_b32 v19, s9
    s_mov_b32 s50, 2621440
    s_mov_b32 s51, 0x20000
    s_mov_b32 s54, 1966080
    s_mov_b32 s55, 0x20000
    s_mov_b32 s58, 1966080
    s_mov_b32 s59, 0x20000
    s_mov_b32 s66, 819200
    s_mov_b32 s67, 0x20000
    s_cmp_eq_u32 s4, 0
    s_waitcnt lgkmcnt(0)
    s_mov_b64 s[48:49], s[16:17]
    s_mov_b64 s[52:53], s[36:37]
    s_mov_b64 s[56:57], s[38:39]
    s_cselect_b64 s[64:65], s[22:23], s[24:25]
L_k1_L:
    s_cmp_lt_u32 s76, 3
    s_cbranch_scc1 L_k1_L_c1_go
    s_lshl_b32 s10, s76, 1
    s_add_i32 s10, s10, -5
    s_waitcnt lgkmcnt(0)
    v_min_u32 v20, v20, v21
    v_min3_u32 v20, v20, v22, v23
    s_nop 0
    v_readfirstlane_b32 s9, v20
    s_nop 0
    s_cmp_ge_i32 s9, s10
    s_cbranch_scc1 L_k1_L_c1_go
L_k1_L_c1_wd:
    ds_read2st64_b32 v[20:21], v18 offset0:0 offset1:1
    ds_read2st64_b32 v[22:23], v18 offset0:2 offset1:3
    s_waitcnt lgkmcnt(0)
    v_min_u32 v20, v20, v21
    v_min3_u32 v20, v20, v22, v23
    s_nop 0
    v_readfirstlane_b32 s9, v20
    s_nop 0
    s_cmp_ge_i32 s9, s10
    s_cbranch_scc1 L_k1_L_c1_wd_ok
    s_sleep 1
    s_branch L_k1_L_c1_wd
L_k1_L_c1_wd_ok:
L_k1_L_c1_go:
    s_add_u32 m0, s74, 0
    s_add_u32 s9, s72, 0
    buffer_load_dwordx4 v12, s[48:51], s9 offen lds
    s_add_u32 m0, s74, 2048
    s_add_u32 s9, s72, 5120
    buffer_load_dwordx4 v12, s[48:51], s9 offen lds
    s_add_u32 m0, s74, 16384
    s_add_u32 s9, s73, 0
    buffer_load_dwordx4 v13, s[52:55], s9 offen lds
    s_add_u32 m0, s74, 4096
    s_add_u32 s9, s72, 10240
    buffer_load_dwordx4 v12, s[48:51], s9 offen lds
    s_add_u32 m0, s74, 6144
    s_add_u32 s9, s72, 15360
    buffer_load_dwordx4 v12, s[48:51], s9 offen lds
    s_add_u32 m0, s74, 24576
    s_add_u32 s9, s73, 0
    buffer_load_dwordx4 v13, s[56:59], s9 offen lds
    s_add_u32 m0, s74, 8192
    s_add_u32 s9, s72, 81920
    buffer_load_dwordx4 v12, s[48:51], s9 offen lds
    s_add_u32 m0, s74, 10240
    s_add_u32 s9, s72, 87040
    buffer_load_dwordx4 v12, s[48:51], s9 offen lds
L_k1_L_sig:
    s_waitcnt vmcnt(40)
    s_cmp_eq_u32 s8, 1
    s_cbranch_scc1 L_k1_L_b1
    s_add_u32 m0, s74, 32768
    s_add_u32 s9, s73, 128
    buffer_load_dwordx4 v13, s[52:55], s9 offen lds
    s_add_u32 m0, s74, 40960
    s_add_u32 s9, s73, 128
    buffer_load_dwordx4 v13, s[56:59], s9 offen lds
    s_add_u32 m0, s74, 34816
    s_add_u32 s9, s73, 49280
    buffer_load_dwordx4 v13, s[52:55], s9 offen lds
    s_add_u32 m0, s74, 43008
    s_add_u32 s9, s73, 49280
    buffer_load_dwordx4 v13, s[56:59], s9 offen lds
L_k1_L_b1:
    s_add_u32 m0, s74, 18432
    s_add_u32 s9, s73, 49152
    buffer_load_dwordx4 v13, s[52:55], s9 offen lds
    s_add_u32 m0, s74, 12288
    s_add_u32 s9, s72, 92160
    buffer_load_dwordx4 v12, s[48:51], s9 offen lds
    ds_read2st64_b32 v[20:21], v18 offset0:0 offset1:1
    ds_read2st64_b32 v[22:23], v18 offset0:2 offset1:3
    s_add_u32 m0, s74, 14336
    s_add_u32 s9, s72, 97280
    buffer_load_dwordx4 v12, s[48:51], s9 offen lds
    s_add_u32 m0, s74, 26624
    s_add_u32 s9, s73, 49152
    buffer_load_dwordx4 v13, s[56:59], s9 offen lds
    s_cmp_lt_u32 s76, 3
    s_cbranch_scc1 L_k1_L_c2_go
    s_lshl_b32 s10, s76, 1
    s_add_i32 s10, s10, -4
    s_waitcnt lgkmcnt(0)
    v_min_u32 v20, v20, v21
    v_min3_u32 v20, v20, v22, v23
    s_nop 0
    v_readfirstlane_b32 s9, v20
    s_nop 0
    s_cmp_ge_i32 s9, s10
    s_cbranch_scc1 L_k1_L_c2_go
L_k1_L_c2_wd:
    ds_read2st64_b32 v[20:21], v18 offset0:0 offset1:1
    ds_read2st64_b32 v[22:23], v18 offset0:2 offset1:3
    s_waitcnt lgkmcnt(0)
    v_min_u32 v20, v20, v21
    v_min3_u32 v20, v20, v22, v23
    s_nop 0
    v_readfirstlane_b32 s9, v20
    s_nop 0
    s_cmp_ge_i32 s9, s10
    s_cbranch_scc1 L_k1_L_c2_wd_ok
    s_sleep 1
    s_branch L_k1_L_c2_wd
L_k1_L_c2_wd_ok:
L_k1_L_c2_go:
    s_cmp_eq_u32 s8, 1
    s_cbranch_scc1 L_k1_L_b2
    s_add_u32 m0, s74, 36864
    s_add_u32 s9, s73, 98432
    buffer_load_dwordx4 v13, s[52:55], s9 offen lds
    s_add_u32 m0, s74, 45056
    s_add_u32 s9, s73, 98432
    buffer_load_dwordx4 v13, s[56:59], s9 offen lds
    s_add_u32 m0, s74, 38912
    s_add_u32 s9, s73, 147584
    buffer_load_dwordx4 v13, s[52:55], s9 offen lds
    s_add_u32 m0, s74, 47104
    s_add_u32 s9, s73, 147584
    buffer_load_dwordx4 v13, s[56:59], s9 offen lds
    s_branch L_k1_L_b3
L_k1_L_b2:
    s_add_u32 m0, s74, 32768
    s_add_u32 s9, s72, 0
    buffer_load_dwordx4 v14, s[64:67], s9 offen lds
    s_add_u32 m0, s74, 34816
    s_add_u32 s9, s72, 10240
    buffer_load_dwordx4 v14, s[64:67], s9 offen lds
    s_add_u32 m0, s74, 36864
    s_add_u32 s9, s72, 20480
    buffer_load_dwordx4 v14, s[64:67], s9 offen lds
    s_add_u32 m0, s74, 38912
    s_add_u32 s9, s72, 30720
    buffer_load_dwordx4 v14, s[64:67], s9 offen lds
    s_add_u32 m0, s74, 40960
    s_add_u32 s9, s72, 40960
    buffer_load_dwordx4 v14, s[64:67], s9 offen lds
    s_add_u32 m0, s74, 43008
    s_add_u32 s9, s72, 51200
    buffer_load_dwordx4 v14, s[64:67], s9 offen lds
    s_add_u32 m0, s74, 45056
    s_add_u32 s9, s72, 61440
    buffer_load_dwordx4 v14, s[64:67], s9 offen lds
    s_add_u32 m0, s74, 47104
    s_add_u32 s9, s72, 71680
    buffer_load_dwordx4 v14, s[64:67], s9 offen lds
    s_add_u32 m0, s74, 49152
    s_add_u32 s9, s72, 81920
    buffer_load_dwordx4 v14, s[64:67], s9 offen lds
    s_add_u32 m0, s74, 51200
    s_add_u32 s9, s72, 92160
    buffer_load_dwordx4 v14, s[64:67], s9 offen lds
L_k1_L_b3:
    s_add_u32 m0, s74, 20480
    s_add_u32 s9, s73, 98304
    buffer_load_dwordx4 v13, s[52:55], s9 offen lds
    s_add_u32 m0, s74, 28672
    s_add_u32 s9, s73, 98304
    buffer_load_dwordx4 v13, s[56:59], s9 offen lds
    ds_read2st64_b32 v[20:21], v18 offset0:0 offset1:1
    ds_read2st64_b32 v[22:23], v18 offset0:2 offset1:3
    s_add_u32 m0, s74, 22528
    s_add_u32 s9, s73, 147456
    buffer_load_dwordx4 v13, s[52:55], s9 offen lds
    s_add_u32 m0, s74, 30720
    s_add_u32 s9, s73, 147456
    buffer_load_dwordx4 v13, s[56:59], s9 offen lds
    s_cmp_lg_u32 s76, 0
    s_cbranch_scc1 L_k1_L_nb
    s_barrier
L_k1_L_nb:
    s_mov_b32 m0, s70
    s_mov_b64 exec, 1
    global_load_lds_dword v24, s[68:69]
    s_mov_b64 exec, -1
    s_bitcmp1_b32 515, s76
    s_cbranch_scc0 L_k1_L_ni
    v_lshrrev_b32 v25, 2, v24
    ds_write_b32 v19, v25 offset:16
L_k1_L_ni:
    v_add_u32 v24, 4, v24
    s_add_u32 s72, s72, 128
    s_add_u32 s73, s73, 196608
    s_add_u32 s74, s74, 53248
    s_add_u32 s77, s77, 1
    s_cmp_eq_u32 s77, 3
    s_cselect_b32 s77, 0, s77
    s_cselect_b32 s9, 159744, 0
    s_sub_u32 s74, s74, s9
    s_add_u32 s76, s76, 1
    s_cmp_lt_u32 s76, 10
    s_cbranch_scc1 L_k1_L
L_k1_Lend:
    s_mov_b32 s60, s46
    s_mov_b32 s61, s47
    s_mov_b32 s62, 19922944
    s_mov_b32 s63, 0x20000
    s_branch L_k1_P2
L_k1_D:
    s_memrealtime s[100:101]
    v_and_b32 v2, 15, v0
    v_lshrrev_b32 v3, 4, v1
    v_lshrrev_b32 v4, 3, v1
    v_and_b32 v5, 7, v0
    s_bfe_u32 s6, s2, 0x10002
    s_lshl_b32 s6, s6, 3
    s_bfe_u32 s11, s2, 0x30003
    s_add_u32 s6, s6, s11
    s_and_b32 s7, s2, 3
    s_lshl_b32 s7, s7, 1
    s_lshr_b32 s11, s2, 7
    s_add_u32 s7, s7, s11
    s_bfe_u32 s8, s2, 0x10006
    s_mov_b32 s13, 0xffff0000
    s_and_b32 s4, s3, 1
    s_bfe_u32 s5, s3, 0x10001
    s_lshl_b32 s9, s7, 7
    s_lshl_b32 s10, s7, 6
    s_add_u32 s10, s10, 1024
    s_cmp_eq_u32 s8, 0
    s_cselect_b32 s83, s9, s10
    v_mul_u32_u24 v6, 1280, v3
    v_lshl_add_u32 v6, v2, 4, v6
    s_and_b32 s9, s2, 7
    s_lshl_b32 s9, s9, 5
    s_lshr_b32 s10, s2, 3
    s_add_u32 s9, s9, s10
    s_lshl_b32 s81, s9, 1
    s_add_u32 s81, s81, s4
    s_bfe_u32 s76, s2, 0x10002
    s_lshl_b32 s76, s76, 5
    s_add_u32 s76, s76, s10
    s_getpc_b64 s[70:71]
L_k1_pcc:
    s_sub_u32 s70, s70, L_k1_pcc-parallel_sum__ssm_conv_s5__geglu_ffn__prompt_kernel
    s_subb_u32 s71, s71, 0
    s_lshr_b32 s9, s2, 3
    s_lshl_b32 s9, s9, 1
    s_add_u32 s9, s9, s4
    s_mul_i32 s9, s9, 640
    v_min_u32 v14, 4, v1
    v_lshl_add_u32 v14, v14, 7, s9
    v_min_u32 v14, L_k1_tab-parallel_sum__ssm_conv_s5__geglu_ffn__prompt_kernel, v14
    global_load_dword v15, v14, s[70:71]
    s_waitcnt lgkmcnt(0)
    s_mov_b32 s48, s16
    s_mov_b32 s49, s17
    s_mov_b32 s50, 2621440
    s_mov_b32 s51, 0x20000
    s_mov_b32 s60, s46
    s_mov_b32 s61, s47
    s_mov_b32 s62, 19922944
    s_mov_b32 s63, 0x20000
    s_cmp_lg_u32 s81, 0
    s_cbranch_scc1 L_k1_nn
    s_or_b32 s9, s100, 1
    v_mov_b32 v8, s9
    v_mov_b32 v7, 0
    global_store_dword v7, v8, s[44:45] sc1
L_k1_nn:
    s_mul_i32 s72, s81, 5120
    s_cmp_eq_u32 s4, 1
    s_cbranch_scc1 L_k1_D1a
    s_mul_i32 s9, s76, 43
    s_lshr_b32 s9, s9, 9
    s_mul_i32 s10, s9, 12
    s_sub_u32 s10, s76, s10
    s_cmp_lt_u32 s10, 6
    s_cselect_b32 s68, s36, s38
    s_cselect_b32 s69, s37, s39
    s_cselect_b32 s11, 0, 6
    s_cselect_b32 s77, 0, 24
    s_sub_u32 s10, s10, s11
    s_and_b32 s11, s2, 3
    s_lshl_b32 s12, s11, 2
    s_lshl_b32 s11, s11, 1
    s_add_u32 s11, s11, 12
    s_cmp_lt_u32 s10, 4
    s_cselect_b32 s11, s12, s11
    s_add_u32 s10, s10, s11
    s_add_u32 s77, s77, s10
    s_mul_i32 s11, s9, 48
    s_add_u32 s77, s77, s11
    s_lshl_b32 s10, s10, 7
    s_mul_i32 s9, s9, 24576
    s_add_u32 s73, s9, s10
    s_cmp_lt_u32 s76, 60
    s_cselect_b32 s70, 1966080, 0
    s_cselect_b32 s77, s77, 1000
    s_mov_b32 s71, 0x20000
    v_mul_u32_u24 v7, 3072, v4
    v_lshl_add_u32 v7, v5, 4, v7
    buffer_load_dwordx4 v[16:19], v6, s[48:51], s72 offen offset:0
    buffer_load_dwordx4 v[36:39], v7, s[68:71], s73 offen
    s_add_u32 s73, s73, 122880
    buffer_load_dwordx4 v[40:43], v7, s[68:71], s73 offen
    s_add_u32 s73, s73, 122880
    buffer_load_dwordx4 v[44:47], v7, s[68:71], s73 offen
    s_add_u32 s73, s73, 122880
    buffer_load_dwordx4 v[48:51], v7, s[68:71], s73 offen
    s_add_u32 s73, s73, 122880
    s_barrier
    v_mov_b32 v9, 163748
L_k1_g0:
    ds_read_b32 v8, v9
    s_waitcnt lgkmcnt(0)
    v_readfirstlane_b32 s9, v8
    s_nop 0
    s_cmp_ge_i32 s9, 2
    s_cbranch_scc1 L_k1_g0_ok
    s_sleep 1
    s_branch L_k1_g0
L_k1_g0_ok:
    buffer_load_dwordx4 v[20:23], v6, s[48:51], s72 offen offset:256
    buffer_load_dwordx4 v[52:55], v7, s[68:71], s73 offen
    s_add_u32 s73, s73, 122880
    buffer_load_dwordx4 v[56:59], v7, s[68:71], s73 offen
    s_add_u32 s73, s73, 122880
    buffer_load_dwordx4 v[60:63], v7, s[68:71], s73 offen
    s_add_u32 s73, s73, 122880
    buffer_load_dwordx4 v[24:27], v6, s[48:51], s72 offen offset:512
    buffer_load_dwordx4 v[64:67], v7, s[68:71], s73 offen
    s_add_u32 s73, s73, 122880
    buffer_load_dwordx4 v[68:71], v7, s[68:71], s73 offen
    s_add_u32 s73, s73, 122880
    buffer_load_dwordx4 v[72:75], v7, s[68:71], s73 offen
    s_add_u32 s73, s73, 122880
    buffer_load_dwordx4 v[28:31], v6, s[48:51], s72 offen offset:768
    buffer_load_dwordx4 v[76:79], v7, s[68:71], s73 offen
    s_add_u32 s73, s73, 122880
    buffer_load_dwordx4 v[80:83], v7, s[68:71], s73 offen
    s_add_u32 s73, s73, 122880
    buffer_load_dwordx4 v[84:87], v7, s[68:71], s73 offen
    s_add_u32 s73, s73, 122880
    buffer_load_dwordx4 v[32:35], v6, s[48:51], s72 offen offset:1024
    buffer_load_dwordx4 v[88:91], v7, s[68:71], s73 offen
    s_add_u32 s73, s73, 122880
    buffer_load_dwordx4 v[92:95], v7, s[68:71], s73 offen
    s_add_u32 s73, s73, 122880
    buffer_load_dwordx4 v[96:99], v7, s[68:71], s73 offen
    s_add_u32 s73, s73, 122880
    s_branch L_k1_Db
L_k1_D1a:
    s_cmp_lt_u32 s76, 20
    s_cselect_b32 s68, s22, s24
    s_cselect_b32 s69, s23, s25
    s_cselect_b32 s10, 0, 20
    s_cselect_b32 s77, 0, 80
    s_sub_u32 s9, s76, s10
    s_and_b32 s10, s2, 3
    s_mul_i32 s10, s10, 20
    s_add_u32 s9, s9, s10
    s_add_u32 s77, s77, s9
    s_mul_i32 s73, s9, 10240
    s_add_u32 s74, s73, 5120
    s_cmp_lt_u32 s76, 40
    s_cselect_b32 s70, 819200, 0
    s_cselect_b32 s77, s77, 1000
    s_mov_b32 s71, 0x20000
    buffer_load_dwordx4 v[16:19], v6, s[48:51], s72 offen offset:0
    buffer_load_dwordx4 v[36:39], v6, s[68:71], s73 offen offset:0
    buffer_load_dwordx4 v[56:59], v6, s[68:71], s74 offen offset:0
    s_barrier
    v_mov_b32 v9, 163748
L_k1_g1:
    ds_read_b32 v8, v9
    s_waitcnt lgkmcnt(0)
    v_readfirstlane_b32 s9, v8
    s_nop 0
    s_cmp_ge_i32 s9, 2
    s_cbranch_scc1 L_k1_g1_ok
    s_sleep 1
    s_branch L_k1_g1
L_k1_g1_ok:
    buffer_load_dwordx4 v[20:23], v6, s[48:51], s72 offen offset:256
    buffer_load_dwordx4 v[40:43], v6, s[68:71], s73 offen offset:256
    buffer_load_dwordx4 v[60:63], v6, s[68:71], s74 offen offset:256
    buffer_load_dwordx4 v[24:27], v6, s[48:51], s72 offen offset:512
    buffer_load_dwordx4 v[44:47], v6, s[68:71], s73 offen offset:512
    buffer_load_dwordx4 v[64:67], v6, s[68:71], s74 offen offset:512
    buffer_load_dwordx4 v[28:31], v6, s[48:51], s72 offen offset:768
    buffer_load_dwordx4 v[48:51], v6, s[68:71], s73 offen offset:768
    buffer_load_dwordx4 v[68:71], v6, s[68:71], s74 offen offset:768
    buffer_load_dwordx4 v[32:35], v6, s[48:51], s72 offen offset:1024
    buffer_load_dwordx4 v[52:55], v6, s[68:71], s73 offen offset:1024
    buffer_load_dwordx4 v[72:75], v6, s[68:71], s74 offen offset:1024
L_k1_Db:
    v_mov_b32 v10, 0
    global_load_dword v12, v10, s[44:45] sc1
    s_cmp_eq_u32 s8, 1
    s_cbranch_scc1 L_k1_pld
    s_lshl_b32 s12, s6, 3
    s_add_u32 s12, s12, s7
    s_lshl_b32 s12, s12, 1
    s_add_u32 s12, s12, s4
    s_lshl_b32 s12, s12, 1
    s_add_u32 s9, s12, 0
    s_mul_i32 s14, s9, 6554
    s_lshr_b32 s14, s14, 16
    s_mul_i32 s10, s14, 10
    s_sub_u32 s15, s9, s10
    s_add_u32 s9, s12, 1
    s_mul_i32 s78, s9, 6554
    s_lshr_b32 s78, s78, 16
    s_mul_i32 s10, s78, 10
    s_sub_u32 s79, s9, s10
    s_mov_b32 s64, s40
    s_mov_b32 s65, s41
    s_mov_b32 s66, 1966080
    s_mov_b32 s67, 0x20000
    s_mov_b32 s52, s26
    s_mov_b32 s53, s27
    s_mov_b32 s54, 819200
    s_mov_b32 s55, 0x20000
    s_mov_b32 s56, s28
    s_mov_b32 s57, s29
    s_mov_b32 s58, 819200
    s_mov_b32 s59, 0x20000
    v_mul_u32_u24 v10, 1280, v4
    v_lshl_add_u32 v10, v5, 4, v10
    s_cmp_lt_u32 s14, 48
    s_cselect_b32 s66, s66, 0
    s_cmp_lt_u32 s14, 40
    s_cselect_b32 s54, s54, 0
    s_cselect_b32 s58, s58, 0
    s_mul_i32 s10, s14, 40960
    s_lshl_b32 s11, s15, 7
    s_add_u32 s10, s10, s11
    buffer_load_dwordx4 v[100:103], v10, s[64:67], s10 offen nt
    s_add_u32 s10, s10, 10240
    buffer_load_dwordx4 v[104:107], v10, s[64:67], s10 offen nt
    s_add_u32 s10, s10, 10240
    buffer_load_dwordx4 v[108:111], v10, s[64:67], s10 offen nt
    s_add_u32 s10, s10, 10240
    buffer_load_dwordx4 v[112:115], v10, s[64:67], s10 offen nt
    s_mul_i32 s10, s78, 40960
    s_lshl_b32 s11, s79, 7
    s_add_u32 s10, s10, s11
    buffer_load_dwordx4 v[116:119], v10, s[64:67], s10 offen nt
    s_add_u32 s10, s10, 10240
    buffer_load_dwordx4 v[120:123], v10, s[64:67], s10 offen nt
    s_add_u32 s10, s10, 10240
    buffer_load_dwordx4 v[124:127], v10, s[64:67], s10 offen nt
    s_add_u32 s10, s10, 10240
    buffer_load_dwordx4 v[128:131], v10, s[64:67], s10 offen nt
    s_mul_i32 s10, s14, 20480
    s_lshl_b32 s11, s15, 7
    s_add_u32 s10, s10, s11
    s_add_u32 s11, s10, 10240
    buffer_load_dwordx4 v[180:183], v10, s[52:55], s10 offen nt
    buffer_load_dwordx4 v[184:187], v10, s[52:55], s11 offen nt
    buffer_load_dwordx4 v[188:191], v10, s[56:59], s10 offen nt
    buffer_load_dwordx4 v[192:195], v10, s[56:59], s11 offen nt
    s_mul_i32 s10, s78, 20480
    s_lshl_b32 s11, s79, 7
    s_add_u32 s10, s10, s11
    s_add_u32 s11, s10, 10240
    buffer_load_dwordx4 v[196:199], v10, s[52:55], s10 offen nt
    buffer_load_dwordx4 v[200:203], v10, s[52:55], s11 offen nt
    buffer_load_dwordx4 v[204:207], v10, s[56:59], s10 offen nt
    buffer_load_dwordx4 v[208:211], v10, s[56:59], s11 offen nt
L_k1_pld:
    s_cmp_eq_u32 s8, 0
    s_cbranch_scc1 L_k1_npar
    s_mul_i32 s9, s7, 80
    s_mul_i32 s10, s4, 40
    s_add_u32 s10, s10, s9
    v_add_u32 v10, s10, v5
    v_lshlrev_b32 v10, 1, v10
    global_load_ushort v180, v10, s[18:19] offset:0
    global_load_ushort v185, v10, s[20:21] offset:0
    global_load_ushort v190, v10, s[30:31] offset:0
    global_load_ushort v181, v10, s[18:19] offset:16
    global_load_ushort v186, v10, s[20:21] offset:16
    global_load_ushort v191, v10, s[30:31] offset:16
    global_load_ushort v182, v10, s[18:19] offset:32
    global_load_ushort v187, v10, s[20:21] offset:32
    global_load_ushort v192, v10, s[30:31] offset:32
    global_load_ushort v183, v10, s[18:19] offset:48
    global_load_ushort v188, v10, s[20:21] offset:48
    global_load_ushort v193, v10, s[30:31] offset:48
    global_load_ushort v184, v10, s[18:19] offset:64
    global_load_ushort v189, v10, s[20:21] offset:64
    global_load_ushort v194, v10, s[30:31] offset:64
    s_waitcnt vmcnt(15)
L_k1_npar:
    v_mov_b32 v13, 0x3f803f80
    s_waitcnt vmcnt(16)
    s_setprio 3
    s_mov_b32 s12, 0
L_k1_gn:
    v_readfirstlane_b32 s82, v12
    s_add_u32 s12, s12, 1
    s_cmp_lg_u32 s82, 0
    s_cbranch_scc1 L_k1_gnd
    s_cmp_gt_u32 s12, 0x40000
    s_cbranch_scc1 L_k1_gnd
    v_mov_b32 v7, 0
    global_load_dword v12, v7, s[44:45] sc1
    s_waitcnt vmcnt(0)
    s_branch L_k1_gn
L_k1_gnd:
    s_max_u32 s82, s82, 1
    v_dot2_f32_bf16 v172, v16, v13, 0
    v_dot2_f32_bf16 v173, v17, v13, 0
    v_dot2_f32_bf16 v172, v18, v13, v172
    v_dot2_f32_bf16 v173, v19, v13, v173
    v_dot2_f32_bf16 v172, v20, v13, v172
    v_dot2_f32_bf16 v173, v21, v13, v173
    v_dot2_f32_bf16 v172, v22, v13, v172
    v_dot2_f32_bf16 v173, v23, v13, v173
    v_dot2_f32_bf16 v172, v24, v13, v172
    v_dot2_f32_bf16 v173, v25, v13, v173
    v_dot2_f32_bf16 v172, v26, v13, v172
    v_dot2_f32_bf16 v173, v27, v13, v173
    v_dot2_f32_bf16 v172, v28, v13, v172
    v_dot2_f32_bf16 v173, v29, v13, v173
    v_dot2_f32_bf16 v172, v30, v13, v172
    v_dot2_f32_bf16 v173, v31, v13, v173
    v_dot2_f32_bf16 v172, v32, v13, v172
    v_dot2_f32_bf16 v173, v33, v13, v173
    v_dot2_f32_bf16 v172, v34, v13, v172
    v_dot2_f32_bf16 v173, v35, v13, v173
    v_dot2_f32_bf16 v174, v16, v16, 0
    v_dot2_f32_bf16 v175, v17, v17, 0
    v_dot2_f32_bf16 v174, v18, v18, v174
    v_dot2_f32_bf16 v175, v19, v19, v175
    v_dot2_f32_bf16 v174, v20, v20, v174
    v_dot2_f32_bf16 v175, v21, v21, v175
    v_dot2_f32_bf16 v174, v22, v22, v174
    v_dot2_f32_bf16 v175, v23, v23, v175
    v_dot2_f32_bf16 v174, v24, v24, v174
    v_dot2_f32_bf16 v175, v25, v25, v175
    v_dot2_f32_bf16 v174, v26, v26, v174
    v_dot2_f32_bf16 v175, v27, v27, v175
    v_dot2_f32_bf16 v174, v28, v28, v174
    v_dot2_f32_bf16 v175, v29, v29, v175
    v_dot2_f32_bf16 v174, v30, v30, v174
    v_dot2_f32_bf16 v175, v31, v31, v175
    v_dot2_f32_bf16 v174, v32, v32, v174
    v_dot2_f32_bf16 v175, v33, v33, v175
    v_dot2_f32_bf16 v174, v34, v34, v174
    v_dot2_f32_bf16 v175, v35, v35, v175
    v_add_f32 v172, v172, v173
    s_nop 1
    v_add_f32 v174, v174, v175
    v_add_f32_dpp v172, v172, v172 row_ror:8 row_mask:0xf bank_mask:0xf
    s_nop 0
    v_add_f32_dpp v174, v174, v174 row_ror:8 row_mask:0xf bank_mask:0xf
    v_add_f32_dpp v172, v172, v172 row_ror:4 row_mask:0xf bank_mask:0xf
    s_nop 0
    v_add_f32_dpp v174, v174, v174 row_ror:4 row_mask:0xf bank_mask:0xf
    v_add_f32_dpp v172, v172, v172 row_ror:2 row_mask:0xf bank_mask:0xf
    s_nop 0
    v_add_f32_dpp v174, v174, v174 row_ror:2 row_mask:0xf bank_mask:0xf
    v_add_f32_dpp v172, v172, v172 row_ror:1 row_mask:0xf bank_mask:0xf
    s_nop 0
    v_add_f32_dpp v174, v174, v174 row_ror:1 row_mask:0xf bank_mask:0xf
    v_mul_f32 v172, 0x3acccccd, v172
    v_mul_f32 v174, 0x3acccccd, v174
    v_fma_f32 v174, -v172, v172, v174
    v_max_f32 v174, 0, v174
    v_cvt_pk_bf16_f32 v174, v174, v174
    v_lshlrev_b32 v174, 16, v174
    v_add_f32 v174, 0x3727c5ac, v174
    v_cvt_pk_bf16_f32 v174, v174, v174
    v_lshlrev_b32 v174, 16, v174
    v_sqrt_f32 v174, v174
    s_nop 0
    v_cvt_pk_bf16_f32 v176, v172, v174
    v_mov_b32 v177, s82
    s_lshl_b32 s9, s81, 5
    s_add_u32 s9, s9, 0x1100000
    v_lshlrev_b32 v8, 3, v3
    s_mov_b32 exec_lo, 0x00010001
    s_mov_b32 exec_hi, 0x00010001
    buffer_store_dwordx2 v[176:177], v8, s[60:63], s9 offen sc1
    s_mov_b64 exec, -1
    s_cmp_eq_u32 s4, 1
    s_cbranch_scc1 L_k1_D1b
    v_and_b32 v140, 1, v2
    v_lshlrev_b32 v140, 4, v140
    v_mov_b32 v141, 0x3f80
    v_lshlrev_b32 v140, v140, v141
    v_bfe_u32 v141, v2, 1, 2
    v_cmp_eq_u32 vcc, 0, v141
    s_nop 1
    v_cndmask_b32 v132, 0, v140, vcc
    v_cmp_eq_u32 vcc, 1, v141
    s_nop 1
    v_cndmask_b32 v133, 0, v140, vcc
    v_cmp_eq_u32 vcc, 2, v141
    s_nop 1
    v_cndmask_b32 v134, 0, v140, vcc
    v_cmp_eq_u32 vcc, 3, v141
    s_nop 1
    v_cndmask_b32 v135, 0, v140, vcc
    s_nop 1
    v_mfma_f32_16x16x32_bf16 v[136:139], v[132:135], v[36:39], 0
    v_mfma_f32_16x16x32_bf16 v[136:139], v[132:135], v[40:43], v[136:139]
    v_mfma_f32_16x16x32_bf16 v[136:139], v[132:135], v[44:47], v[136:139]
    v_mfma_f32_16x16x32_bf16 v[136:139], v[132:135], v[48:51], v[136:139]
    v_mfma_f32_16x16x32_bf16 v[136:139], v[132:135], v[52:55], v[136:139]
    v_mfma_f32_16x16x32_bf16 v[136:139], v[132:135], v[56:59], v[136:139]
    v_mfma_f32_16x16x32_bf16 v[136:139], v[132:135], v[60:63], v[136:139]
    v_mfma_f32_16x16x32_bf16 v[136:139], v[132:135], v[64:67], v[136:139]
    v_mfma_f32_16x16x32_bf16 v[136:139], v[132:135], v[68:71], v[136:139]
    v_mfma_f32_16x16x32_bf16 v[136:139], v[132:135], v[72:75], v[136:139]
    v_mfma_f32_16x16x32_bf16 v[136:139], v[132:135], v[76:79], v[136:139]
    v_mfma_f32_16x16x32_bf16 v[136:139], v[132:135], v[80:83], v[136:139]
    v_mfma_f32_16x16x32_bf16 v[136:139], v[132:135], v[84:87], v[136:139]
    v_mfma_f32_16x16x32_bf16 v[136:139], v[132:135], v[88:91], v[136:139]
    v_mfma_f32_16x16x32_bf16 v[136:139], v[132:135], v[92:95], v[136:139]
    v_mfma_f32_16x16x32_bf16 v[136:139], v[132:135], v[96:99], v[136:139]
    s_lshl_b32 s9, s77, 9
    s_add_u32 s9, s9, 0x1110000
    s_cmp_lt_u32 s77, 240
    s_cselect_b32 s9, s9, 0x1300000
    v_lshlrev_b32 v140, 5, v3
    v_lshl_add_u32 v140, v5, 6, v140
    v_add_u32 v140, s9, v140
    v_mov_b32 v145, s82
    v_mov_b32 v147, s82
    v_mov_b32 v149, s82
    v_mov_b32 v151, s82
    v_add_f32_dpp v144, v136, v136 row_ror:8 row_mask:0xf bank_mask:0xf
    v_add_f32_dpp v146, v137, v137 row_ror:8 row_mask:0xf bank_mask:0xf
    v_add_f32_dpp v148, v138, v138 row_ror:8 row_mask:0xf bank_mask:0xf
    v_add_f32_dpp v150, v139, v139 row_ror:8 row_mask:0xf bank_mask:0xf
    s_mov_b32 exec_lo, 0x00ff00ff
    s_mov_b32 exec_hi, 0
    buffer_store_dwordx4 v[144:147], v140, s[60:63], 0 offen sc1
    buffer_store_dwordx4 v[148:151], v140, s[60:63], 0 offen offset:16 sc1
    s_mov_b64 exec, -1
    s_branch L_k1_Dc
L_k1_D1b:
    v_dot2_f32_bf16 v172, v36, v13, 0
    v_dot2_f32_bf16 v173, v37, v13, 0
    v_dot2_f32_bf16 v172, v38, v13, v172
    v_dot2_f32_bf16 v173, v39, v13, v173
    v_dot2_f32_bf16 v172, v40, v13, v172
    v_dot2_f32_bf16 v173, v41, v13, v173
    v_dot2_f32_bf16 v172, v42, v13, v172
    v_dot2_f32_bf16 v173, v43, v13, v173
    v_dot2_f32_bf16 v172, v44, v13, v172
    v_dot2_f32_bf16 v173, v45, v13, v173
    v_dot2_f32_bf16 v172, v46, v13, v172
    v_dot2_f32_bf16 v173, v47, v13, v173
    v_dot2_f32_bf16 v172, v48, v13, v172
    v_dot2_f32_bf16 v173, v49, v13, v173
    v_dot2_f32_bf16 v172, v50, v13, v172
    v_dot2_f32_bf16 v173, v51, v13, v173
    v_dot2_f32_bf16 v172, v52, v13, v172
    v_dot2_f32_bf16 v173, v53, v13, v173
    v_dot2_f32_bf16 v172, v54, v13, v172
    v_dot2_f32_bf16 v173, v55, v13, v173
    v_dot2_f32_bf16 v174, v56, v13, 0
    v_dot2_f32_bf16 v175, v57, v13, 0
    v_dot2_f32_bf16 v174, v58, v13, v174
    v_dot2_f32_bf16 v175, v59, v13, v175
    v_dot2_f32_bf16 v174, v60, v13, v174
    v_dot2_f32_bf16 v175, v61, v13, v175
    v_dot2_f32_bf16 v174, v62, v13, v174
    v_dot2_f32_bf16 v175, v63, v13, v175
    v_dot2_f32_bf16 v174, v64, v13, v174
    v_dot2_f32_bf16 v175, v65, v13, v175
    v_dot2_f32_bf16 v174, v66, v13, v174
    v_dot2_f32_bf16 v175, v67, v13, v175
    v_dot2_f32_bf16 v174, v68, v13, v174
    v_dot2_f32_bf16 v175, v69, v13, v175
    v_dot2_f32_bf16 v174, v70, v13, v174
    v_dot2_f32_bf16 v175, v71, v13, v175
    v_dot2_f32_bf16 v174, v72, v13, v174
    v_dot2_f32_bf16 v175, v73, v13, v175
    v_dot2_f32_bf16 v174, v74, v13, v174
    v_dot2_f32_bf16 v175, v75, v13, v175
    v_add_f32 v172, v172, v173
    s_nop 1
    v_add_f32 v174, v174, v175
    v_add_f32_dpp v172, v172, v172 row_ror:8 row_mask:0xf bank_mask:0xf
    s_nop 0
    v_add_f32_dpp v174, v174, v174 row_ror:8 row_mask:0xf bank_mask:0xf
    v_add_f32_dpp v172, v172, v172 row_ror:4 row_mask:0xf bank_mask:0xf
    s_nop 0
    v_add_f32_dpp v174, v174, v174 row_ror:4 row_mask:0xf bank_mask:0xf
    v_add_f32_dpp v172, v172, v172 row_ror:2 row_mask:0xf bank_mask:0xf
    s_nop 0
    v_add_f32_dpp v174, v174, v174 row_ror:2 row_mask:0xf bank_mask:0xf
    v_add_f32_dpp v172, v172, v172 row_ror:1 row_mask:0xf bank_mask:0xf
    s_nop 0
    v_add_f32_dpp v174, v174, v174 row_ror:1 row_mask:0xf bank_mask:0xf
    v_mov_b32 v173, s82
    v_mov_b32 v175, s82
    s_lshl_b32 s9, s77, 6
    s_add_u32 s9, s9, 0x1108000
    s_cmp_lt_u32 s77, 160
    s_cselect_b32 s9, s9, 0x1300000
    v_add_u32 v9, s9, v8
    s_mov_b32 exec_lo, 0x00010001
    s_mov_b32 exec_hi, 0x00010001
    buffer_store_dwordx2 v[172:173], v9, s[60:63], 0 offen sc1
    buffer_store_dwordx2 v[174:175], v9, s[60:63], 0 offen offset:32 sc1
    s_mov_b64 exec, -1
L_k1_Dc:
    s_waitcnt vmcnt(3)
    s_cmp_eq_u32 s8, 1
    s_cbranch_scc1 L_k1_pdd
    s_cmp_ge_u32 s14, 48
    s_cbranch_scc1 L_k1_pdd
    s_mul_i32 s11, s4, 53248
    s_add_u32 s11, s11, 49152
    v_lshlrev_b32 v133, 4, v1
    v_add_u32 v132, s11, v133
    v_lshrrev_b32 v134, 2, v2
    v_lshl_add_u32 v134, v3, 2, v134
    v_lshlrev_b32 v134, 7, v134
    v_and_b32 v135, 3, v2
    v_lshl_add_u32 v134, v135, 3, v134
    v_add_u32 v134, s11, v134
    v_lshl_add_u32 v135, v5, 3, v4
    v_lshl_add_u32 v135, v135, 4, s11
    v_lshrrev_b32 v136, 1, v4
    v_mul_u32_u24 v136, 5120, v136
    v_and_b32 v137, 1, v4
    v_lshl_add_u32 v137, v137, 5, v5
    v_lshl_add_u32 v136, v137, 4, v136
    ds_write_b128 v132, v[100:103] offset:0
    ds_write_b128 v132, v[104:107] offset:1024
    ds_write_b128 v132, v[108:111] offset:2048
    ds_write_b128 v132, v[112:115] offset:3072
    ds_read_b64_tr_b16 v[100:101], v134 offset:0
    ds_read_b64_tr_b16 v[102:103], v134 offset:2048
    ds_read_b64_tr_b16 v[104:105], v134 offset:32
    ds_read_b64_tr_b16 v[106:107], v134 offset:2080
    ds_read_b64_tr_b16 v[108:109], v134 offset:64
    ds_read_b64_tr_b16 v[110:111], v134 offset:2112
    ds_read_b64_tr_b16 v[112:113], v134 offset:96
    ds_read_b64_tr_b16 v[114:115], v134 offset:2144
    s_waitcnt lgkmcnt(3)
    ds_write_b128 v132, v[116:119] offset:0
    ds_write_b128 v132, v[120:123] offset:1024
    ds_write_b128 v132, v[124:127] offset:2048
    ds_write_b128 v132, v[128:131] offset:3072
    ds_read_b64_tr_b16 v[116:117], v134 offset:0
    ds_read_b64_tr_b16 v[118:119], v134 offset:2048
    ds_read_b64_tr_b16 v[120:121], v134 offset:32
    ds_read_b64_tr_b16 v[122:123], v134 offset:2080
    ds_read_b64_tr_b16 v[124:125], v134 offset:64
    ds_read_b64_tr_b16 v[126:127], v134 offset:2112
    ds_read_b64_tr_b16 v[128:129], v134 offset:96
    ds_read_b64_tr_b16 v[130:131], v134 offset:2144
    s_waitcnt lgkmcnt(7)
    ds_write_b128 v132, v[180:183] offset:0
    ds_write_b128 v132, v[184:187] offset:1024
    ds_write_b128 v132, v[188:191] offset:2048
    ds_write_b128 v132, v[192:195] offset:3072
    ds_read_b128 v[180:183], v135 offset:0
    ds_read_b128 v[184:187], v135 offset:1024
    ds_read_b128 v[188:191], v135 offset:2048
    ds_read_b128 v[192:195], v135 offset:3072
    s_waitcnt lgkmcnt(7)
    ds_write_b128 v132, v[196:199] offset:0
    ds_write_b128 v132, v[200:203] offset:1024
    ds_write_b128 v132, v[204:207] offset:2048
    ds_write_b128 v132, v[208:211] offset:3072
    ds_read_b128 v[196:199], v135 offset:0
    ds_read_b128 v[200:203], v135 offset:1024
    ds_read_b128 v[204:207], v135 offset:2048
    ds_read_b128 v[208:211], v135 offset:3072
    s_lshl_b32 s9, s15, 2
    s_add_u32 s9, s9, 0
    s_mul_i32 s10, s9, 52
    s_lshr_b32 s10, s10, 8
    s_mul_i32 s10, s10, 435
    s_add_u32 s10, s10, s9
    s_mul_i32 s9, s14, 5
    s_add_u32 s10, s10, s9
    s_lshl_b32 s10, s10, 10
    s_add_u32 s10, s10, 12582912
    buffer_store_dwordx4 v[100:103], v133, s[60:63], s10 offen sc1
    s_lshl_b32 s9, s15, 2
    s_add_u32 s9, s9, 1
    s_mul_i32 s10, s9, 52
    s_lshr_b32 s10, s10, 8
    s_mul_i32 s10, s10, 435
    s_add_u32 s10, s10, s9
    s_mul_i32 s9, s14, 5
    s_add_u32 s10, s10, s9
    s_lshl_b32 s10, s10, 10
    s_add_u32 s10, s10, 12582912
    buffer_store_dwordx4 v[104:107], v133, s[60:63], s10 offen sc1
    s_lshl_b32 s9, s15, 2
    s_add_u32 s9, s9, 2
    s_mul_i32 s10, s9, 52
    s_lshr_b32 s10, s10, 8
    s_mul_i32 s10, s10, 435
    s_add_u32 s10, s10, s9
    s_mul_i32 s9, s14, 5
    s_add_u32 s10, s10, s9
    s_lshl_b32 s10, s10, 10
    s_add_u32 s10, s10, 12582912
    buffer_store_dwordx4 v[108:111], v133, s[60:63], s10 offen sc1
    s_lshl_b32 s9, s15, 2
    s_add_u32 s9, s9, 3
    s_mul_i32 s10, s9, 52
    s_lshr_b32 s10, s10, 8
    s_mul_i32 s10, s10, 435
    s_add_u32 s10, s10, s9
    s_mul_i32 s9, s14, 5
    s_add_u32 s10, s10, s9
    s_lshl_b32 s10, s10, 10
    s_add_u32 s10, s10, 12582912
    buffer_store_dwordx4 v[112:115], v133, s[60:63], s10 offen sc1
    s_lshl_b32 s9, s79, 2
    s_add_u32 s9, s9, 0
    s_mul_i32 s10, s9, 52
    s_lshr_b32 s10, s10, 8
    s_mul_i32 s10, s10, 435
    s_add_u32 s10, s10, s9
    s_mul_i32 s9, s78, 5
    s_add_u32 s10, s10, s9
    s_lshl_b32 s10, s10, 10
    s_add_u32 s10, s10, 12582912
    buffer_store_dwordx4 v[116:119], v133, s[60:63], s10 offen sc1
    s_lshl_b32 s9, s79, 2
    s_add_u32 s9, s9, 1
    s_mul_i32 s10, s9, 52
    s_lshr_b32 s10, s10, 8
    s_mul_i32 s10, s10, 435
    s_add_u32 s10, s10, s9
    s_mul_i32 s9, s78, 5
    s_add_u32 s10, s10, s9
    s_lshl_b32 s10, s10, 10
    s_add_u32 s10, s10, 12582912
    buffer_store_dwordx4 v[120:123], v133, s[60:63], s10 offen sc1
    s_lshl_b32 s9, s79, 2
    s_add_u32 s9, s9, 2
    s_mul_i32 s10, s9, 52
    s_lshr_b32 s10, s10, 8
    s_mul_i32 s10, s10, 435
    s_add_u32 s10, s10, s9
    s_mul_i32 s9, s78, 5
    s_add_u32 s10, s10, s9
    s_lshl_b32 s10, s10, 10
    s_add_u32 s10, s10, 12582912
    buffer_store_dwordx4 v[124:127], v133, s[60:63], s10 offen sc1
    s_lshl_b32 s9, s79, 2
    s_add_u32 s9, s9, 3
    s_mul_i32 s10, s9, 52
    s_lshr_b32 s10, s10, 8
    s_mul_i32 s10, s10, 435
    s_add_u32 s10, s10, s9
    s_mul_i32 s9, s78, 5
    s_add_u32 s10, s10, s9
    s_lshl_b32 s10, s10, 10
    s_add_u32 s10, s10, 12582912
    buffer_store_dwordx4 v[128:131], v133, s[60:63], s10 offen sc1
    s_cmp_ge_u32 s14, 40
    s_cbranch_scc1 L_k1_pdd
    s_waitcnt lgkmcnt(0)
    s_mul_i32 s10, s14, 52
    s_lshr_b32 s10, s10, 8
    s_mul_i32 s10, s10, 435
    s_add_u32 s10, s10, s14
    s_mul_i32 s9, s15, 20
    s_add_u32 s10, s10, s9
    s_add_u32 s10, s10, 240
    s_lshl_b32 s10, s10, 10
    s_add_u32 s10, s10, 12582912
    v_xor_b32 v188, 0x80008000, v188
    v_xor_b32 v189, 0x80008000, v189
    v_xor_b32 v190, 0x80008000, v190
    v_xor_b32 v191, 0x80008000, v191
    v_xor_b32 v192, 0x80008000, v192
    v_xor_b32 v193, 0x80008000, v193
    v_xor_b32 v194, 0x80008000, v194
    v_xor_b32 v195, 0x80008000, v195
    buffer_store_dwordx4 v[180:183], v136, s[60:63], s10 offen offset:0 sc1
    buffer_store_dwordx4 v[184:187], v136, s[60:63], s10 offen offset:128 sc1
    buffer_store_dwordx4 v[188:191], v136, s[60:63], s10 offen offset:256 sc1
    buffer_store_dwordx4 v[192:195], v136, s[60:63], s10 offen offset:384 sc1
    s_mul_i32 s10, s78, 52
    s_lshr_b32 s10, s10, 8
    s_mul_i32 s10, s10, 435
    s_add_u32 s10, s10, s78
    s_mul_i32 s9, s79, 20
    s_add_u32 s10, s10, s9
    s_add_u32 s10, s10, 240
    s_lshl_b32 s10, s10, 10
    s_add_u32 s10, s10, 12582912
    v_xor_b32 v204, 0x80008000, v204
    v_xor_b32 v205, 0x80008000, v205
    v_xor_b32 v206, 0x80008000, v206
    v_xor_b32 v207, 0x80008000, v207
    v_xor_b32 v208, 0x80008000, v208
    v_xor_b32 v209, 0x80008000, v209
    v_xor_b32 v210, 0x80008000, v210
    v_xor_b32 v211, 0x80008000, v211
    buffer_store_dwordx4 v[196:199], v136, s[60:63], s10 offen offset:0 sc1
    buffer_store_dwordx4 v[200:203], v136, s[60:63], s10 offen offset:128 sc1
    buffer_store_dwordx4 v[204:207], v136, s[60:63], s10 offen offset:256 sc1
    buffer_store_dwordx4 v[208:211], v136, s[60:63], s10 offen offset:384 sc1
L_k1_pdd:
    s_cmp_eq_u32 s8, 1
    s_cbranch_scc1 L_k1_npf
    s_lshl_b32 s9, s8, 4
    s_add_u32 s9, s9, s6
    s_lshl_b32 s9, s9, 3
    s_add_u32 s9, s9, s7
    s_lshl_b32 s9, s9, 1
    s_add_u32 s9, s9, s4
    s_lshl_b32 s9, s9, 2
    s_add_u32 s9, s9, 0x1130000
    v_mov_b32 v132, s9
    v_mov_b32 v133, s82
    s_waitcnt vmcnt(0)
    s_mov_b64 exec, 1
    buffer_store_dword v133, v132, s[60:63], 0 offen sc1
    s_mov_b64 exec, -1
L_k1_npf:
    s_setprio 0
    s_cmp_eq_u32 s8, 0
    s_cbranch_scc1 L_k1_ntb
    v_lshrrev_b32 v7, 3, v2
    v_xor_b32 v7, 1, v7
    v_lshlrev_b32 v7, 31, v7
    v_lshlrev_b32 v180, 16, v180
    v_lshlrev_b32 v181, 16, v181
    v_lshlrev_b32 v182, 16, v182
    v_lshlrev_b32 v183, 16, v183
    v_lshlrev_b32 v184, 16, v184
    v_lshlrev_b32 v185, 16, v185
    v_lshlrev_b32 v186, 16, v186
    v_lshlrev_b32 v187, 16, v187
    v_lshlrev_b32 v188, 16, v188
    v_lshlrev_b32 v189, 16, v189
    v_lshlrev_b32 v190, 16, v190
    v_lshlrev_b32 v191, 16, v191
    v_lshlrev_b32 v192, 16, v192
    v_lshlrev_b32 v193, 16, v193
    v_lshlrev_b32 v194, 16, v194
    v_xor_b32 v185, v185, v7
    v_mul_f32 v190, 0x3fb8aa3b, v190
    v_xor_b32 v186, v186, v7
    v_mul_f32 v191, 0x3fb8aa3b, v191
    v_xor_b32 v187, v187, v7
    v_mul_f32 v192, 0x3fb8aa3b, v192
    v_xor_b32 v188, v188, v7
    v_mul_f32 v193, 0x3fb8aa3b, v193
    v_xor_b32 v189, v189, v7
    v_mul_f32 v194, 0x3fb8aa3b, v194
    v_exp_f32 v190, v190
    v_exp_f32 v191, v191
    v_exp_f32 v192, v192
    v_exp_f32 v193, v193
    v_exp_f32 v194, v194
    v_cvt_pk_bf16_f32 v190, v190, v190
    v_cvt_pk_bf16_f32 v191, v191, v191
    v_cvt_pk_bf16_f32 v192, v192, v192
    v_cvt_pk_bf16_f32 v193, v193, v193
    v_cvt_pk_bf16_f32 v194, v194, v194
    v_lshlrev_b32 v190, 16, v190
    v_lshlrev_b32 v191, 16, v191
    v_lshlrev_b32 v192, 16, v192
    v_lshlrev_b32 v193, 16, v193
    v_lshlrev_b32 v194, 16, v194
    v_mul_f32 v80, v190, v180
    v_mul_f32 v85, v190, v185
    v_mul_f32 v81, v191, v181
    v_mul_f32 v86, v191, v186
    v_mul_f32 v82, v192, v182
    v_mul_f32 v87, v192, v187
    v_mul_f32 v83, v193, v183
    v_mul_f32 v88, v193, v188
    v_mul_f32 v84, v194, v184
    v_mul_f32 v89, v194, v189
    v_mul_f32 v80, 0x3fb8aa3b, v80
    v_mul_f32 v85, 0x3e22f983, v85
    v_mul_f32 v81, 0x3fb8aa3b, v81
    v_mul_f32 v86, 0x3e22f983, v86
    v_mul_f32 v82, 0x3fb8aa3b, v82
    v_mul_f32 v87, 0x3e22f983, v87
    v_mul_f32 v83, 0x3fb8aa3b, v83
    v_mul_f32 v88, 0x3e22f983, v88
    v_mul_f32 v84, 0x3fb8aa3b, v84
    v_mul_f32 v89, 0x3e22f983, v89
    v_cvt_f32_u32 v7, v3
    v_mul_f32 v8, 0x42800000, v7
    v_mul_f32 v7, 0x41800000, v7
    v_mul_f32 v90, 1.0, v80
    v_mul_f32 v95, 1.0, v85
    v_mul_f32 v91, 1.0, v81
    v_mul_f32 v96, 1.0, v86
    v_mul_f32 v92, 1.0, v82
    v_mul_f32 v97, 1.0, v87
    v_mul_f32 v93, 1.0, v83
    v_mul_f32 v98, 1.0, v88
    v_mul_f32 v94, 1.0, v84
    v_mul_f32 v99, 1.0, v89
    v_exp_f32 v90, v90
    v_rndne_f32 v196, v95
    v_exp_f32 v91, v91
    v_rndne_f32 v197, v96
    v_exp_f32 v92, v92
    v_rndne_f32 v198, v97
    v_exp_f32 v93, v93
    v_rndne_f32 v199, v98
    v_exp_f32 v94, v94
    v_rndne_f32 v200, v99
    v_sub_f32 v95, v95, v196
    v_sub_f32 v96, v96, v197
    v_sub_f32 v97, v97, v198
    v_sub_f32 v98, v98, v199
    v_sub_f32 v99, v99, v200
    v_cos_f32 v196, v95
    v_sin_f32 v201, v95
    v_cos_f32 v197, v96
    v_sin_f32 v202, v96
    v_cos_f32 v198, v97
    v_sin_f32 v203, v97
    v_cos_f32 v199, v98
    v_sin_f32 v204, v98
    v_cos_f32 v200, v99
    v_sin_f32 v205, v99
    v_mul_f32 v196, v196, v90
    v_mul_f32 v201, v201, v90
    v_mul_f32 v197, v197, v91
    v_mul_f32 v202, v202, v91
    v_mul_f32 v198, v198, v92
    v_mul_f32 v203, v203, v92
    v_mul_f32 v199, v199, v93
    v_mul_f32 v204, v204, v93
    v_mul_f32 v200, v200, v94
    v_mul_f32 v205, v205, v94
    v_mul_f32 v90, 0x41800000, v80
    v_mul_f32 v95, 0x41800000, v85
    v_mul_f32 v91, 0x41800000, v81
    v_mul_f32 v96, 0x41800000, v86
    v_mul_f32 v92, 0x41800000, v82
    v_mul_f32 v97, 0x41800000, v87
    v_mul_f32 v93, 0x41800000, v83
    v_mul_f32 v98, 0x41800000, v88
    v_mul_f32 v94, 0x41800000, v84
    v_mul_f32 v99, 0x41800000, v89
    v_exp_f32 v90, v90
    v_rndne_f32 v211, v95
    v_exp_f32 v91, v91
    v_rndne_f32 v212, v96
    v_exp_f32 v92, v92
    v_rndne_f32 v213, v97
    v_exp_f32 v93, v93
    v_rndne_f32 v214, v98
    v_exp_f32 v94, v94
    v_rndne_f32 v215, v99
    v_sub_f32 v95, v95, v211
    v_sub_f32 v96, v96, v212
    v_sub_f32 v97, v97, v213
    v_sub_f32 v98, v98, v214
    v_sub_f32 v99, v99, v215
    v_cos_f32 v211, v95
    v_sin_f32 v216, v95
    v_cos_f32 v212, v96
    v_sin_f32 v217, v96
    v_cos_f32 v213, v97
    v_sin_f32 v218, v97
    v_cos_f32 v214, v98
    v_sin_f32 v219, v98
    v_cos_f32 v215, v99
    v_sin_f32 v220, v99
    v_mul_f32 v211, v211, v90
    v_mul_f32 v216, v216, v90
    v_mul_f32 v212, v212, v91
    v_mul_f32 v217, v217, v91
    v_mul_f32 v213, v213, v92
    v_mul_f32 v218, v218, v92
    v_mul_f32 v214, v214, v93
    v_mul_f32 v219, v219, v93
    v_mul_f32 v215, v215, v94
    v_mul_f32 v220, v220, v94
    v_mul_f32 v90, 0x43800000, v80
    v_mul_f32 v95, 0x43800000, v85
    v_mul_f32 v91, 0x43800000, v81
    v_mul_f32 v96, 0x43800000, v86
    v_mul_f32 v92, 0x43800000, v82
    v_mul_f32 v97, 0x43800000, v87
    v_mul_f32 v93, 0x43800000, v83
    v_mul_f32 v98, 0x43800000, v88
    v_mul_f32 v94, 0x43800000, v84
    v_mul_f32 v99, 0x43800000, v89
    v_exp_f32 v90, v90
    v_rndne_f32 v232, v95
    v_exp_f32 v91, v91
    v_rndne_f32 v233, v96
    v_exp_f32 v92, v92
    v_rndne_f32 v234, v97
    v_exp_f32 v93, v93
    v_rndne_f32 v235, v98
    v_exp_f32 v94, v94
    v_rndne_f32 v236, v99
    v_sub_f32 v95, v95, v232
    v_sub_f32 v96, v96, v233
    v_sub_f32 v97, v97, v234
    v_sub_f32 v98, v98, v235
    v_sub_f32 v99, v99, v236
    v_cos_f32 v232, v95
    v_sin_f32 v237, v95
    v_cos_f32 v233, v96
    v_sin_f32 v238, v96
    v_cos_f32 v234, v97
    v_sin_f32 v239, v97
    v_cos_f32 v235, v98
    v_sin_f32 v240, v98
    v_cos_f32 v236, v99
    v_sin_f32 v241, v99
    v_mul_f32 v232, v232, v90
    v_mul_f32 v237, v237, v90
    v_mul_f32 v233, v233, v91
    v_mul_f32 v238, v238, v91
    v_mul_f32 v234, v234, v92
    v_mul_f32 v239, v239, v92
    v_mul_f32 v235, v235, v93
    v_mul_f32 v240, v240, v93
    v_mul_f32 v236, v236, v94
    v_mul_f32 v241, v241, v94
    v_mul_f32 v90, v8, v80
    v_mul_f32 v95, v8, v85
    v_mul_f32 v91, v8, v81
    v_mul_f32 v96, v8, v86
    v_mul_f32 v92, v8, v82
    v_mul_f32 v97, v8, v87
    v_mul_f32 v93, v8, v83
    v_mul_f32 v98, v8, v88
    v_mul_f32 v94, v8, v84
    v_mul_f32 v99, v8, v89
    v_exp_f32 v90, v90
    v_rndne_f32 v48, v95
    v_exp_f32 v91, v91
    v_rndne_f32 v49, v96
    v_exp_f32 v92, v92
    v_rndne_f32 v50, v97
    v_exp_f32 v93, v93
    v_rndne_f32 v51, v98
    v_exp_f32 v94, v94
    v_rndne_f32 v52, v99
    v_sub_f32 v95, v95, v48
    v_sub_f32 v96, v96, v49
    v_sub_f32 v97, v97, v50
    v_sub_f32 v98, v98, v51
    v_sub_f32 v99, v99, v52
    v_cos_f32 v48, v95
    v_sin_f32 v53, v95
    v_cos_f32 v49, v96
    v_sin_f32 v54, v96
    v_cos_f32 v50, v97
    v_sin_f32 v55, v97
    v_cos_f32 v51, v98
    v_sin_f32 v56, v98
    v_cos_f32 v52, v99
    v_sin_f32 v57, v99
    v_mul_f32 v48, v48, v90
    v_mul_f32 v53, v53, v90
    v_mul_f32 v49, v49, v91
    v_mul_f32 v54, v54, v91
    v_mul_f32 v50, v50, v92
    v_mul_f32 v55, v55, v92
    v_mul_f32 v51, v51, v93
    v_mul_f32 v56, v56, v93
    v_mul_f32 v52, v52, v94
    v_mul_f32 v57, v57, v94
    v_mul_f32 v90, v7, v80
    v_mul_f32 v95, v7, v85
    v_mul_f32 v91, v7, v81
    v_mul_f32 v96, v7, v86
    v_mul_f32 v92, v7, v82
    v_mul_f32 v97, v7, v87
    v_mul_f32 v93, v7, v83
    v_mul_f32 v98, v7, v88
    v_mul_f32 v94, v7, v84
    v_mul_f32 v99, v7, v89
    v_exp_f32 v90, v90
    v_rndne_f32 v58, v95
    v_exp_f32 v91, v91
    v_rndne_f32 v59, v96
    v_exp_f32 v92, v92
    v_rndne_f32 v60, v97
    v_exp_f32 v93, v93
    v_rndne_f32 v61, v98
    v_exp_f32 v94, v94
    v_rndne_f32 v62, v99
    v_sub_f32 v95, v95, v58
    v_sub_f32 v96, v96, v59
    v_sub_f32 v97, v97, v60
    v_sub_f32 v98, v98, v61
    v_sub_f32 v99, v99, v62
    v_cos_f32 v58, v95
    v_sin_f32 v63, v95
    v_cos_f32 v59, v96
    v_sin_f32 v64, v96
    v_cos_f32 v60, v97
    v_sin_f32 v65, v97
    v_cos_f32 v61, v98
    v_sin_f32 v66, v98
    v_cos_f32 v62, v99
    v_sin_f32 v67, v99
    v_mul_f32 v58, v58, v90
    v_mul_f32 v63, v63, v90
    v_mul_f32 v59, v59, v91
    v_mul_f32 v64, v64, v91
    v_mul_f32 v60, v60, v92
    v_mul_f32 v65, v65, v92
    v_mul_f32 v61, v61, v93
    v_mul_f32 v66, v66, v93
    v_mul_f32 v62, v62, v94
    v_mul_f32 v67, v67, v94
    v_add_f32 v90, -1.0, v196
    v_mul_f32 v95, v180, v180
    v_add_f32 v91, -1.0, v197
    v_mul_f32 v96, v181, v181
    v_add_f32 v92, -1.0, v198
    v_mul_f32 v97, v182, v182
    v_add_f32 v93, -1.0, v199
    v_mul_f32 v98, v183, v183
    v_add_f32 v94, -1.0, v200
    v_mul_f32 v99, v184, v184
    v_fmac_f32 v95, v185, v185
    v_fmac_f32 v96, v186, v186
    v_fmac_f32 v97, v187, v187
    v_fmac_f32 v98, v188, v188
    v_fmac_f32 v99, v189, v189
    v_rcp_f32 v95, v95
    v_rcp_f32 v96, v96
    v_rcp_f32 v97, v97
    v_rcp_f32 v98, v98
    v_rcp_f32 v99, v99
    v_mul_f32 v222, v90, v180
    v_mul_f32 v206, v201, v180
    v_mul_f32 v224, v91, v181
    v_mul_f32 v207, v202, v181
    v_mul_f32 v226, v92, v182
    v_mul_f32 v208, v203, v182
    v_mul_f32 v228, v93, v183
    v_mul_f32 v209, v204, v183
    v_mul_f32 v230, v94, v184
    v_mul_f32 v210, v205, v184
    v_fmac_f32 v222, v201, v185
    v_fma_f32 v206, -v90, v185, v206
    v_fmac_f32 v224, v202, v186
    v_fma_f32 v207, -v91, v186, v207
    v_fmac_f32 v226, v203, v187
    v_fma_f32 v208, -v92, v187, v208
    v_fmac_f32 v228, v204, v188
    v_fma_f32 v209, -v93, v188, v209
    v_fmac_f32 v230, v205, v189
    v_fma_f32 v210, -v94, v189, v210
    v_add_f32 v95, v95, v95
    v_add_f32 v96, v96, v96
    v_add_f32 v97, v97, v97
    v_add_f32 v98, v98, v98
    v_add_f32 v99, v99, v99
    v_mul_f32 v222, v222, v95
    v_mul_f32 v206, v206, v95
    v_mul_f32 v224, v224, v96
    v_mul_f32 v207, v207, v96
    v_mul_f32 v226, v226, v97
    v_mul_f32 v208, v208, v97
    v_mul_f32 v228, v228, v98
    v_mul_f32 v209, v209, v98
    v_mul_f32 v230, v230, v99
    v_mul_f32 v210, v210, v99
L_k1_ntb:
    s_lshl_b32 s9, s6, 1
    s_add_u32 s9, s9, s4
    s_lshl_b32 s9, s9, 9
    s_add_u32 s9, s9, 0x1100000
    v_lshrrev_b32 v40, 2, v2
    v_lshlrev_b32 v40, 4, v40
    v_lshl_add_u32 v40, v3, 2, v40
    v_and_b32 v41, 3, v2
    v_add_u32 v40, v40, v41
    v_lshl_add_u32 v40, v40, 3, s9
    s_cmp_eq_u32 s8, 1
    s_cbranch_scc1 L_k1_eaB
    s_lshl_b32 s9, s4, 6
    s_add_u32 s9, s9, s83
    s_lshl_b32 s9, s9, 3
    s_add_u32 s9, s9, 0x1110000
    v_lshl_add_u32 v41, v1, 3, s9
    v_add_u32 v42, 12288, v41
    s_mov_b32 s73, 24576
    s_branch L_k1_ead
L_k1_eaB:
    s_lshl_b32 s9, s4, 5
    s_add_u32 s9, s9, s83
    s_lshl_b32 s9, s9, 3
    s_add_u32 s9, s9, 0x1110000
    v_lshrrev_b32 v41, 5, v1
    v_mul_u32_u24 v41, 1504, v41
    v_add_u32 v41, v41, v1
    v_lshl_add_u32 v41, v41, 3, s9
    s_mul_i32 s9, s7, 80
    s_mul_i32 s10, s4, 40
    s_add_u32 s9, s9, s10
    s_lshl_b32 s9, s9, 3
    s_add_u32 s9, s9, 0x1108000
    v_lshrrev_b32 v42, 3, v2
    v_mul_u32_u24 v42, 640, v42
    v_add_u32 v42, v42, v5
    v_lshl_add_u32 v42, v42, 3, s9
    s_mov_b32 s73, 64
L_k1_ead:
    s_lshl_b32 s9, s4, 2
    s_add_u32 s9, s9, 163736
    v_mov_b32 v138, s9
    v_mov_b32 v139, s82
    v_lshlrev_b32 v43, 4, v1
    s_mul_i32 s72, s4, 512
    s_add_u32 s72, s72, 0x1130000
    v_mul_u32_u24 v144, 8, v1
    s_mov_b32 s70, 0
    v_mov_b32 v132, 163732
L_k1_eg:
    ds_read_b32 v133, v132
    s_waitcnt lgkmcnt(0)
    v_readfirstlane_b32 s9, v133
    s_nop 0
    s_cmp_ge_i32 s9, 7
    s_cbranch_scc1 L_k1_eg_ok
    s_sleep 1
    s_branch L_k1_eg
L_k1_eg_ok:
    s_getpc_b64 s[70:71]
L_k1_pcb:
    s_sub_u32 s70, s70, L_k1_pcb-parallel_sum__ssm_conv_s5__geglu_ffn__prompt_kernel
    s_subb_u32 s71, s71, 0
    s_lshr_b32 s9, s2, 3
    s_lshl_b32 s9, s9, 1
    s_add_u32 s9, s9, s4
    s_mul_i32 s9, s9, 640
    v_min_u32 v14, 4, v1
    v_lshl_add_u32 v14, v14, 7, s9
    v_min_u32 v14, L_k1_tab-parallel_sum__ssm_conv_s5__geglu_ffn__prompt_kernel, v14
    global_load_dword v15, v14, s[70:71]
    s_mov_b32 s12, 0
L_k1_eil:
    buffer_load_dwordx2 v[16:17], v40, s[60:63], 0 offen sc1
    s_mov_b32 s9, 0
    s_mul_i32 s10, s73, 0
    buffer_load_dwordx2 v[18:19], v41, s[60:63], s9 offen sc1
    buffer_load_dwordx2 v[28:29], v42, s[60:63], s10 offen sc1
    s_mov_b32 s9, 24576
    s_mul_i32 s10, s73, 1
    buffer_load_dwordx2 v[20:21], v41, s[60:63], s9 offen sc1
    buffer_load_dwordx2 v[30:31], v42, s[60:63], s10 offen sc1
    s_mov_b32 s9, 49152
    s_mul_i32 s10, s73, 2
    buffer_load_dwordx2 v[22:23], v41, s[60:63], s9 offen sc1
    buffer_load_dwordx2 v[32:33], v42, s[60:63], s10 offen sc1
    s_mov_b32 s9, 73728
    s_mul_i32 s10, s73, 3
    buffer_load_dwordx2 v[24:25], v41, s[60:63], s9 offen sc1
    buffer_load_dwordx2 v[34:35], v42, s[60:63], s10 offen sc1
    s_mov_b32 s9, 98304
    s_mul_i32 s10, s73, 4
    buffer_load_dwordx2 v[26:27], v41, s[60:63], s9 offen sc1
    buffer_load_dwordx2 v[36:37], v42, s[60:63], s10 offen sc1
    s_waitcnt vmcnt(0)
    v_xor_b32 v132, s82, v17
    v_xor_b32 v133, s82, v19
    v_or_b32 v132, v132, v133
    v_xor_b32 v133, s82, v21
    v_or_b32 v132, v132, v133
    v_xor_b32 v133, s82, v23
    v_or_b32 v132, v132, v133
    v_xor_b32 v133, s82, v25
    v_or_b32 v132, v132, v133
    v_xor_b32 v133, s82, v27
    v_or_b32 v132, v132, v133
    v_xor_b32 v133, s82, v29
    v_or_b32 v132, v132, v133
    v_xor_b32 v133, s82, v31
    v_or_b32 v132, v132, v133
    v_xor_b32 v133, s82, v33
    v_or_b32 v132, v132, v133
    v_xor_b32 v133, s82, v35
    v_or_b32 v132, v132, v133
    v_xor_b32 v133, s82, v37
    v_or_b32 v132, v132, v133
    v_cmp_ne_u32 vcc, 0, v132
    s_add_u32 s12, s12, 1
    s_cbranch_vccz L_k1_eid
    s_sleep 16
    s_cmp_lt_u32 s12, 0x40000
    s_cbranch_scc1 L_k1_eil
L_k1_eid:
    v_lshlrev_b32 v148, 16, v16
    v_and_b32 v149, s13, v16
    v_rcp_f32 v150, v149
    s_mul_i32 s9, s4, 768
    s_add_u32 s9, s9, 159744
    v_lshl_add_u32 v151, v1, 2, s9
    v_add_f32 v18, v18, v20
    v_add_f32 v22, v22, v24
    v_add_f32 v18, v18, v26
    v_add_f32 v18, v18, v22
    s_lshl_b32 s9, s4, 9
    s_add_u32 s9, s9, 161280
    v_lshl_add_u32 v152, v1, 2, s9
    v_mov_b32 v223, v28
    v_mov_b32 v225, v30
    v_mov_b32 v227, v32
    v_mov_b32 v229, v34
    v_mov_b32 v221, v36
    v_add_f32 v28, v28, v30
    v_add_f32 v32, v32, v34
    v_add_f32 v28, v28, v36
    v_add_f32 v28, v28, v32
    s_mul_i32 s9, s4, 23040
    s_add_u32 s9, s9, 53248
    v_add_u32 v43, s9, v43
    s_mul_i32 s9, s4, 3072
    s_add_u32 s9, s9, 99328
    v_lshl_add_u32 v153, v2, 4, s9
    s_getpc_b64 s[68:69]
L_k1_tbD:
    s_add_u32 s68, s68, L_k1_tab-L_k1_tbD
    s_addc_u32 s69, s69, 0
    v_mov_b32 v132, 163748
L_k1_pg:
    ds_read_b32 v133, v132
    s_waitcnt lgkmcnt(0)
    v_readfirstlane_b32 s9, v133
    s_nop 0
    s_cmp_ge_i32 s9, 10
    s_cbranch_scc1 L_k1_pg_ok
    s_sleep 1
    s_branch L_k1_pg
L_k1_pg_ok:
    buffer_load_dwordx2 v[44:45], v144, s[60:63], s72 offen sc1
    ds_write_b32 v151, v148
    ds_write_b32 v151, v150 offset:256
    ds_write_b32 v151, v149 offset:512
    ds_write_b32 v152, v18
    s_cmp_eq_u32 s8, 1
    s_cbranch_scc1 L_k1_ewB
    ds_write_b32 v152, v28 offset:256
    s_branch L_k1_ewd
L_k1_ewB:
    v_mov_b32 v134, 162304
L_k1_tbw:
    ds_read2st64_b32 v[140:141], v134 offset0:0 offset1:1
    ds_read2st64_b32 v[142:143], v134 offset0:2 offset1:3
    s_waitcnt lgkmcnt(0)
    v_min_u32 v140, v140, v141
    v_min3_u32 v140, v140, v142, v143
    s_nop 0
    v_readfirstlane_b32 s9, v140
    s_nop 0
    s_cmp_ge_i32 s9, 16
    s_cbranch_scc1 L_k1_tbw_ok
    s_sleep 1
    s_branch L_k1_tbw
L_k1_tbw_ok:
    ds_write_b128 v153, v[196:199] offset:0
    ds_write_b128 v153, v[200:203] offset:256
    ds_write_b128 v153, v[204:207] offset:512
    ds_write_b128 v153, v[208:211] offset:768
    ds_write_b128 v153, v[212:215] offset:1024
    ds_write_b128 v153, v[216:219] offset:1280
    ds_write_b128 v153, v[220:223] offset:1536
    ds_write_b128 v153, v[224:227] offset:1792
    ds_write_b128 v153, v[228:231] offset:2048
    ds_write_b128 v153, v[232:235] offset:2304
    ds_write_b128 v153, v[236:239] offset:2560
    ds_write_b128 v153, v[240:243] offset:2816
    ds_write_b128 v43, v[48:51] offset:0
    ds_write_b128 v43, v[52:55] offset:1024
    ds_write_b128 v43, v[56:59] offset:2048
    ds_write_b128 v43, v[60:63] offset:3072
    ds_write_b128 v43, v[64:67] offset:4096
    ds_write_b128 v43, v[48:51] offset:11520
    ds_write_b128 v43, v[52:55] offset:12544
    ds_write_b128 v43, v[56:59] offset:13568
    ds_write_b128 v43, v[60:63] offset:14592
    ds_write_b128 v43, v[64:67] offset:15616
L_k1_ewd:
    ds_write_b32 v138, v139
    s_mov_b32 s12, 0
    s_branch L_k1_pfc
L_k1_pfl:
    s_sleep 12
    buffer_load_dwordx2 v[44:45], v144, s[60:63], s72 offen sc1
L_k1_pfc:
    s_waitcnt vmcnt(0)
    v_xor_b32 v132, s82, v44
    v_xor_b32 v133, s82, v45
    v_or_b32 v132, v132, v133
    v_cmp_ne_u32 vcc, 0, v132
    s_add_u32 s12, s12, 1
    s_cbranch_vccz L_k1_pfo
    s_cmp_lt_u32 s12, 0x40000
    s_cbranch_scc1 L_k1_pfl
L_k1_pfo:
    ds_write_b32 v138, v139 offset:16
L_k1_P2:
    s_sub_u32 s4, s3, 4
    s_and_b32 s9, s2, 7
    s_lshr_b32 s10, s2, 3
    s_lshr_b32 s5, s9, 1
    s_lshl_b32 s5, s5, 3
    s_and_b32 s11, s10, 7
    s_add_u32 s5, s5, s11
    s_and_b32 s6, s9, 1
    s_lshl_b32 s6, s6, 2
    s_lshr_b32 s11, s10, 3
    s_add_u32 s6, s6, s11
    v_bfe_u32 v44, v2, 1, 2
    v_xor_b32 v44, v44, v3
    v_mul_u32_u24 v8, 320, v2
    v_lshl_add_u32 v8, v44, 4, v8
    v_lshlrev_b32 v6, 4, v1
    v_add_u32 v7, 4096, v6
    s_xor_b32 s9, s4, 0
    s_lshl_b32 s9, s9, 10
    v_add_u32 v2, s9, v6
    s_xor_b32 s9, s4, 1
    s_lshl_b32 s9, s9, 10
    v_add_u32 v3, s9, v6
    s_xor_b32 s9, s4, 2
    s_lshl_b32 s9, s9, 10
    v_add_u32 v4, s9, v6
    s_xor_b32 s9, s4, 3
    s_lshl_b32 s9, s9, 10
    v_add_u32 v5, s9, v6
    s_mul_i32 s75, s5, 360448
    s_mul_i32 s76, s6, 450560
    s_add_u32 s76, s76, 0xc00000
    s_mul_i32 s72, s4, 8
    s_add_u32 s72, s72, 0
    s_mul_i32 s73, s4, 4
    s_add_u32 s73, s73, 32
    s_mul_i32 s74, s4, 10
    s_add_u32 s74, s74, 48
    s_and_b32 s78, s4, 1
    s_mul_i32 s78, s78, 25600
    s_cmp_lt_u32 s4, 2
    s_cselect_b32 s9, 106496, 0
    s_add_u32 s78, s78, s9
    v_add_u32 v9, s78, v6
    v_add_u32 v8, s78, v8
    s_lshl_b32 s79, s5, 2
    s_add_u32 s79, s79, s4
    s_mul_i32 s79, s79, 4224
    s_add_u32 s79, s79, 0x1160000
    s_lshl_b32 s9, s4, 2
    s_add_u32 s9, s9, 163776
    v_mov_b32 v11, s9
    v_mov_b32 v38, 163744
    s_lshr_b32 s10, s2, 3
    s_and_b32 s9, s10, 7
    s_lshr_b32 s10, s10, 3
    s_mov_b32 s11, 0
    s_mov_b32 s12, 0
    s_add_u32 s9, s11, 0
    s_and_b32 s9, s9, 3
    s_add_u32 s24, s9, s73
    s_lshl_b32 s9, s9, 1
    s_add_u32 s16, s9, s72
    s_add_u32 s20, s16, 1
    s_add_u32 s9, s11, 1
    s_and_b32 s9, s9, 3
    s_add_u32 s25, s9, s73
    s_lshl_b32 s9, s9, 1
    s_add_u32 s17, s9, s72
    s_add_u32 s21, s17, 1
    s_add_u32 s9, s11, 2
    s_and_b32 s9, s9, 3
    s_add_u32 s26, s9, s73
    s_lshl_b32 s9, s9, 1
    s_add_u32 s18, s9, s72
    s_add_u32 s22, s18, 1
    s_add_u32 s9, s11, 3
    s_and_b32 s9, s9, 3
    s_add_u32 s27, s9, s73
    s_lshl_b32 s9, s9, 1
    s_add_u32 s19, s9, s72
    s_add_u32 s23, s19, 1
    s_add_u32 s9, s12, 0
    s_cmp_ge_u32 s9, 10
    s_cselect_b32 s10, 10, 0
    s_sub_u32 s9, s9, s10
    s_add_u32 s28, s9, s74
    s_add_u32 s9, s12, 1
    s_cmp_ge_u32 s9, 10
    s_cselect_b32 s10, 10, 0
    s_sub_u32 s9, s9, s10
    s_add_u32 s29, s9, s74
    s_add_u32 s9, s12, 2
    s_cmp_ge_u32 s9, 10
    s_cselect_b32 s10, 10, 0
    s_sub_u32 s9, s9, s10
    s_add_u32 s30, s9, s74
    s_add_u32 s9, s12, 3
    s_cmp_ge_u32 s9, 10
    s_cselect_b32 s10, 10, 0
    s_sub_u32 s9, s9, s10
    s_add_u32 s31, s9, s74
    s_add_u32 s9, s12, 4
    s_cmp_ge_u32 s9, 10
    s_cselect_b32 s10, 10, 0
    s_sub_u32 s9, s9, s10
    s_add_u32 s34, s9, s74
    s_add_u32 s9, s12, 5
    s_cmp_ge_u32 s9, 10
    s_cselect_b32 s10, 10, 0
    s_sub_u32 s9, s9, s10
    s_add_u32 s35, s9, s74
    s_add_u32 s9, s12, 6
    s_cmp_ge_u32 s9, 10
    s_cselect_b32 s10, 10, 0
    s_sub_u32 s9, s9, s10
    s_add_u32 s36, s9, s74
    s_add_u32 s9, s12, 7
    s_cmp_ge_u32 s9, 10
    s_cselect_b32 s10, 10, 0
    s_sub_u32 s9, s9, s10
    s_add_u32 s37, s9, s74
    s_add_u32 s9, s12, 8
    s_cmp_ge_u32 s9, 10
    s_cselect_b32 s10, 10, 0
    s_sub_u32 s9, s9, s10
    s_add_u32 s38, s9, s74
    s_add_u32 s9, s12, 9
    s_cmp_ge_u32 s9, 10
    s_cselect_b32 s10, 10, 0
    s_sub_u32 s9, s9, s10
    s_add_u32 s39, s9, s74
L_k1_p2e:
    ds_read_b64 v[40:41], v38 offset:8
    s_waitcnt lgkmcnt(0)
    v_min_u32 v40, v40, v41
    s_nop 0
    v_readfirstlane_b32 s9, v40
    s_nop 0
    s_cmp_lg_u32 s9, 0
    s_cbranch_scc1 L_k1_p2eo
    s_sleep 1
    s_branch L_k1_p2e
L_k1_p2eo:
    s_mul_i32 s10, s16, 5120
    s_add_u32 s10, s10, s76
    buffer_load_dwordx4 v[76:79], v6, s[60:63], s10 offen offset:0 sc1
    buffer_load_dwordx4 v[80:83], v6, s[60:63], s10 offen offset:1024 sc1
    buffer_load_dwordx4 v[84:87], v6, s[60:63], s10 offen offset:2048 sc1
    buffer_load_dwordx4 v[88:91], v6, s[60:63], s10 offen offset:3072 sc1
    buffer_load_dwordx4 v[92:95], v7, s[60:63], s10 offen offset:0 sc1
    s_mul_i32 s10, s17, 5120
    s_add_u32 s10, s10, s76
    buffer_load_dwordx4 v[96:99], v6, s[60:63], s10 offen offset:0 sc1
    buffer_load_dwordx4 v[100:103], v6, s[60:63], s10 offen offset:1024 sc1
    buffer_load_dwordx4 v[104:107], v6, s[60:63], s10 offen offset:2048 sc1
    buffer_load_dwordx4 v[108:111], v6, s[60:63], s10 offen offset:3072 sc1
    buffer_load_dwordx4 v[112:115], v7, s[60:63], s10 offen offset:0 sc1
    s_mul_i32 s10, s18, 5120
    s_add_u32 s10, s10, s76
    buffer_load_dwordx4 v[116:119], v6, s[60:63], s10 offen offset:0 sc1
    buffer_load_dwordx4 v[120:123], v6, s[60:63], s10 offen offset:1024 sc1
    buffer_load_dwordx4 v[124:127], v6, s[60:63], s10 offen offset:2048 sc1
    buffer_load_dwordx4 v[128:131], v6, s[60:63], s10 offen offset:3072 sc1
    buffer_load_dwordx4 v[132:135], v7, s[60:63], s10 offen offset:0 sc1
    s_mul_i32 s10, s19, 5120
    s_add_u32 s10, s10, s76
    buffer_load_dwordx4 v[136:139], v6, s[60:63], s10 offen offset:0 sc1
    buffer_load_dwordx4 v[140:143], v6, s[60:63], s10 offen offset:1024 sc1
    buffer_load_dwordx4 v[144:147], v6, s[60:63], s10 offen offset:2048 sc1
    buffer_load_dwordx4 v[148:151], v6, s[60:63], s10 offen offset:3072 sc1
    buffer_load_dwordx4 v[152:155], v7, s[60:63], s10 offen offset:0 sc1
    s_mul_i32 s10, s20, 5120
    s_add_u32 s10, s10, s76
    buffer_load_dwordx4 v[156:159], v6, s[60:63], s10 offen offset:0 sc1
    buffer_load_dwordx4 v[160:163], v6, s[60:63], s10 offen offset:1024 sc1
    buffer_load_dwordx4 v[164:167], v6, s[60:63], s10 offen offset:2048 sc1
    buffer_load_dwordx4 v[168:171], v6, s[60:63], s10 offen offset:3072 sc1
    buffer_load_dwordx4 v[172:175], v7, s[60:63], s10 offen offset:0 sc1
    s_mov_b32 s48, s42
    s_mov_b32 s49, s43
    s_mov_b32 s50, 5242880
    s_mov_b32 s51, 0x20000
    v_mov_b32 v20, 162304
    s_and_b32 s10, s4, 2
    s_add_u32 s10, s10, 18
    v_mov_b32 v21, 163736
L_k1_p2n:
    ds_read_b64 v[24:25], v21
    s_waitcnt lgkmcnt(0)
    v_min_u32 v24, v24, v25
    s_nop 0
    v_readfirstlane_b32 s82, v24
    s_nop 0
    s_cmp_lg_u32 s82, 0
    s_cbranch_scc1 L_k1_p2no
    s_sleep 1
    s_branch L_k1_p2n
L_k1_p2no:
L_k1_p2w:
    ds_read2st64_b32 v[24:25], v20 offset0:0 offset1:1
    ds_read2st64_b32 v[26:27], v20 offset0:2 offset1:3
    s_waitcnt lgkmcnt(0)
    v_min_u32 v24, v24, v25
    v_min3_u32 v24, v24, v26, v27
    s_nop 0
    v_readfirstlane_b32 s9, v24
    s_nop 0
    s_cmp_ge_i32 s9, s10
    s_cbranch_scc1 L_k1_p2w_ok
    s_sleep 1
    s_branch L_k1_p2w
L_k1_p2w_ok:
    s_add_u32 m0, s78, 0
    s_mul_i32 s10, s25, 5120
    s_add_u32 s10, s10, s76
    buffer_load_dwordx4 v6, s[60:63], s10 offen offset:0 sc1 lds
    buffer_load_dwordx4 v6, s[60:63], s10 offen offset:1024 sc1 lds
    buffer_load_dwordx4 v6, s[60:63], s10 offen offset:2048 sc1 lds
    buffer_load_dwordx4 v6, s[60:63], s10 offen offset:3072 sc1 lds
    s_add_u32 m0, s78, 4096
    s_nop 0
    buffer_load_dwordx4 v7, s[60:63], s10 offen sc1 lds
    s_add_u32 m0, s78, 5120
    s_mul_i32 s10, s28, 5120
    s_add_u32 s10, s10, s76
    buffer_load_dwordx4 v6, s[60:63], s10 offen offset:0 sc1 lds
    buffer_load_dwordx4 v6, s[60:63], s10 offen offset:1024 sc1 lds
    buffer_load_dwordx4 v6, s[60:63], s10 offen offset:2048 sc1 lds
    buffer_load_dwordx4 v6, s[60:63], s10 offen offset:3072 sc1 lds
    s_add_u32 m0, s78, 9216
    s_nop 0
    buffer_load_dwordx4 v7, s[60:63], s10 offen sc1 lds
    s_add_u32 m0, s78, 10240
    s_mul_i32 s10, s31, 5120
    s_add_u32 s10, s10, s76
    buffer_load_dwordx4 v6, s[60:63], s10 offen offset:0 sc1 lds
    buffer_load_dwordx4 v6, s[60:63], s10 offen offset:1024 sc1 lds
    buffer_load_dwordx4 v6, s[60:63], s10 offen offset:2048 sc1 lds
    buffer_load_dwordx4 v6, s[60:63], s10 offen offset:3072 sc1 lds
    s_add_u32 m0, s78, 14336
    s_nop 0
    buffer_load_dwordx4 v7, s[60:63], s10 offen sc1 lds
    s_add_u32 m0, s78, 15360
    s_mul_i32 s10, s36, 5120
    s_add_u32 s10, s10, s76
    buffer_load_dwordx4 v6, s[60:63], s10 offen offset:0 sc1 lds
    buffer_load_dwordx4 v6, s[60:63], s10 offen offset:1024 sc1 lds
    buffer_load_dwordx4 v6, s[60:63], s10 offen offset:2048 sc1 lds
    buffer_load_dwordx4 v6, s[60:63], s10 offen offset:3072 sc1 lds
    s_add_u32 m0, s78, 19456
    s_nop 0
    buffer_load_dwordx4 v7, s[60:63], s10 offen sc1 lds
    s_add_u32 m0, s78, 20480
    s_mul_i32 s10, s39, 5120
    s_add_u32 s10, s10, s76
    buffer_load_dwordx4 v6, s[60:63], s10 offen offset:0 sc1 lds
    buffer_load_dwordx4 v6, s[60:63], s10 offen offset:1024 sc1 lds
    buffer_load_dwordx4 v6, s[60:63], s10 offen offset:2048 sc1 lds
    buffer_load_dwordx4 v6, s[60:63], s10 offen offset:3072 sc1 lds
    s_add_u32 m0, s78, 24576
    s_nop 0
    buffer_load_dwordx4 v7, s[60:63], s10 offen sc1 lds
    s_add_u32 s40, s46, s79
    s_addc_u32 s41, s47, 0
    s_load_dwordx4 s[52:55], s[40:41], 0 glc
    s_mov_b32 s12, 0
    s_branch L_k1_fc0_c
L_k1_fc0_r:
    s_sleep 6
    s_load_dwordx4 s[52:55], s[40:41], 0 glc
L_k1_fc0_c:
    s_waitcnt lgkmcnt(0)
    s_xor_b32 s52, s52, s82
    s_xor_b32 s53, s53, s82
    s_xor_b32 s54, s54, s82
    s_xor_b32 s55, s55, s82
    s_add_u32 s12, s12, 1
    s_or_b64 s[52:53], s[52:53], s[54:55]
    s_cbranch_scc0 L_k1_fc0_d
    s_cmp_lt_u32 s12, 0x100000
    s_cbranch_scc1 L_k1_fc0_r
L_k1_fc0_d:
    s_lshl_b32 s9, s16, 12
    s_add_u32 s9, s9, s75
    buffer_load_dwordx4 v[12:15], v2, s[60:63], s9 offen sc1
    buffer_load_dwordx4 v[16:19], v3, s[60:63], s9 offen sc1
    buffer_load_dwordx4 v[20:23], v4, s[60:63], s9 offen sc1
    buffer_load_dwordx4 v[24:27], v5, s[60:63], s9 offen sc1
    s_lshl_b32 s9, s17, 12
    s_add_u32 s9, s9, s75
    buffer_load_dwordx4 v[28:31], v2, s[60:63], s9 offen sc1
    buffer_load_dwordx4 v[32:35], v3, s[60:63], s9 offen sc1
    buffer_load_dwordx4 v[36:39], v4, s[60:63], s9 offen sc1
    buffer_load_dwordx4 v[40:43], v5, s[60:63], s9 offen sc1
    s_lshl_b32 s9, s18, 12
    s_add_u32 s9, s9, s75
    buffer_load_dwordx4 v[44:47], v2, s[60:63], s9 offen sc1
    buffer_load_dwordx4 v[48:51], v3, s[60:63], s9 offen sc1
    buffer_load_dwordx4 v[52:55], v4, s[60:63], s9 offen sc1
    buffer_load_dwordx4 v[56:59], v5, s[60:63], s9 offen sc1
    s_lshl_b32 s9, s19, 12
    s_add_u32 s9, s9, s75
    buffer_load_dwordx4 v[60:63], v2, s[60:63], s9 offen sc1
    buffer_load_dwordx4 v[64:67], v3, s[60:63], s9 offen sc1
    buffer_load_dwordx4 v[68:71], v4, s[60:63], s9 offen sc1
    buffer_load_dwordx4 v[72:75], v5, s[60:63], s9 offen sc1
L_k1_cs0_r:
    ds_read_b32 v10, v11
    s_waitcnt lgkmcnt(0)
    v_readfirstlane_b32 s11, v10
    s_nop 0
    s_cmp_eq_u32 s11, 0
    s_cbranch_scc1 L_k1_cs0_r
    s_waitcnt vmcnt(12)
    v_mfma_f32_16x16x32_bf16 v[176:179], v[76:79], v[12:15], 0
    v_mfma_f32_16x16x32_bf16 v[180:183], v[80:83], v[12:15], 0
    v_mfma_f32_16x16x32_bf16 v[184:187], v[84:87], v[12:15], 0
    v_mfma_f32_16x16x32_bf16 v[188:191], v[88:91], v[12:15], 0
    v_mfma_f32_16x16x32_bf16 v[192:195], v[92:95], v[12:15], 0
    v_mfma_f32_16x16x32_bf16 v[196:199], v[76:79], v[16:19], 0
    v_mfma_f32_16x16x32_bf16 v[200:203], v[80:83], v[16:19], 0
    v_mfma_f32_16x16x32_bf16 v[204:207], v[84:87], v[16:19], 0
    v_mfma_f32_16x16x32_bf16 v[208:211], v[88:91], v[16:19], 0
    v_mfma_f32_16x16x32_bf16 v[212:215], v[92:95], v[16:19], 0
    v_mfma_f32_16x16x32_bf16 v[216:219], v[76:79], v[20:23], 0
    v_mfma_f32_16x16x32_bf16 v[220:223], v[80:83], v[20:23], 0
    v_mfma_f32_16x16x32_bf16 v[224:227], v[84:87], v[20:23], 0
    v_mfma_f32_16x16x32_bf16 v[228:231], v[88:91], v[20:23], 0
    v_mfma_f32_16x16x32_bf16 v[232:235], v[92:95], v[20:23], 0
    v_mfma_f32_16x16x32_bf16 v[236:239], v[76:79], v[24:27], 0
    v_mfma_f32_16x16x32_bf16 v[240:243], v[80:83], v[24:27], 0
    v_mfma_f32_16x16x32_bf16 v[244:247], v[84:87], v[24:27], 0
    v_mfma_f32_16x16x32_bf16 v[248:251], v[88:91], v[24:27], 0
    v_mfma_f32_16x16x32_bf16 v[252:255], v[92:95], v[24:27], 0
    s_waitcnt vmcnt(8)
    v_mfma_f32_16x16x32_bf16 v[176:179], v[96:99], v[28:31], v[176:179]
    s_mul_i32 s10, s21, 5120
    s_add_u32 s10, s10, s76
    v_mfma_f32_16x16x32_bf16 v[180:183], v[100:103], v[28:31], v[180:183]
    buffer_load_dwordx4 v[76:79], v6, s[60:63], s10 offen offset:0 sc1
    v_mfma_f32_16x16x32_bf16 v[184:187], v[104:107], v[28:31], v[184:187]
    buffer_load_dwordx4 v[80:83], v6, s[60:63], s10 offen offset:1024 sc1
    v_mfma_f32_16x16x32_bf16 v[188:191], v[108:111], v[28:31], v[188:191]
    buffer_load_dwordx4 v[84:87], v6, s[60:63], s10 offen offset:2048 sc1
    v_mfma_f32_16x16x32_bf16 v[192:195], v[112:115], v[28:31], v[192:195]
    buffer_load_dwordx4 v[88:91], v6, s[60:63], s10 offen offset:3072 sc1
    v_mfma_f32_16x16x32_bf16 v[196:199], v[96:99], v[32:35], v[196:199]
    buffer_load_dwordx4 v[92:95], v7, s[60:63], s10 offen offset:0 sc1
    v_mfma_f32_16x16x32_bf16 v[200:203], v[100:103], v[32:35], v[200:203]
    v_mfma_f32_16x16x32_bf16 v[204:207], v[104:107], v[32:35], v[204:207]
    v_mfma_f32_16x16x32_bf16 v[208:211], v[108:111], v[32:35], v[208:211]
    v_mfma_f32_16x16x32_bf16 v[212:215], v[112:115], v[32:35], v[212:215]
    v_mfma_f32_16x16x32_bf16 v[216:219], v[96:99], v[36:39], v[216:219]
    v_mfma_f32_16x16x32_bf16 v[220:223], v[100:103], v[36:39], v[220:223]
    v_mfma_f32_16x16x32_bf16 v[224:227], v[104:107], v[36:39], v[224:227]
    v_mfma_f32_16x16x32_bf16 v[228:231], v[108:111], v[36:39], v[228:231]
    v_mfma_f32_16x16x32_bf16 v[232:235], v[112:115], v[36:39], v[232:235]
    v_mfma_f32_16x16x32_bf16 v[236:239], v[96:99], v[40:43], v[236:239]
    v_mfma_f32_16x16x32_bf16 v[240:243], v[100:103], v[40:43], v[240:243]
    v_mfma_f32_16x16x32_bf16 v[244:247], v[104:107], v[40:43], v[244:247]
    v_mfma_f32_16x16x32_bf16 v[248:251], v[108:111], v[40:43], v[248:251]
    v_mfma_f32_16x16x32_bf16 v[252:255], v[112:115], v[40:43], v[252:255]
    s_waitcnt vmcnt(9)
    v_mfma_f32_16x16x32_bf16 v[176:179], v[116:119], v[44:47], v[176:179]
    s_load_dwordx4 s[52:55], s[40:41], 48 glc
    v_mfma_f32_16x16x32_bf16 v[180:183], v[120:123], v[44:47], v[180:183]
    s_mul_i32 s10, s22, 5120
    s_add_u32 s10, s10, s76
    v_mfma_f32_16x16x32_bf16 v[184:187], v[124:127], v[44:47], v[184:187]
    buffer_load_dwordx4 v[96:99], v6, s[60:63], s10 offen offset:0 sc1
    v_mfma_f32_16x16x32_bf16 v[188:191], v[128:131], v[44:47], v[188:191]
    buffer_load_dwordx4 v[100:103], v6, s[60:63], s10 offen offset:1024 sc1
    v_mfma_f32_16x16x32_bf16 v[192:195], v[132:135], v[44:47], v[192:195]
    buffer_load_dwordx4 v[104:107], v6, s[60:63], s10 offen offset:2048 sc1
    v_mfma_f32_16x16x32_bf16 v[196:199], v[116:119], v[48:51], v[196:199]
    buffer_load_dwordx4 v[108:111], v6, s[60:63], s10 offen offset:3072 sc1
    v_mfma_f32_16x16x32_bf16 v[200:203], v[120:123], v[48:51], v[200:203]
    buffer_load_dwordx4 v[112:115], v7, s[60:63], s10 offen offset:0 sc1
    v_mfma_f32_16x16x32_bf16 v[204:207], v[124:127], v[48:51], v[204:207]
    v_mfma_f32_16x16x32_bf16 v[208:211], v[128:131], v[48:51], v[208:211]
    v_mfma_f32_16x16x32_bf16 v[212:215], v[132:135], v[48:51], v[212:215]
    v_mfma_f32_16x16x32_bf16 v[216:219], v[116:119], v[52:55], v[216:219]
    v_mfma_f32_16x16x32_bf16 v[220:223], v[120:123], v[52:55], v[220:223]
    v_mfma_f32_16x16x32_bf16 v[224:227], v[124:127], v[52:55], v[224:227]
    v_mfma_f32_16x16x32_bf16 v[228:231], v[128:131], v[52:55], v[228:231]
    v_mfma_f32_16x16x32_bf16 v[232:235], v[132:135], v[52:55], v[232:235]
    v_mfma_f32_16x16x32_bf16 v[236:239], v[116:119], v[56:59], v[236:239]
    v_mfma_f32_16x16x32_bf16 v[240:243], v[120:123], v[56:59], v[240:243]
    v_mfma_f32_16x16x32_bf16 v[244:247], v[124:127], v[56:59], v[244:247]
    v_mfma_f32_16x16x32_bf16 v[248:251], v[128:131], v[56:59], v[248:251]
    v_mfma_f32_16x16x32_bf16 v[252:255], v[132:135], v[56:59], v[252:255]
    s_mov_b32 s12, 0
    s_branch L_k1_fc3_c
L_k1_fc3_r:
    s_sleep 6
    s_load_dwordx4 s[52:55], s[40:41], 48 glc
L_k1_fc3_c:
    s_waitcnt lgkmcnt(0)
    s_xor_b32 s52, s52, s82
    s_xor_b32 s53, s53, s82
    s_xor_b32 s54, s54, s82
    s_xor_b32 s55, s55, s82
    s_add_u32 s12, s12, 1
    s_or_b64 s[52:53], s[52:53], s[54:55]
    s_cbranch_scc0 L_k1_fc3_d
    s_cmp_lt_u32 s12, 0x100000
    s_cbranch_scc1 L_k1_fc3_r
L_k1_fc3_d:
    s_waitcnt vmcnt(10)
    v_mfma_f32_16x16x32_bf16 v[176:179], v[136:139], v[60:63], v[176:179]
    s_lshl_b32 s9, s20, 12
    s_add_u32 s9, s9, s75
    v_mfma_f32_16x16x32_bf16 v[180:183], v[140:143], v[60:63], v[180:183]
    buffer_load_dwordx4 v[12:15], v2, s[60:63], s9 offen sc1
    v_mfma_f32_16x16x32_bf16 v[184:187], v[144:147], v[60:63], v[184:187]
    buffer_load_dwordx4 v[16:19], v3, s[60:63], s9 offen sc1
    v_mfma_f32_16x16x32_bf16 v[188:191], v[148:151], v[60:63], v[188:191]
    buffer_load_dwordx4 v[20:23], v4, s[60:63], s9 offen sc1
    v_mfma_f32_16x16x32_bf16 v[192:195], v[152:155], v[60:63], v[192:195]
    buffer_load_dwordx4 v[24:27], v5, s[60:63], s9 offen sc1
    v_mfma_f32_16x16x32_bf16 v[196:199], v[136:139], v[64:67], v[196:199]
    s_lshl_b32 s9, s21, 12
    s_add_u32 s9, s9, s75
    v_mfma_f32_16x16x32_bf16 v[200:203], v[140:143], v[64:67], v[200:203]
    buffer_load_dwordx4 v[28:31], v2, s[60:63], s9 offen sc1
    v_mfma_f32_16x16x32_bf16 v[204:207], v[144:147], v[64:67], v[204:207]
    buffer_load_dwordx4 v[32:35], v3, s[60:63], s9 offen sc1
    v_mfma_f32_16x16x32_bf16 v[208:211], v[148:151], v[64:67], v[208:211]
    buffer_load_dwordx4 v[36:39], v4, s[60:63], s9 offen sc1
    v_mfma_f32_16x16x32_bf16 v[212:215], v[152:155], v[64:67], v[212:215]
    buffer_load_dwordx4 v[40:43], v5, s[60:63], s9 offen sc1
    v_mfma_f32_16x16x32_bf16 v[216:219], v[136:139], v[68:71], v[216:219]
    s_lshl_b32 s9, s22, 12
    s_add_u32 s9, s9, s75
    v_mfma_f32_16x16x32_bf16 v[220:223], v[140:143], v[68:71], v[220:223]
    buffer_load_dwordx4 v[44:47], v2, s[60:63], s9 offen sc1
    v_mfma_f32_16x16x32_bf16 v[224:227], v[144:147], v[68:71], v[224:227]
    buffer_load_dwordx4 v[48:51], v3, s[60:63], s9 offen sc1
    v_mfma_f32_16x16x32_bf16 v[228:231], v[148:151], v[68:71], v[228:231]
    buffer_load_dwordx4 v[52:55], v4, s[60:63], s9 offen sc1
    v_mfma_f32_16x16x32_bf16 v[232:235], v[152:155], v[68:71], v[232:235]
    buffer_load_dwordx4 v[56:59], v5, s[60:63], s9 offen sc1
    v_mfma_f32_16x16x32_bf16 v[236:239], v[136:139], v[72:75], v[236:239]
    s_mul_i32 s10, s23, 5120
    s_add_u32 s10, s10, s76
    v_mfma_f32_16x16x32_bf16 v[240:243], v[140:143], v[72:75], v[240:243]
    buffer_load_dwordx4 v[116:119], v6, s[60:63], s10 offen offset:0 sc1
    v_mfma_f32_16x16x32_bf16 v[244:247], v[144:147], v[72:75], v[244:247]
    buffer_load_dwordx4 v[120:123], v6, s[60:63], s10 offen offset:1024 sc1
    v_mfma_f32_16x16x32_bf16 v[248:251], v[148:151], v[72:75], v[248:251]
    buffer_load_dwordx4 v[124:127], v6, s[60:63], s10 offen offset:2048 sc1
    v_mfma_f32_16x16x32_bf16 v[252:255], v[152:155], v[72:75], v[252:255]
    buffer_load_dwordx4 v[128:131], v6, s[60:63], s10 offen offset:3072 sc1
    buffer_load_dwordx4 v[132:135], v7, s[60:63], s10 offen offset:0 sc1
    s_waitcnt vmcnt(13)
    v_mfma_f32_16x16x32_bf16 v[176:179], v[156:159], v[12:15], v[176:179]
    s_lshl_b32 s9, s23, 12
    s_add_u32 s9, s9, s75
    v_mfma_f32_16x16x32_bf16 v[180:183], v[160:163], v[12:15], v[180:183]
    buffer_load_dwordx4 v[60:63], v2, s[60:63], s9 offen sc1
    v_mfma_f32_16x16x32_bf16 v[184:187], v[164:167], v[12:15], v[184:187]
    buffer_load_dwordx4 v[64:67], v3, s[60:63], s9 offen sc1
    v_mfma_f32_16x16x32_bf16 v[188:191], v[168:171], v[12:15], v[188:191]
    buffer_load_dwordx4 v[68:71], v4, s[60:63], s9 offen sc1
    v_mfma_f32_16x16x32_bf16 v[192:195], v[172:175], v[12:15], v[192:195]
    buffer_load_dwordx4 v[72:75], v5, s[60:63], s9 offen sc1
    v_mfma_f32_16x16x32_bf16 v[196:199], v[156:159], v[16:19], v[196:199]
    s_mul_i32 s10, s24, 5120
    s_add_u32 s10, s10, s76
    v_mfma_f32_16x16x32_bf16 v[200:203], v[160:163], v[16:19], v[200:203]
    buffer_load_dwordx4 v[136:139], v6, s[60:63], s10 offen offset:0 sc1
    v_mfma_f32_16x16x32_bf16 v[204:207], v[164:167], v[16:19], v[204:207]
    buffer_load_dwordx4 v[140:143], v6, s[60:63], s10 offen offset:1024 sc1
    v_mfma_f32_16x16x32_bf16 v[208:211], v[168:171], v[16:19], v[208:211]
    buffer_load_dwordx4 v[144:147], v6, s[60:63], s10 offen offset:2048 sc1
    v_mfma_f32_16x16x32_bf16 v[212:215], v[172:175], v[16:19], v[212:215]
    buffer_load_dwordx4 v[148:151], v6, s[60:63], s10 offen offset:3072 sc1
    v_mfma_f32_16x16x32_bf16 v[216:219], v[156:159], v[20:23], v[216:219]
    buffer_load_dwordx4 v[152:155], v7, s[60:63], s10 offen offset:0 sc1
    v_mfma_f32_16x16x32_bf16 v[220:223], v[160:163], v[20:23], v[220:223]
    v_mfma_f32_16x16x32_bf16 v[224:227], v[164:167], v[20:23], v[224:227]
    v_mfma_f32_16x16x32_bf16 v[228:231], v[168:171], v[20:23], v[228:231]
    v_mfma_f32_16x16x32_bf16 v[232:235], v[172:175], v[20:23], v[232:235]
    v_mfma_f32_16x16x32_bf16 v[236:239], v[156:159], v[24:27], v[236:239]
    v_mfma_f32_16x16x32_bf16 v[240:243], v[160:163], v[24:27], v[240:243]
    v_mfma_f32_16x16x32_bf16 v[244:247], v[164:167], v[24:27], v[244:247]
    v_mfma_f32_16x16x32_bf16 v[248:251], v[168:171], v[24:27], v[248:251]
    v_mfma_f32_16x16x32_bf16 v[252:255], v[172:175], v[24:27], v[252:255]
    s_waitcnt vmcnt(18)
    v_mfma_f32_16x16x32_bf16 v[176:179], v[76:79], v[28:31], v[176:179]
    s_load_dwordx4 s[52:55], s[40:41], 16 glc
    v_mfma_f32_16x16x32_bf16 v[180:183], v[80:83], v[28:31], v[180:183]
    s_mul_i32 s10, s26, 5120
    s_add_u32 s10, s10, s76
    v_mfma_f32_16x16x32_bf16 v[184:187], v[84:87], v[28:31], v[184:187]
    buffer_load_dwordx4 v[156:159], v6, s[60:63], s10 offen offset:0 sc1
    v_mfma_f32_16x16x32_bf16 v[188:191], v[88:91], v[28:31], v[188:191]
    buffer_load_dwordx4 v[160:163], v6, s[60:63], s10 offen offset:1024 sc1
    v_mfma_f32_16x16x32_bf16 v[192:195], v[92:95], v[28:31], v[192:195]
    buffer_load_dwordx4 v[164:167], v6, s[60:63], s10 offen offset:2048 sc1
    v_mfma_f32_16x16x32_bf16 v[196:199], v[76:79], v[32:35], v[196:199]
    buffer_load_dwordx4 v[168:171], v6, s[60:63], s10 offen offset:3072 sc1
    v_mfma_f32_16x16x32_bf16 v[200:203], v[80:83], v[32:35], v[200:203]
    buffer_load_dwordx4 v[172:175], v7, s[60:63], s10 offen offset:0 sc1
    v_mfma_f32_16x16x32_bf16 v[204:207], v[84:87], v[32:35], v[204:207]
    v_mfma_f32_16x16x32_bf16 v[208:211], v[88:91], v[32:35], v[208:211]
    v_mfma_f32_16x16x32_bf16 v[212:215], v[92:95], v[32:35], v[212:215]
    v_mfma_f32_16x16x32_bf16 v[216:219], v[76:79], v[36:39], v[216:219]
    v_mfma_f32_16x16x32_bf16 v[220:223], v[80:83], v[36:39], v[220:223]
    v_mfma_f32_16x16x32_bf16 v[224:227], v[84:87], v[36:39], v[224:227]
    v_mfma_f32_16x16x32_bf16 v[228:231], v[88:91], v[36:39], v[228:231]
    v_mfma_f32_16x16x32_bf16 v[232:235], v[92:95], v[36:39], v[232:235]
    v_mfma_f32_16x16x32_bf16 v[236:239], v[76:79], v[40:43], v[236:239]
    v_mfma_f32_16x16x32_bf16 v[240:243], v[80:83], v[40:43], v[240:243]
    v_mfma_f32_16x16x32_bf16 v[244:247], v[84:87], v[40:43], v[244:247]
    v_mfma_f32_16x16x32_bf16 v[248:251], v[88:91], v[40:43], v[248:251]
    v_mfma_f32_16x16x32_bf16 v[252:255], v[92:95], v[40:43], v[252:255]
    s_mov_b32 s12, 0
    s_branch L_k1_fc1_c
L_k1_fc1_r:
    s_sleep 6
    s_load_dwordx4 s[52:55], s[40:41], 16 glc
L_k1_fc1_c:
    s_waitcnt lgkmcnt(0)
    s_xor_b32 s52, s52, s82
    s_xor_b32 s53, s53, s82
    s_xor_b32 s54, s54, s82
    s_xor_b32 s55, s55, s82
    s_add_u32 s12, s12, 1
    s_or_b64 s[52:53], s[52:53], s[54:55]
    s_cbranch_scc0 L_k1_fc1_d
    s_cmp_lt_u32 s12, 0x100000
    s_cbranch_scc1 L_k1_fc1_r
L_k1_fc1_d:
    s_waitcnt vmcnt(19)
    v_mfma_f32_16x16x32_bf16 v[176:179], v[96:99], v[44:47], v[176:179]
    s_lshl_b32 s9, s24, 12
    s_add_u32 s9, s9, s75
    v_mfma_f32_16x16x32_bf16 v[180:183], v[100:103], v[44:47], v[180:183]
    buffer_load_dwordx4 v[12:15], v2, s[60:63], s9 offen sc1
    v_mfma_f32_16x16x32_bf16 v[184:187], v[104:107], v[44:47], v[184:187]
    buffer_load_dwordx4 v[16:19], v3, s[60:63], s9 offen sc1
    v_mfma_f32_16x16x32_bf16 v[188:191], v[108:111], v[44:47], v[188:191]
    buffer_load_dwordx4 v[20:23], v4, s[60:63], s9 offen sc1
    v_mfma_f32_16x16x32_bf16 v[192:195], v[112:115], v[44:47], v[192:195]
    buffer_load_dwordx4 v[24:27], v5, s[60:63], s9 offen sc1
    v_mfma_f32_16x16x32_bf16 v[196:199], v[96:99], v[48:51], v[196:199]
    s_lshl_b32 s9, s25, 12
    s_add_u32 s9, s9, s75
    v_mfma_f32_16x16x32_bf16 v[200:203], v[100:103], v[48:51], v[200:203]
    buffer_load_dwordx4 v[28:31], v2, s[60:63], s9 offen sc1
    v_mfma_f32_16x16x32_bf16 v[204:207], v[104:107], v[48:51], v[204:207]
    buffer_load_dwordx4 v[32:35], v3, s[60:63], s9 offen sc1
    v_mfma_f32_16x16x32_bf16 v[208:211], v[108:111], v[48:51], v[208:211]
    buffer_load_dwordx4 v[36:39], v4, s[60:63], s9 offen sc1
    v_mfma_f32_16x16x32_bf16 v[212:215], v[112:115], v[48:51], v[212:215]
    buffer_load_dwordx4 v[40:43], v5, s[60:63], s9 offen sc1
    v_mfma_f32_16x16x32_bf16 v[216:219], v[96:99], v[52:55], v[216:219]
    s_mul_i32 s10, s27, 5120
    s_add_u32 s10, s10, s76
    v_mfma_f32_16x16x32_bf16 v[220:223], v[100:103], v[52:55], v[220:223]
    buffer_load_dwordx4 v[76:79], v6, s[60:63], s10 offen offset:0 sc1
    v_mfma_f32_16x16x32_bf16 v[224:227], v[104:107], v[52:55], v[224:227]
    buffer_load_dwordx4 v[80:83], v6, s[60:63], s10 offen offset:1024 sc1
    v_mfma_f32_16x16x32_bf16 v[228:231], v[108:111], v[52:55], v[228:231]
    buffer_load_dwordx4 v[84:87], v6, s[60:63], s10 offen offset:2048 sc1
    v_mfma_f32_16x16x32_bf16 v[232:235], v[112:115], v[52:55], v[232:235]
    buffer_load_dwordx4 v[88:91], v6, s[60:63], s10 offen offset:3072 sc1
    v_mfma_f32_16x16x32_bf16 v[236:239], v[96:99], v[56:59], v[236:239]
    buffer_load_dwordx4 v[92:95], v7, s[60:63], s10 offen offset:0 sc1
    v_mfma_f32_16x16x32_bf16 v[240:243], v[100:103], v[56:59], v[240:243]
    v_mfma_f32_16x16x32_bf16 v[244:247], v[104:107], v[56:59], v[244:247]
    v_mfma_f32_16x16x32_bf16 v[248:251], v[108:111], v[56:59], v[248:251]
    v_mfma_f32_16x16x32_bf16 v[252:255], v[112:115], v[56:59], v[252:255]
    s_waitcnt vmcnt(23)
    v_mfma_f32_16x16x32_bf16 v[176:179], v[116:119], v[60:63], v[176:179]
    s_lshl_b32 s9, s26, 12
    s_add_u32 s9, s9, s75
    v_mfma_f32_16x16x32_bf16 v[180:183], v[120:123], v[60:63], v[180:183]
    buffer_load_dwordx4 v[44:47], v2, s[60:63], s9 offen sc1
    v_mfma_f32_16x16x32_bf16 v[184:187], v[124:127], v[60:63], v[184:187]
    buffer_load_dwordx4 v[48:51], v3, s[60:63], s9 offen sc1
    v_mfma_f32_16x16x32_bf16 v[188:191], v[128:131], v[60:63], v[188:191]
    buffer_load_dwordx4 v[52:55], v4, s[60:63], s9 offen sc1
    v_mfma_f32_16x16x32_bf16 v[192:195], v[132:135], v[60:63], v[192:195]
    buffer_load_dwordx4 v[56:59], v5, s[60:63], s9 offen sc1
    v_mfma_f32_16x16x32_bf16 v[196:199], v[116:119], v[64:67], v[196:199]
    s_mul_i32 s10, s29, 5120
    s_add_u32 s10, s10, s76
    v_mfma_f32_16x16x32_bf16 v[200:203], v[120:123], v[64:67], v[200:203]
    buffer_load_dwordx4 v[96:99], v6, s[60:63], s10 offen offset:0 sc1
    v_mfma_f32_16x16x32_bf16 v[204:207], v[124:127], v[64:67], v[204:207]
    buffer_load_dwordx4 v[100:103], v6, s[60:63], s10 offen offset:1024 sc1
    v_mfma_f32_16x16x32_bf16 v[208:211], v[128:131], v[64:67], v[208:211]
    buffer_load_dwordx4 v[104:107], v6, s[60:63], s10 offen offset:2048 sc1
    v_mfma_f32_16x16x32_bf16 v[212:215], v[132:135], v[64:67], v[212:215]
    buffer_load_dwordx4 v[108:111], v6, s[60:63], s10 offen offset:3072 sc1
    v_mfma_f32_16x16x32_bf16 v[216:219], v[116:119], v[68:71], v[216:219]
    buffer_load_dwordx4 v[112:115], v7, s[60:63], s10 offen offset:0 sc1
    v_mfma_f32_16x16x32_bf16 v[220:223], v[120:123], v[68:71], v[220:223]
    v_mfma_f32_16x16x32_bf16 v[224:227], v[124:127], v[68:71], v[224:227]
    v_mfma_f32_16x16x32_bf16 v[228:231], v[128:131], v[68:71], v[228:231]
    v_mfma_f32_16x16x32_bf16 v[232:235], v[132:135], v[68:71], v[232:235]
    v_mfma_f32_16x16x32_bf16 v[236:239], v[116:119], v[72:75], v[236:239]
    v_mfma_f32_16x16x32_bf16 v[240:243], v[120:123], v[72:75], v[240:243]
    v_mfma_f32_16x16x32_bf16 v[244:247], v[124:127], v[72:75], v[244:247]
    v_mfma_f32_16x16x32_bf16 v[248:251], v[128:131], v[72:75], v[248:251]
    v_mfma_f32_16x16x32_bf16 v[252:255], v[132:135], v[72:75], v[252:255]
    s_waitcnt vmcnt(18)
    v_mfma_f32_16x16x32_bf16 v[176:179], v[136:139], v[12:15], v[176:179]
    s_lshl_b32 s9, s27, 12
    s_add_u32 s9, s9, s75
    v_mfma_f32_16x16x32_bf16 v[180:183], v[140:143], v[12:15], v[180:183]
    buffer_load_dwordx4 v[60:63], v2, s[60:63], s9 offen sc1
    v_mfma_f32_16x16x32_bf16 v[184:187], v[144:147], v[12:15], v[184:187]
    buffer_load_dwordx4 v[64:67], v3, s[60:63], s9 offen sc1
    v_mfma_f32_16x16x32_bf16 v[188:191], v[148:151], v[12:15], v[188:191]
    buffer_load_dwordx4 v[68:71], v4, s[60:63], s9 offen sc1
    v_mfma_f32_16x16x32_bf16 v[192:195], v[152:155], v[12:15], v[192:195]
    buffer_load_dwordx4 v[72:75], v5, s[60:63], s9 offen sc1
    v_mfma_f32_16x16x32_bf16 v[196:199], v[136:139], v[16:19], v[196:199]
    s_waitcnt vmcnt(63)
    v_mfma_f32_16x16x32_bf16 v[200:203], v[140:143], v[16:19], v[200:203]
    ds_read_b128 v[116:119], v9 offset:0
    v_mfma_f32_16x16x32_bf16 v[204:207], v[144:147], v[16:19], v[204:207]
    ds_read_b128 v[120:123], v9 offset:1024
    v_mfma_f32_16x16x32_bf16 v[208:211], v[148:151], v[16:19], v[208:211]
    ds_read_b128 v[124:127], v9 offset:2048
    v_mfma_f32_16x16x32_bf16 v[212:215], v[152:155], v[16:19], v[212:215]
    ds_read_b128 v[128:131], v9 offset:3072
    v_mfma_f32_16x16x32_bf16 v[216:219], v[136:139], v[20:23], v[216:219]
    ds_read_b128 v[132:135], v9 offset:4096
    v_mfma_f32_16x16x32_bf16 v[220:223], v[140:143], v[20:23], v[220:223]
    v_mfma_f32_16x16x32_bf16 v[224:227], v[144:147], v[20:23], v[224:227]
    v_mfma_f32_16x16x32_bf16 v[228:231], v[148:151], v[20:23], v[228:231]
    v_mfma_f32_16x16x32_bf16 v[232:235], v[152:155], v[20:23], v[232:235]
    v_mfma_f32_16x16x32_bf16 v[236:239], v[136:139], v[24:27], v[236:239]
    v_mfma_f32_16x16x32_bf16 v[240:243], v[140:143], v[24:27], v[240:243]
    v_mfma_f32_16x16x32_bf16 v[244:247], v[144:147], v[24:27], v[244:247]
    v_mfma_f32_16x16x32_bf16 v[248:251], v[148:151], v[24:27], v[248:251]
    v_mfma_f32_16x16x32_bf16 v[252:255], v[152:155], v[24:27], v[252:255]
    s_waitcnt vmcnt(18) lgkmcnt(0)
    v_mfma_f32_16x16x32_bf16 v[176:179], v[116:119], v[28:31], v[176:179]
    s_load_dwordx4 s[52:55], s[40:41], 32 glc
    v_mfma_f32_16x16x32_bf16 v[180:183], v[120:123], v[28:31], v[180:183]
    s_mul_i32 s10, s30, 5120
    s_add_u32 s10, s10, s76
    v_mfma_f32_16x16x32_bf16 v[184:187], v[124:127], v[28:31], v[184:187]
    buffer_load_dwordx4 v[136:139], v6, s[60:63], s10 offen offset:0 sc1
    v_mfma_f32_16x16x32_bf16 v[188:191], v[128:131], v[28:31], v[188:191]
    buffer_load_dwordx4 v[140:143], v6, s[60:63], s10 offen offset:1024 sc1
    v_mfma_f32_16x16x32_bf16 v[192:195], v[132:135], v[28:31], v[192:195]
    buffer_load_dwordx4 v[144:147], v6, s[60:63], s10 offen offset:2048 sc1
    v_mfma_f32_16x16x32_bf16 v[196:199], v[116:119], v[32:35], v[196:199]
    buffer_load_dwordx4 v[148:151], v6, s[60:63], s10 offen offset:3072 sc1
    v_mfma_f32_16x16x32_bf16 v[200:203], v[120:123], v[32:35], v[200:203]
    buffer_load_dwordx4 v[152:155], v7, s[60:63], s10 offen offset:0 sc1
    v_mfma_f32_16x16x32_bf16 v[204:207], v[124:127], v[32:35], v[204:207]
    v_mfma_f32_16x16x32_bf16 v[208:211], v[128:131], v[32:35], v[208:211]
    v_mfma_f32_16x16x32_bf16 v[212:215], v[132:135], v[32:35], v[212:215]
    v_mfma_f32_16x16x32_bf16 v[216:219], v[116:119], v[36:39], v[216:219]
    v_mfma_f32_16x16x32_bf16 v[220:223], v[120:123], v[36:39], v[220:223]
    v_mfma_f32_16x16x32_bf16 v[224:227], v[124:127], v[36:39], v[224:227]
    v_mfma_f32_16x16x32_bf16 v[228:231], v[128:131], v[36:39], v[228:231]
    v_mfma_f32_16x16x32_bf16 v[232:235], v[132:135], v[36:39], v[232:235]
    v_mfma_f32_16x16x32_bf16 v[236:239], v[116:119], v[40:43], v[236:239]
    v_mfma_f32_16x16x32_bf16 v[240:243], v[120:123], v[40:43], v[240:243]
    v_mfma_f32_16x16x32_bf16 v[244:247], v[124:127], v[40:43], v[244:247]
    v_mfma_f32_16x16x32_bf16 v[248:251], v[128:131], v[40:43], v[248:251]
    v_mfma_f32_16x16x32_bf16 v[252:255], v[132:135], v[40:43], v[252:255]
    s_mov_b32 s12, 0
    s_branch L_k1_fc2_c
L_k1_fc2_r:
    s_sleep 6
    s_load_dwordx4 s[52:55], s[40:41], 32 glc
L_k1_fc2_c:
    s_waitcnt lgkmcnt(0)
    s_xor_b32 s52, s52, s82
    s_xor_b32 s53, s53, s82
    s_xor_b32 s54, s54, s82
    s_xor_b32 s55, s55, s82
    s_add_u32 s12, s12, 1
    s_or_b64 s[52:53], s[52:53], s[54:55]
    s_cbranch_scc0 L_k1_fc2_d
    s_cmp_lt_u32 s12, 0x100000
    s_cbranch_scc1 L_k1_fc2_r
L_k1_fc2_d:
    s_waitcnt vmcnt(14)
    v_mfma_f32_16x16x32_bf16 v[176:179], v[156:159], v[44:47], v[176:179]
    s_lshl_b32 s9, s28, 12
    s_add_u32 s9, s9, s75
    v_mfma_f32_16x16x32_bf16 v[180:183], v[160:163], v[44:47], v[180:183]
    buffer_load_dwordx4 v[12:15], v2, s[60:63], s9 offen sc1
    v_mfma_f32_16x16x32_bf16 v[184:187], v[164:167], v[44:47], v[184:187]
    buffer_load_dwordx4 v[16:19], v3, s[60:63], s9 offen sc1
    v_mfma_f32_16x16x32_bf16 v[188:191], v[168:171], v[44:47], v[188:191]
    buffer_load_dwordx4 v[20:23], v4, s[60:63], s9 offen sc1
    v_mfma_f32_16x16x32_bf16 v[192:195], v[172:175], v[44:47], v[192:195]
    buffer_load_dwordx4 v[24:27], v5, s[60:63], s9 offen sc1
    v_mfma_f32_16x16x32_bf16 v[196:199], v[156:159], v[48:51], v[196:199]
    s_lshl_b32 s9, s29, 12
    s_add_u32 s9, s9, s75
    v_mfma_f32_16x16x32_bf16 v[200:203], v[160:163], v[48:51], v[200:203]
    buffer_load_dwordx4 v[28:31], v2, s[60:63], s9 offen sc1
    v_mfma_f32_16x16x32_bf16 v[204:207], v[164:167], v[48:51], v[204:207]
    buffer_load_dwordx4 v[32:35], v3, s[60:63], s9 offen sc1
    v_mfma_f32_16x16x32_bf16 v[208:211], v[168:171], v[48:51], v[208:211]
    buffer_load_dwordx4 v[36:39], v4, s[60:63], s9 offen sc1
    v_mfma_f32_16x16x32_bf16 v[212:215], v[172:175], v[48:51], v[212:215]
    buffer_load_dwordx4 v[40:43], v5, s[60:63], s9 offen sc1
    v_mfma_f32_16x16x32_bf16 v[216:219], v[156:159], v[52:55], v[216:219]
    s_mul_i32 s10, s34, 5120
    s_add_u32 s10, s10, s76
    v_mfma_f32_16x16x32_bf16 v[220:223], v[160:163], v[52:55], v[220:223]
    buffer_load_dwordx4 v[116:119], v6, s[60:63], s10 offen offset:0 sc1
    v_mfma_f32_16x16x32_bf16 v[224:227], v[164:167], v[52:55], v[224:227]
    buffer_load_dwordx4 v[120:123], v6, s[60:63], s10 offen offset:1024 sc1
    v_mfma_f32_16x16x32_bf16 v[228:231], v[168:171], v[52:55], v[228:231]
    buffer_load_dwordx4 v[124:127], v6, s[60:63], s10 offen offset:2048 sc1
    v_mfma_f32_16x16x32_bf16 v[232:235], v[172:175], v[52:55], v[232:235]
    buffer_load_dwordx4 v[128:131], v6, s[60:63], s10 offen offset:3072 sc1
    v_mfma_f32_16x16x32_bf16 v[236:239], v[156:159], v[56:59], v[236:239]
    buffer_load_dwordx4 v[132:135], v7, s[60:63], s10 offen offset:0 sc1
    v_mfma_f32_16x16x32_bf16 v[240:243], v[160:163], v[56:59], v[240:243]
    v_mfma_f32_16x16x32_bf16 v[244:247], v[164:167], v[56:59], v[244:247]
    v_mfma_f32_16x16x32_bf16 v[248:251], v[168:171], v[56:59], v[248:251]
    v_mfma_f32_16x16x32_bf16 v[252:255], v[172:175], v[56:59], v[252:255]
    s_waitcnt vmcnt(18)
    v_mfma_f32_16x16x32_bf16 v[176:179], v[76:79], v[60:63], v[176:179]
    s_lshl_b32 s9, s30, 12
    s_add_u32 s9, s9, s75
    v_mfma_f32_16x16x32_bf16 v[180:183], v[80:83], v[60:63], v[180:183]
    buffer_load_dwordx4 v[44:47], v2, s[60:63], s9 offen sc1
    v_mfma_f32_16x16x32_bf16 v[184:187], v[84:87], v[60:63], v[184:187]
    buffer_load_dwordx4 v[48:51], v3, s[60:63], s9 offen sc1
    v_mfma_f32_16x16x32_bf16 v[188:191], v[88:91], v[60:63], v[188:191]
    buffer_load_dwordx4 v[52:55], v4, s[60:63], s9 offen sc1
    v_mfma_f32_16x16x32_bf16 v[192:195], v[92:95], v[60:63], v[192:195]
    buffer_load_dwordx4 v[56:59], v5, s[60:63], s9 offen sc1
    v_mfma_f32_16x16x32_bf16 v[196:199], v[76:79], v[64:67], v[196:199]
    s_waitcnt vmcnt(63)
    v_mfma_f32_16x16x32_bf16 v[200:203], v[80:83], v[64:67], v[200:203]
    ds_read_b128 v[156:159], v9 offset:5120
    v_mfma_f32_16x16x32_bf16 v[204:207], v[84:87], v[64:67], v[204:207]
    ds_read_b128 v[160:163], v9 offset:6144
    v_mfma_f32_16x16x32_bf16 v[208:211], v[88:91], v[64:67], v[208:211]
    ds_read_b128 v[164:167], v9 offset:7168
    v_mfma_f32_16x16x32_bf16 v[212:215], v[92:95], v[64:67], v[212:215]
    ds_read_b128 v[168:171], v9 offset:8192
    v_mfma_f32_16x16x32_bf16 v[216:219], v[76:79], v[68:71], v[216:219]
    ds_read_b128 v[172:175], v9 offset:9216
    v_mfma_f32_16x16x32_bf16 v[220:223], v[80:83], v[68:71], v[220:223]
    v_mfma_f32_16x16x32_bf16 v[224:227], v[84:87], v[68:71], v[224:227]
    v_mfma_f32_16x16x32_bf16 v[228:231], v[88:91], v[68:71], v[228:231]
    v_mfma_f32_16x16x32_bf16 v[232:235], v[92:95], v[68:71], v[232:235]
    v_mfma_f32_16x16x32_bf16 v[236:239], v[76:79], v[72:75], v[236:239]
    v_mfma_f32_16x16x32_bf16 v[240:243], v[80:83], v[72:75], v[240:243]
    v_mfma_f32_16x16x32_bf16 v[244:247], v[84:87], v[72:75], v[244:247]
    v_mfma_f32_16x16x32_bf16 v[248:251], v[88:91], v[72:75], v[248:251]
    v_mfma_f32_16x16x32_bf16 v[252:255], v[92:95], v[72:75], v[252:255]
    s_waitcnt vmcnt(13) lgkmcnt(0)
    v_mfma_f32_16x16x32_bf16 v[176:179], v[156:159], v[12:15], v[176:179]
    s_lshl_b32 s9, s31, 12
    s_add_u32 s9, s9, s75
    v_mfma_f32_16x16x32_bf16 v[180:183], v[160:163], v[12:15], v[180:183]
    buffer_load_dwordx4 v[60:63], v2, s[60:63], s9 offen sc1
    v_mfma_f32_16x16x32_bf16 v[184:187], v[164:167], v[12:15], v[184:187]
    buffer_load_dwordx4 v[64:67], v3, s[60:63], s9 offen sc1
    v_mfma_f32_16x16x32_bf16 v[188:191], v[168:171], v[12:15], v[188:191]
    buffer_load_dwordx4 v[68:71], v4, s[60:63], s9 offen sc1
    v_mfma_f32_16x16x32_bf16 v[192:195], v[172:175], v[12:15], v[192:195]
    buffer_load_dwordx4 v[72:75], v5, s[60:63], s9 offen sc1
    v_mfma_f32_16x16x32_bf16 v[196:199], v[156:159], v[16:19], v[196:199]
    s_mul_i32 s10, s35, 5120
    s_add_u32 s10, s10, s76
    v_mfma_f32_16x16x32_bf16 v[200:203], v[160:163], v[16:19], v[200:203]
    buffer_load_dwordx4 v[76:79], v6, s[60:63], s10 offen offset:0 sc1
    v_mfma_f32_16x16x32_bf16 v[204:207], v[164:167], v[16:19], v[204:207]
    buffer_load_dwordx4 v[80:83], v6, s[60:63], s10 offen offset:1024 sc1
    v_mfma_f32_16x16x32_bf16 v[208:211], v[168:171], v[16:19], v[208:211]
    buffer_load_dwordx4 v[84:87], v6, s[60:63], s10 offen offset:2048 sc1
    v_mfma_f32_16x16x32_bf16 v[212:215], v[172:175], v[16:19], v[212:215]
    buffer_load_dwordx4 v[88:91], v6, s[60:63], s10 offen offset:3072 sc1
    v_mfma_f32_16x16x32_bf16 v[216:219], v[156:159], v[20:23], v[216:219]
    buffer_load_dwordx4 v[92:95], v7, s[60:63], s10 offen offset:0 sc1
    v_mfma_f32_16x16x32_bf16 v[220:223], v[160:163], v[20:23], v[220:223]
    v_mfma_f32_16x16x32_bf16 v[224:227], v[164:167], v[20:23], v[224:227]
    v_mfma_f32_16x16x32_bf16 v[228:231], v[168:171], v[20:23], v[228:231]
    v_mfma_f32_16x16x32_bf16 v[232:235], v[172:175], v[20:23], v[232:235]
    v_mfma_f32_16x16x32_bf16 v[236:239], v[156:159], v[24:27], v[236:239]
    v_mfma_f32_16x16x32_bf16 v[240:243], v[160:163], v[24:27], v[240:243]
    v_mfma_f32_16x16x32_bf16 v[244:247], v[164:167], v[24:27], v[244:247]
    v_mfma_f32_16x16x32_bf16 v[248:251], v[168:171], v[24:27], v[248:251]
    v_mfma_f32_16x16x32_bf16 v[252:255], v[172:175], v[24:27], v[252:255]
    s_waitcnt vmcnt(18)
    v_mfma_f32_16x16x32_bf16 v[176:179], v[96:99], v[28:31], v[176:179]
    s_lshl_b32 s9, s34, 12
    s_add_u32 s9, s9, s75
    v_mfma_f32_16x16x32_bf16 v[180:183], v[100:103], v[28:31], v[180:183]
    buffer_load_dwordx4 v[12:15], v2, s[60:63], s9 offen sc1
    v_mfma_f32_16x16x32_bf16 v[184:187], v[104:107], v[28:31], v[184:187]
    buffer_load_dwordx4 v[16:19], v3, s[60:63], s9 offen sc1
    v_mfma_f32_16x16x32_bf16 v[188:191], v[108:111], v[28:31], v[188:191]
    buffer_load_dwordx4 v[20:23], v4, s[60:63], s9 offen sc1
    v_mfma_f32_16x16x32_bf16 v[192:195], v[112:115], v[28:31], v[192:195]
    buffer_load_dwordx4 v[24:27], v5, s[60:63], s9 offen sc1
    v_mfma_f32_16x16x32_bf16 v[196:199], v[96:99], v[32:35], v[196:199]
    s_mul_i32 s10, s37, 5120
    s_add_u32 s10, s10, s76
    v_mfma_f32_16x16x32_bf16 v[200:203], v[100:103], v[32:35], v[200:203]
    buffer_load_dwordx4 v[156:159], v6, s[60:63], s10 offen offset:0 sc1
    v_mfma_f32_16x16x32_bf16 v[204:207], v[104:107], v[32:35], v[204:207]
    buffer_load_dwordx4 v[160:163], v6, s[60:63], s10 offen offset:1024 sc1
    v_mfma_f32_16x16x32_bf16 v[208:211], v[108:111], v[32:35], v[208:211]
    buffer_load_dwordx4 v[164:167], v6, s[60:63], s10 offen offset:2048 sc1
    v_mfma_f32_16x16x32_bf16 v[212:215], v[112:115], v[32:35], v[212:215]
    buffer_load_dwordx4 v[168:171], v6, s[60:63], s10 offen offset:3072 sc1
    v_mfma_f32_16x16x32_bf16 v[216:219], v[96:99], v[36:39], v[216:219]
    buffer_load_dwordx4 v[172:175], v7, s[60:63], s10 offen offset:0 sc1
    v_mfma_f32_16x16x32_bf16 v[220:223], v[100:103], v[36:39], v[220:223]
    v_mfma_f32_16x16x32_bf16 v[224:227], v[104:107], v[36:39], v[224:227]
    v_mfma_f32_16x16x32_bf16 v[228:231], v[108:111], v[36:39], v[228:231]
    v_mfma_f32_16x16x32_bf16 v[232:235], v[112:115], v[36:39], v[232:235]
    v_mfma_f32_16x16x32_bf16 v[236:239], v[96:99], v[40:43], v[236:239]
    v_mfma_f32_16x16x32_bf16 v[240:243], v[100:103], v[40:43], v[240:243]
    v_mfma_f32_16x16x32_bf16 v[244:247], v[104:107], v[40:43], v[244:247]
    v_mfma_f32_16x16x32_bf16 v[248:251], v[108:111], v[40:43], v[248:251]
    v_mfma_f32_16x16x32_bf16 v[252:255], v[112:115], v[40:43], v[252:255]
    s_waitcnt vmcnt(18)
    v_mfma_f32_16x16x32_bf16 v[176:179], v[136:139], v[44:47], v[176:179]
    s_lshl_b32 s9, s35, 12
    s_add_u32 s9, s9, s75
    v_mfma_f32_16x16x32_bf16 v[180:183], v[140:143], v[44:47], v[180:183]
    buffer_load_dwordx4 v[28:31], v2, s[60:63], s9 offen sc1
    v_mfma_f32_16x16x32_bf16 v[184:187], v[144:147], v[44:47], v[184:187]
    buffer_load_dwordx4 v[32:35], v3, s[60:63], s9 offen sc1
    v_mfma_f32_16x16x32_bf16 v[188:191], v[148:151], v[44:47], v[188:191]
    buffer_load_dwordx4 v[36:39], v4, s[60:63], s9 offen sc1
    v_mfma_f32_16x16x32_bf16 v[192:195], v[152:155], v[44:47], v[192:195]
    buffer_load_dwordx4 v[40:43], v5, s[60:63], s9 offen sc1
    v_mfma_f32_16x16x32_bf16 v[196:199], v[136:139], v[48:51], v[196:199]
    s_waitcnt vmcnt(63)
    v_mfma_f32_16x16x32_bf16 v[200:203], v[140:143], v[48:51], v[200:203]
    ds_read_b128 v[96:99], v9 offset:10240
    v_mfma_f32_16x16x32_bf16 v[204:207], v[144:147], v[48:51], v[204:207]
    ds_read_b128 v[100:103], v9 offset:11264
    v_mfma_f32_16x16x32_bf16 v[208:211], v[148:151], v[48:51], v[208:211]
    ds_read_b128 v[104:107], v9 offset:12288
    v_mfma_f32_16x16x32_bf16 v[212:215], v[152:155], v[48:51], v[212:215]
    ds_read_b128 v[108:111], v9 offset:13312
    v_mfma_f32_16x16x32_bf16 v[216:219], v[136:139], v[52:55], v[216:219]
    ds_read_b128 v[112:115], v9 offset:14336
    v_mfma_f32_16x16x32_bf16 v[220:223], v[140:143], v[52:55], v[220:223]
    v_mfma_f32_16x16x32_bf16 v[224:227], v[144:147], v[52:55], v[224:227]
    v_mfma_f32_16x16x32_bf16 v[228:231], v[148:151], v[52:55], v[228:231]
    v_mfma_f32_16x16x32_bf16 v[232:235], v[152:155], v[52:55], v[232:235]
    v_mfma_f32_16x16x32_bf16 v[236:239], v[136:139], v[56:59], v[236:239]
    v_mfma_f32_16x16x32_bf16 v[240:243], v[140:143], v[56:59], v[240:243]
    v_mfma_f32_16x16x32_bf16 v[244:247], v[144:147], v[56:59], v[244:247]
    v_mfma_f32_16x16x32_bf16 v[248:251], v[148:151], v[56:59], v[248:251]
    v_mfma_f32_16x16x32_bf16 v[252:255], v[152:155], v[56:59], v[252:255]
    s_waitcnt vmcnt(18) lgkmcnt(0)
    v_mfma_f32_16x16x32_bf16 v[176:179], v[96:99], v[60:63], v[176:179]
    s_lshl_b32 s9, s36, 12
    s_add_u32 s9, s9, s75
    v_mfma_f32_16x16x32_bf16 v[180:183], v[100:103], v[60:63], v[180:183]
    buffer_load_dwordx4 v[44:47], v2, s[60:63], s9 offen sc1
    v_mfma_f32_16x16x32_bf16 v[184:187], v[104:107], v[60:63], v[184:187]
    buffer_load_dwordx4 v[48:51], v3, s[60:63], s9 offen sc1
    v_mfma_f32_16x16x32_bf16 v[188:191], v[108:111], v[60:63], v[188:191]
    buffer_load_dwordx4 v[52:55], v4, s[60:63], s9 offen sc1
    v_mfma_f32_16x16x32_bf16 v[192:195], v[112:115], v[60:63], v[192:195]
    buffer_load_dwordx4 v[56:59], v5, s[60:63], s9 offen sc1
    v_mfma_f32_16x16x32_bf16 v[196:199], v[96:99], v[64:67], v[196:199]
    s_mul_i32 s10, s38, 5120
    s_add_u32 s10, s10, s76
    v_mfma_f32_16x16x32_bf16 v[200:203], v[100:103], v[64:67], v[200:203]
    buffer_load_dwordx4 v[136:139], v6, s[60:63], s10 offen offset:0 sc1
    v_mfma_f32_16x16x32_bf16 v[204:207], v[104:107], v[64:67], v[204:207]
    buffer_load_dwordx4 v[140:143], v6, s[60:63], s10 offen offset:1024 sc1
    v_mfma_f32_16x16x32_bf16 v[208:211], v[108:111], v[64:67], v[208:211]
    buffer_load_dwordx4 v[144:147], v6, s[60:63], s10 offen offset:2048 sc1
    v_mfma_f32_16x16x32_bf16 v[212:215], v[112:115], v[64:67], v[212:215]
    buffer_load_dwordx4 v[148:151], v6, s[60:63], s10 offen offset:3072 sc1
    v_mfma_f32_16x16x32_bf16 v[216:219], v[96:99], v[68:71], v[216:219]
    buffer_load_dwordx4 v[152:155], v7, s[60:63], s10 offen offset:0 sc1
    v_mfma_f32_16x16x32_bf16 v[220:223], v[100:103], v[68:71], v[220:223]
    v_mfma_f32_16x16x32_bf16 v[224:227], v[104:107], v[68:71], v[224:227]
    v_mfma_f32_16x16x32_bf16 v[228:231], v[108:111], v[68:71], v[228:231]
    v_mfma_f32_16x16x32_bf16 v[232:235], v[112:115], v[68:71], v[232:235]
    v_mfma_f32_16x16x32_bf16 v[236:239], v[96:99], v[72:75], v[236:239]
    v_mfma_f32_16x16x32_bf16 v[240:243], v[100:103], v[72:75], v[240:243]
    v_mfma_f32_16x16x32_bf16 v[244:247], v[104:107], v[72:75], v[244:247]
    v_mfma_f32_16x16x32_bf16 v[248:251], v[108:111], v[72:75], v[248:251]
    v_mfma_f32_16x16x32_bf16 v[252:255], v[112:115], v[72:75], v[252:255]
    s_waitcnt vmcnt(18)
    v_mfma_f32_16x16x32_bf16 v[176:179], v[116:119], v[12:15], v[176:179]
    s_lshl_b32 s9, s37, 12
    s_add_u32 s9, s9, s75
    v_mfma_f32_16x16x32_bf16 v[180:183], v[120:123], v[12:15], v[180:183]
    buffer_load_dwordx4 v[60:63], v2, s[60:63], s9 offen sc1
    v_mfma_f32_16x16x32_bf16 v[184:187], v[124:127], v[12:15], v[184:187]
    buffer_load_dwordx4 v[64:67], v3, s[60:63], s9 offen sc1
    v_mfma_f32_16x16x32_bf16 v[188:191], v[128:131], v[12:15], v[188:191]
    buffer_load_dwordx4 v[68:71], v4, s[60:63], s9 offen sc1
    v_mfma_f32_16x16x32_bf16 v[192:195], v[132:135], v[12:15], v[192:195]
    buffer_load_dwordx4 v[72:75], v5, s[60:63], s9 offen sc1
    v_mfma_f32_16x16x32_bf16 v[196:199], v[116:119], v[16:19], v[196:199]
    v_mfma_f32_16x16x32_bf16 v[200:203], v[120:123], v[16:19], v[200:203]
    v_mfma_f32_16x16x32_bf16 v[204:207], v[124:127], v[16:19], v[204:207]
    v_mfma_f32_16x16x32_bf16 v[208:211], v[128:131], v[16:19], v[208:211]
    v_mfma_f32_16x16x32_bf16 v[212:215], v[132:135], v[16:19], v[212:215]
    v_mfma_f32_16x16x32_bf16 v[216:219], v[116:119], v[20:23], v[216:219]
    v_mfma_f32_16x16x32_bf16 v[220:223], v[120:123], v[20:23], v[220:223]
    v_mfma_f32_16x16x32_bf16 v[224:227], v[124:127], v[20:23], v[224:227]
    v_mfma_f32_16x16x32_bf16 v[228:231], v[128:131], v[20:23], v[228:231]
    v_mfma_f32_16x16x32_bf16 v[232:235], v[132:135], v[20:23], v[232:235]
    v_mfma_f32_16x16x32_bf16 v[236:239], v[116:119], v[24:27], v[236:239]
    v_mfma_f32_16x16x32_bf16 v[240:243], v[120:123], v[24:27], v[240:243]
    v_mfma_f32_16x16x32_bf16 v[244:247], v[124:127], v[24:27], v[244:247]
    v_mfma_f32_16x16x32_bf16 v[248:251], v[128:131], v[24:27], v[248:251]
    v_mfma_f32_16x16x32_bf16 v[252:255], v[132:135], v[24:27], v[252:255]
    s_waitcnt vmcnt(13)
    v_mfma_f32_16x16x32_bf16 v[176:179], v[76:79], v[28:31], v[176:179]
    s_lshl_b32 s9, s38, 12
    s_add_u32 s9, s9, s75
    v_mfma_f32_16x16x32_bf16 v[180:183], v[80:83], v[28:31], v[180:183]
    buffer_load_dwordx4 v[12:15], v2, s[60:63], s9 offen sc1
    v_mfma_f32_16x16x32_bf16 v[184:187], v[84:87], v[28:31], v[184:187]
    buffer_load_dwordx4 v[16:19], v3, s[60:63], s9 offen sc1
    v_mfma_f32_16x16x32_bf16 v[188:191], v[88:91], v[28:31], v[188:191]
    buffer_load_dwordx4 v[20:23], v4, s[60:63], s9 offen sc1
    v_mfma_f32_16x16x32_bf16 v[192:195], v[92:95], v[28:31], v[192:195]
    buffer_load_dwordx4 v[24:27], v5, s[60:63], s9 offen sc1
    v_mfma_f32_16x16x32_bf16 v[196:199], v[76:79], v[32:35], v[196:199]
    s_waitcnt vmcnt(63)
    v_mfma_f32_16x16x32_bf16 v[200:203], v[80:83], v[32:35], v[200:203]
    ds_read_b128 v[116:119], v9 offset:15360
    v_mfma_f32_16x16x32_bf16 v[204:207], v[84:87], v[32:35], v[204:207]
    ds_read_b128 v[120:123], v9 offset:16384
    v_mfma_f32_16x16x32_bf16 v[208:211], v[88:91], v[32:35], v[208:211]
    ds_read_b128 v[124:127], v9 offset:17408
    v_mfma_f32_16x16x32_bf16 v[212:215], v[92:95], v[32:35], v[212:215]
    ds_read_b128 v[128:131], v9 offset:18432
    v_mfma_f32_16x16x32_bf16 v[216:219], v[76:79], v[36:39], v[216:219]
    ds_read_b128 v[132:135], v9 offset:19456
    v_mfma_f32_16x16x32_bf16 v[220:223], v[80:83], v[36:39], v[220:223]
    v_mfma_f32_16x16x32_bf16 v[224:227], v[84:87], v[36:39], v[224:227]
    v_mfma_f32_16x16x32_bf16 v[228:231], v[88:91], v[36:39], v[228:231]
    v_mfma_f32_16x16x32_bf16 v[232:235], v[92:95], v[36:39], v[232:235]
    v_mfma_f32_16x16x32_bf16 v[236:239], v[76:79], v[40:43], v[236:239]
    v_mfma_f32_16x16x32_bf16 v[240:243], v[80:83], v[40:43], v[240:243]
    v_mfma_f32_16x16x32_bf16 v[244:247], v[84:87], v[40:43], v[244:247]
    v_mfma_f32_16x16x32_bf16 v[248:251], v[88:91], v[40:43], v[248:251]
    v_mfma_f32_16x16x32_bf16 v[252:255], v[92:95], v[40:43], v[252:255]
    s_waitcnt vmcnt(13) lgkmcnt(0)
    v_mfma_f32_16x16x32_bf16 v[176:179], v[116:119], v[44:47], v[176:179]
    s_lshl_b32 s9, s39, 12
    s_add_u32 s9, s9, s75
    v_mfma_f32_16x16x32_bf16 v[180:183], v[120:123], v[44:47], v[180:183]
    buffer_load_dwordx4 v[28:31], v2, s[60:63], s9 offen sc1
    v_mfma_f32_16x16x32_bf16 v[184:187], v[124:127], v[44:47], v[184:187]
    buffer_load_dwordx4 v[32:35], v3, s[60:63], s9 offen sc1
    v_mfma_f32_16x16x32_bf16 v[188:191], v[128:131], v[44:47], v[188:191]
    buffer_load_dwordx4 v[36:39], v4, s[60:63], s9 offen sc1
    v_mfma_f32_16x16x32_bf16 v[192:195], v[132:135], v[44:47], v[192:195]
    buffer_load_dwordx4 v[40:43], v5, s[60:63], s9 offen sc1
    v_mfma_f32_16x16x32_bf16 v[196:199], v[116:119], v[48:51], v[196:199]
    v_mfma_f32_16x16x32_bf16 v[200:203], v[120:123], v[48:51], v[200:203]
    v_mfma_f32_16x16x32_bf16 v[204:207], v[124:127], v[48:51], v[204:207]
    v_mfma_f32_16x16x32_bf16 v[208:211], v[128:131], v[48:51], v[208:211]
    v_mfma_f32_16x16x32_bf16 v[212:215], v[132:135], v[48:51], v[212:215]
    v_mfma_f32_16x16x32_bf16 v[216:219], v[116:119], v[52:55], v[216:219]
    v_mfma_f32_16x16x32_bf16 v[220:223], v[120:123], v[52:55], v[220:223]
    v_mfma_f32_16x16x32_bf16 v[224:227], v[124:127], v[52:55], v[224:227]
    v_mfma_f32_16x16x32_bf16 v[228:231], v[128:131], v[52:55], v[228:231]
    v_mfma_f32_16x16x32_bf16 v[232:235], v[132:135], v[52:55], v[232:235]
    v_mfma_f32_16x16x32_bf16 v[236:239], v[116:119], v[56:59], v[236:239]
    v_mfma_f32_16x16x32_bf16 v[240:243], v[120:123], v[56:59], v[240:243]
    v_mfma_f32_16x16x32_bf16 v[244:247], v[124:127], v[56:59], v[244:247]
    v_mfma_f32_16x16x32_bf16 v[248:251], v[128:131], v[56:59], v[248:251]
    v_mfma_f32_16x16x32_bf16 v[252:255], v[132:135], v[56:59], v[252:255]
    s_waitcnt vmcnt(8)
    v_mfma_f32_16x16x32_bf16 v[176:179], v[156:159], v[60:63], v[176:179]
    s_xor_b32 s11, s4, 1
    s_and_b32 s10, s11, 1
    s_mul_i32 s10, s10, 25600
    s_cmp_lt_u32 s11, 2
    s_cselect_b32 s9, 106496, 0
    s_add_u32 s10, s10, s9
    v_mfma_f32_16x16x32_bf16 v[180:183], v[160:163], v[60:63], v[180:183]
    v_add_u32 v3, s10, v6
    s_xor_b32 s11, s4, 2
    s_and_b32 s10, s11, 1
    s_mul_i32 s10, s10, 25600
    v_mfma_f32_16x16x32_bf16 v[184:187], v[164:167], v[60:63], v[184:187]
    s_cmp_lt_u32 s11, 2
    s_cselect_b32 s9, 106496, 0
    s_add_u32 s10, s10, s9
    v_add_u32 v4, s10, v6
    v_mfma_f32_16x16x32_bf16 v[188:191], v[168:171], v[60:63], v[188:191]
    s_xor_b32 s11, s4, 3
    s_and_b32 s10, s11, 1
    s_mul_i32 s10, s10, 25600
    s_cmp_lt_u32 s11, 2
    s_cselect_b32 s9, 106496, 0
    s_add_u32 s10, s10, s9
    v_mfma_f32_16x16x32_bf16 v[192:195], v[172:175], v[60:63], v[192:195]
    v_add_u32 v5, s10, v6
    s_mul_i32 s10, s4, 11520
    s_add_u32 s10, s10, 53248
    v_add_u32 v2, s10, v6
    v_mfma_f32_16x16x32_bf16 v[196:199], v[156:159], v[64:67], v[196:199]
    v_lshrrev_b32 v10, 4, v6
    s_lshl_b32 s9, s5, 6
    s_lshl_b32 s10, s4, 2
    s_add_u32 s9, s9, s10
    v_mfma_f32_16x16x32_bf16 v[200:203], v[160:163], v[64:67], v[200:203]
    s_mul_i32 s9, s9, 2560
    s_mul_i32 s10, s6, 320
    s_add_u32 s12, s9, s10
    v_add_u32 v96, 0, v10
    v_mfma_f32_16x16x32_bf16 v[204:207], v[164:167], v[64:67], v[204:207]
    v_add_u32 v97, 64, v10
    v_add_u32 v98, 128, v10
    v_mfma_f32_16x16x32_bf16 v[208:211], v[168:171], v[64:67], v[208:211]
    v_add_u32 v99, 192, v10
    v_add_u32 v100, 256, v10
    v_mfma_f32_16x16x32_bf16 v[212:215], v[172:175], v[64:67], v[212:215]
    v_mul_u32_u24 v101, 205, v96
    v_mul_u32_u24 v102, 205, v97
    v_mfma_f32_16x16x32_bf16 v[216:219], v[156:159], v[68:71], v[216:219]
    v_mul_u32_u24 v103, 205, v98
    v_mul_u32_u24 v104, 205, v99
    v_mfma_f32_16x16x32_bf16 v[220:223], v[160:163], v[68:71], v[220:223]
    v_mul_u32_u24 v105, 205, v100
    v_lshrrev_b32 v101, 12, v101
    v_mfma_f32_16x16x32_bf16 v[224:227], v[164:167], v[68:71], v[224:227]
    v_lshrrev_b32 v102, 12, v102
    v_lshrrev_b32 v103, 12, v103
    v_mfma_f32_16x16x32_bf16 v[228:231], v[168:171], v[68:71], v[228:231]
    v_lshrrev_b32 v104, 12, v104
    v_lshrrev_b32 v105, 12, v105
    v_mfma_f32_16x16x32_bf16 v[232:235], v[172:175], v[68:71], v[232:235]
    v_mul_u32_u24 v106, 20, v101
    v_bfe_u32 v111, v101, 1, 2
    v_mfma_f32_16x16x32_bf16 v[236:239], v[156:159], v[72:75], v[236:239]
    v_mul_u32_u24 v107, 20, v102
    v_bfe_u32 v112, v102, 1, 2
    v_mfma_f32_16x16x32_bf16 v[240:243], v[160:163], v[72:75], v[240:243]
    v_mul_u32_u24 v108, 20, v103
    v_bfe_u32 v113, v103, 1, 2
    v_mfma_f32_16x16x32_bf16 v[244:247], v[164:167], v[72:75], v[244:247]
    v_mul_u32_u24 v109, 20, v104
    v_bfe_u32 v114, v104, 1, 2
    v_mfma_f32_16x16x32_bf16 v[248:251], v[168:171], v[72:75], v[248:251]
    v_mfma_f32_16x16x32_bf16 v[252:255], v[172:175], v[72:75], v[252:255]
    s_waitcnt vmcnt(4)
    v_mfma_f32_16x16x32_bf16 v[176:179], v[136:139], v[12:15], v[176:179]
    s_waitcnt vmcnt(63)
    ds_read_b128 v[156:159], v9 offset:20480
    v_mfma_f32_16x16x32_bf16 v[180:183], v[140:143], v[12:15], v[180:183]
    ds_read_b128 v[160:163], v9 offset:21504
    ds_read_b128 v[164:167], v9 offset:22528
    v_mfma_f32_16x16x32_bf16 v[184:187], v[144:147], v[12:15], v[184:187]
    ds_read_b128 v[168:171], v9 offset:23552
    ds_read_b128 v[172:175], v9 offset:24576
    v_mfma_f32_16x16x32_bf16 v[188:191], v[148:151], v[12:15], v[188:191]
    v_mul_u32_u24 v110, 20, v105
    v_bfe_u32 v115, v105, 1, 2
    v_mfma_f32_16x16x32_bf16 v[192:195], v[152:155], v[12:15], v[192:195]
    v_sub_u32 v106, v96, v106
    v_sub_u32 v107, v97, v107
    v_mfma_f32_16x16x32_bf16 v[196:199], v[136:139], v[16:19], v[196:199]
    v_sub_u32 v108, v98, v108
    v_sub_u32 v109, v99, v109
    v_mfma_f32_16x16x32_bf16 v[200:203], v[140:143], v[16:19], v[200:203]
    v_sub_u32 v110, v100, v110
    v_xor_b32 v106, v106, v111
    v_mfma_f32_16x16x32_bf16 v[204:207], v[144:147], v[16:19], v[204:207]
    v_lshrrev_b32 v111, 2, v101
    v_xor_b32 v107, v107, v112
    v_mfma_f32_16x16x32_bf16 v[208:211], v[148:151], v[16:19], v[208:211]
    v_lshrrev_b32 v112, 2, v102
    v_xor_b32 v108, v108, v113
    v_mfma_f32_16x16x32_bf16 v[212:215], v[152:155], v[16:19], v[212:215]
    v_lshrrev_b32 v113, 2, v103
    v_xor_b32 v109, v109, v114
    v_mfma_f32_16x16x32_bf16 v[216:219], v[136:139], v[20:23], v[216:219]
    v_lshrrev_b32 v114, 2, v104
    v_xor_b32 v110, v110, v115
    v_mfma_f32_16x16x32_bf16 v[220:223], v[140:143], v[20:23], v[220:223]
    v_lshrrev_b32 v115, 2, v105
    v_mad_u32_u24 v101, v111, 12, v101
    v_mfma_f32_16x16x32_bf16 v[224:227], v[144:147], v[20:23], v[224:227]
    v_mad_u32_u24 v102, v112, 12, v102
    v_mad_u32_u24 v103, v113, 12, v103
    v_mfma_f32_16x16x32_bf16 v[228:231], v[148:151], v[20:23], v[228:231]
    v_mad_u32_u24 v104, v114, 12, v104
    v_mad_u32_u24 v105, v115, 12, v105
    v_mfma_f32_16x16x32_bf16 v[232:235], v[152:155], v[20:23], v[232:235]
    v_mul_u32_u24 v101, 2560, v101
    v_mul_u32_u24 v102, 2560, v102
    v_mfma_f32_16x16x32_bf16 v[236:239], v[136:139], v[24:27], v[236:239]
    v_mul_u32_u24 v103, 2560, v103
    v_mul_u32_u24 v104, 2560, v104
    v_mfma_f32_16x16x32_bf16 v[240:243], v[140:143], v[24:27], v[240:243]
    v_mul_u32_u24 v105, 2560, v105
    v_lshl_add_u32 v96, v106, 4, v101
    v_mfma_f32_16x16x32_bf16 v[244:247], v[144:147], v[24:27], v[244:247]
    v_lshl_add_u32 v97, v107, 4, v102
    v_lshl_add_u32 v98, v108, 4, v103
    v_mfma_f32_16x16x32_bf16 v[248:251], v[148:151], v[24:27], v[248:251]
    v_lshl_add_u32 v99, v109, 4, v104
    v_lshl_add_u32 v100, v110, 4, v105
    v_mfma_f32_16x16x32_bf16 v[252:255], v[152:155], v[24:27], v[252:255]
    s_waitcnt vmcnt(0) lgkmcnt(0)
    v_mfma_f32_16x16x32_bf16 v[176:179], v[156:159], v[28:31], v[176:179]
    s_nop 0
    v_mfma_f32_16x16x32_bf16 v[180:183], v[160:163], v[28:31], v[180:183]
    s_nop 0
    v_mfma_f32_16x16x32_bf16 v[184:187], v[164:167], v[28:31], v[184:187]
    s_nop 0
    v_mfma_f32_16x16x32_bf16 v[188:191], v[168:171], v[28:31], v[188:191]
    s_nop 0
    v_mfma_f32_16x16x32_bf16 v[192:195], v[172:175], v[28:31], v[192:195]
    s_nop 0
    v_mfma_f32_16x16x32_bf16 v[196:199], v[156:159], v[32:35], v[196:199]
    ds_write_b128 v8, v[176:179] offset:0
    v_mfma_f32_16x16x32_bf16 v[200:203], v[160:163], v[32:35], v[200:203]
    ds_write_b128 v8, v[180:183] offset:64
    v_mfma_f32_16x16x32_bf16 v[204:207], v[164:167], v[32:35], v[204:207]
    ds_write_b128 v8, v[184:187] offset:128
    v_mfma_f32_16x16x32_bf16 v[208:211], v[168:171], v[32:35], v[208:211]
    ds_write_b128 v8, v[188:191] offset:192
    v_mfma_f32_16x16x32_bf16 v[212:215], v[172:175], v[32:35], v[212:215]
    ds_write_b128 v8, v[192:195] offset:256
    v_mfma_f32_16x16x32_bf16 v[216:219], v[156:159], v[36:39], v[216:219]
    ds_write_b128 v8, v[196:199] offset:5120
    v_mfma_f32_16x16x32_bf16 v[220:223], v[160:163], v[36:39], v[220:223]
    ds_write_b128 v8, v[200:203] offset:5184
    v_mfma_f32_16x16x32_bf16 v[224:227], v[164:167], v[36:39], v[224:227]
    ds_write_b128 v8, v[204:207] offset:5248
    v_mfma_f32_16x16x32_bf16 v[228:231], v[168:171], v[36:39], v[228:231]
    ds_write_b128 v8, v[208:211] offset:5312
    v_mfma_f32_16x16x32_bf16 v[232:235], v[172:175], v[36:39], v[232:235]
    ds_write_b128 v8, v[212:215] offset:5376
    v_mfma_f32_16x16x32_bf16 v[236:239], v[156:159], v[40:43], v[236:239]
    ds_write_b128 v8, v[216:219] offset:10240
    v_mfma_f32_16x16x32_bf16 v[240:243], v[160:163], v[40:43], v[240:243]
    ds_write_b128 v8, v[220:223] offset:10304
    v_mfma_f32_16x16x32_bf16 v[244:247], v[164:167], v[40:43], v[244:247]
    ds_write_b128 v8, v[224:227] offset:10368
    v_mfma_f32_16x16x32_bf16 v[248:251], v[168:171], v[40:43], v[248:251]
    ds_write_b128 v8, v[228:231] offset:10432
    v_mfma_f32_16x16x32_bf16 v[252:255], v[172:175], v[40:43], v[252:255]
    ds_write_b128 v8, v[232:235] offset:10496
    ds_write_b128 v8, v[236:239] offset:15360
    ds_write_b128 v8, v[240:243] offset:15424
    s_nop 0
    ds_write_b128 v8, v[244:247] offset:15488
    s_nop 0
    ds_write_b128 v8, v[248:251] offset:15552
    s_nop 0
    ds_write_b128 v8, v[252:255] offset:15616
    s_waitcnt lgkmcnt(0)
    s_barrier
    ds_read_b128 v[12:15], v2 offset:0
    ds_read_b128 v[16:19], v3 offset:5120
    ds_read_b128 v[20:23], v4 offset:10240
    ds_read_b128 v[24:27], v5 offset:15360
    ds_read_b128 v[28:31], v9 offset:0
    ds_read_b128 v[32:35], v2 offset:1024
    ds_read_b128 v[36:39], v3 offset:6144
    ds_read_b128 v[40:43], v4 offset:11264
    ds_read_b128 v[44:47], v5 offset:16384
    ds_read_b128 v[48:51], v9 offset:1024
    ds_read_b128 v[52:55], v2 offset:2048
    ds_read_b128 v[56:59], v3 offset:7168
    ds_read_b128 v[60:63], v4 offset:12288
    ds_read_b128 v[64:67], v5 offset:17408
    ds_read_b128 v[68:71], v9 offset:2048
    s_waitcnt lgkmcnt(5)
    ds_read_b128 v[72:75], v2 offset:3072
    ds_read_b128 v[76:79], v3 offset:8192
    ds_read_b128 v[80:83], v4 offset:13312
    ds_read_b128 v[84:87], v5 offset:18432
    ds_read_b128 v[88:91], v9 offset:3072
    ds_read_b128 v[132:135], v2 offset:4096
    ds_read_b128 v[136:139], v3 offset:9216
    ds_read_b128 v[140:143], v4 offset:14336
    ds_read_b128 v[144:147], v5 offset:19456
    ds_read_b128 v[148:151], v9 offset:4096
    s_waitcnt lgkmcnt(15)
    v_pk_add_f32 v[12:13], v[12:13], v[16:17]
    v_pk_add_f32 v[20:21], v[20:21], v[24:25]
    v_pk_add_f32 v[14:15], v[14:15], v[18:19]
    v_pk_add_f32 v[22:23], v[22:23], v[26:27]
    v_pk_add_f32 v[12:13], v[12:13], v[28:29]
    v_pk_add_f32 v[14:15], v[14:15], v[30:31]
    v_pk_add_f32 v[12:13], v[12:13], v[20:21]
    v_pk_add_f32 v[14:15], v[14:15], v[22:23]
    buffer_store_dwordx4 v[12:15], v96, s[48:51], s12 offen sc1
    s_waitcnt lgkmcnt(15)
    v_pk_add_f32 v[32:33], v[32:33], v[36:37]
    v_pk_add_f32 v[40:41], v[40:41], v[44:45]
    v_pk_add_f32 v[34:35], v[34:35], v[38:39]
    v_pk_add_f32 v[42:43], v[42:43], v[46:47]
    v_pk_add_f32 v[32:33], v[32:33], v[48:49]
    v_pk_add_f32 v[34:35], v[34:35], v[50:51]
    v_pk_add_f32 v[32:33], v[32:33], v[40:41]
    v_pk_add_f32 v[34:35], v[34:35], v[42:43]
    buffer_store_dwordx4 v[32:35], v97, s[48:51], s12 offen sc1
    s_waitcnt lgkmcnt(10)
    v_pk_add_f32 v[52:53], v[52:53], v[56:57]
    v_pk_add_f32 v[60:61], v[60:61], v[64:65]
    v_pk_add_f32 v[54:55], v[54:55], v[58:59]
    v_pk_add_f32 v[62:63], v[62:63], v[66:67]
    v_pk_add_f32 v[52:53], v[52:53], v[68:69]
    v_pk_add_f32 v[54:55], v[54:55], v[70:71]
    v_pk_add_f32 v[52:53], v[52:53], v[60:61]
    v_pk_add_f32 v[54:55], v[54:55], v[62:63]
    buffer_store_dwordx4 v[52:55], v98, s[48:51], s12 offen sc1
    s_waitcnt lgkmcnt(5)
    v_pk_add_f32 v[72:73], v[72:73], v[76:77]
    v_pk_add_f32 v[80:81], v[80:81], v[84:85]
    v_pk_add_f32 v[74:75], v[74:75], v[78:79]
    v_pk_add_f32 v[82:83], v[82:83], v[86:87]
    v_pk_add_f32 v[72:73], v[72:73], v[88:89]
    v_pk_add_f32 v[74:75], v[74:75], v[90:91]
    v_pk_add_f32 v[72:73], v[72:73], v[80:81]
    v_pk_add_f32 v[74:75], v[74:75], v[82:83]
    buffer_store_dwordx4 v[72:75], v99, s[48:51], s12 offen sc1
    s_waitcnt lgkmcnt(0)
    v_pk_add_f32 v[132:133], v[132:133], v[136:137]
    v_pk_add_f32 v[140:141], v[140:141], v[144:145]
    v_pk_add_f32 v[134:135], v[134:135], v[138:139]
    v_pk_add_f32 v[142:143], v[142:143], v[146:147]
    v_pk_add_f32 v[132:133], v[132:133], v[148:149]
    v_pk_add_f32 v[134:135], v[134:135], v[150:151]
    v_pk_add_f32 v[132:133], v[132:133], v[140:141]
    v_pk_add_f32 v[134:135], v[134:135], v[142:143]
    buffer_store_dwordx4 v[132:135], v100, s[48:51], s12 offen sc1
    s_endpgm
L_k1_C:
    v_and_b32 v2, 15, v0
    v_lshrrev_b32 v3, 4, v1
    v_lshrrev_b32 v4, 3, v1
    v_and_b32 v5, 7, v0
    s_bfe_u32 s6, s2, 0x10002
    s_lshl_b32 s6, s6, 3
    s_bfe_u32 s11, s2, 0x30003
    s_add_u32 s6, s6, s11
    s_and_b32 s7, s2, 3
    s_lshl_b32 s7, s7, 1
    s_lshr_b32 s11, s2, 7
    s_add_u32 s7, s7, s11
    s_bfe_u32 s8, s2, 0x10006
    s_mov_b32 s13, 0xffff0000
    s_and_b32 s4, s3, 1
    s_bfe_u32 s5, s3, 0x10001
    s_lshl_b32 s9, s7, 7
    s_lshl_b32 s10, s7, 6
    s_add_u32 s10, s10, 1024
    s_cmp_eq_u32 s8, 0
    s_cselect_b32 s83, s9, s10
    v_mov_b32 v7, 0
    v_lshlrev_b32 v8, 2, v2
    v_add_u32 v8, 163712, v8
    ds_write2_b32 v8, v7, v7 offset1:16
    s_lshl_b32 s9, s3, 8
    s_add_u32 s9, s9, 162304
    v_mov_b32 v8, s9
    ds_write_b32 v8, v7
    s_mov_b32 m0, s9
    s_getpc_b64 s[56:57]
L_k1_tbC:
    s_add_u32 s56, s56, L_k1_tab-L_k1_tbC
    s_addc_u32 s57, s57, 0
    s_waitcnt lgkmcnt(0)
    s_barrier
    s_setprio 2
    s_mov_b64 s[48:49], s[16:17]
    s_mov_b64 s[50:51], s[32:33]
    s_mov_b64 s[52:53], s[46:47]
    v_lshrrev_b32 v6, 1, v2
    v_xor_b32 v6, v6, v3
    v_lshlrev_b32 v6, 4, v6
    v_lshl_add_u32 v11, v2, 7, v6
    s_lshl_b32 s9, s4, 13
    v_add_u32 v12, s9, v11
    v_xor_b32 v13, 64, v12
    v_lshrrev_b32 v6, 2, v2
    v_lshl_add_u32 v6, v3, 3, v6
    v_lshlrev_b32 v6, 7, v6
    v_and_b32 v7, 1, v3
    v_lshlrev_b32 v7, 1, v7
    v_lshrrev_b32 v8, 3, v2
    v_or_b32 v7, v7, v8
    v_lshl_add_u32 v6, v7, 5, v6
    v_and_b32 v7, 3, v2
    v_lshl_add_u32 v6, v7, 3, v6
    v_add_u32 v6, 16384, v6
    s_lshl_b32 s81, s6, 1
    s_add_u32 s81, s81, s4
    s_mov_b32 s76, 0
    s_mov_b32 s77, 0
    s_cmp_eq_u32 s8, 1
    s_cbranch_scc1 L_k1_CB
    s_lshl_b32 s9, s5, 14
    v_add_u32 v14, s9, v6
    v_xor_b32 v15, 32, v14
    v_xor_b32 v16, 64, v14
    v_xor_b32 v17, 96, v14
    s_lshr_b32 s9, s83, 5
    s_lshl_b32 s10, s5, 1
    s_add_u32 s9, s9, s10
    s_mul_i32 s10, s81, 88
    s_add_u32 s9, s9, s10
    s_lshl_b32 s80, s9, 12
    v_mov_b64 v[84:85], 0
    v_mov_b64 v[86:87], 0
    v_mov_b64 v[88:89], 0
    v_mov_b64 v[90:91], 0
    v_mov_b64 v[92:93], 0
    v_mov_b64 v[94:95], 0
    v_mov_b64 v[96:97], 0
    v_mov_b64 v[98:99], 0
    v_mov_b64 v[100:101], 0
    v_mov_b64 v[102:103], 0
    v_mov_b64 v[104:105], 0
    v_mov_b64 v[106:107], 0
    v_mov_b64 v[108:109], 0
    v_mov_b64 v[110:111], 0
    v_mov_b64 v[112:113], 0
    v_mov_b64 v[114:115], 0
    v_mov_b64 v[116:117], 0
    v_mov_b64 v[118:119], 0
    v_mov_b64 v[120:121], 0
    v_mov_b64 v[122:123], 0
    v_mov_b64 v[124:125], 0
    v_mov_b64 v[126:127], 0
    v_mov_b64 v[128:129], 0
    v_mov_b64 v[130:131], 0
    v_mov_b64 v[132:133], 0
    v_mov_b64 v[134:135], 0
    v_mov_b64 v[136:137], 0
    v_mov_b64 v[138:139], 0
    v_mov_b64 v[140:141], 0
    v_mov_b64 v[142:143], 0
    v_mov_b64 v[144:145], 0
    v_mov_b64 v[146:147], 0
    v_mov_b64 v[148:149], 0
    v_mov_b64 v[150:151], 0
    v_mov_b64 v[152:153], 0
    v_mov_b64 v[154:155], 0
    v_mov_b64 v[156:157], 0
    v_mov_b64 v[158:159], 0
    v_mov_b64 v[160:161], 0
    v_mov_b64 v[162:163], 0
    v_mov_b64 v[164:165], 0
    v_mov_b64 v[166:167], 0
    v_mov_b64 v[168:169], 0
    v_mov_b64 v[170:171], 0
    v_mov_b64 v[172:173], 0
    v_mov_b64 v[174:175], 0
    v_mov_b64 v[176:177], 0
    v_mov_b64 v[178:179], 0
    v_mov_b64 v[180:181], 0
    v_mov_b64 v[182:183], 0
    v_mov_b64 v[184:185], 0
    v_mov_b64 v[186:187], 0
    v_mov_b64 v[188:189], 0
    v_mov_b64 v[190:191], 0
    v_mov_b64 v[192:193], 0
    v_mov_b64 v[194:195], 0
    v_mov_b64 v[196:197], 0
    v_mov_b64 v[198:199], 0
    v_mov_b64 v[200:201], 0
    v_mov_b64 v[202:203], 0
    v_mov_b64 v[204:205], 0
    v_mov_b64 v[206:207], 0
    v_mov_b64 v[208:209], 0
    v_mov_b64 v[210:211], 0
    s_mov_b32 s60, s46
    s_mov_b32 s61, s47
    s_mov_b32 s62, 19922944
    s_mov_b32 s63, 0x20000
    v_mov_b32 v7, 163728
    v_mov_b32 v9, 0
    s_mov_b32 s14, 4294860800
    s_mov_b32 s15, 53248
L_k1_clA_sp:
    ds_read_b64 v[18:19], v7
    s_waitcnt lgkmcnt(0)
    v_min_u32 v18, v18, v19
    s_nop 0
    v_readfirstlane_b32 s78, v18
    s_nop 0
    s_cmp_gt_u32 s78, s76
    s_cbranch_scc0 L_k1_clA_sp
    s_cmp_lg_u32 s76, 0
    s_cbranch_scc1 L_k1_clA
    ds_read_b128 v[20:23], v12 offset:0
    ds_read_b128 v[24:27], v12 offset:2048
    ds_read_b64_tr_b16 v[52:53], v14 offset:0
    ds_read_b64_tr_b16 v[54:55], v14 offset:512
    ds_read_b128 v[28:31], v12 offset:4096
    ds_read_b128 v[32:35], v12 offset:6144
    ds_read_b64_tr_b16 v[56:57], v14 offset:8192
    ds_read_b64_tr_b16 v[58:59], v14 offset:8704
    ds_read_b64_tr_b16 v[60:61], v15 offset:0
    ds_read_b64_tr_b16 v[62:63], v15 offset:512
    ds_read_b64_tr_b16 v[64:65], v15 offset:8192
    ds_read_b64_tr_b16 v[66:67], v15 offset:8704
    ds_read_b64_tr_b16 v[68:69], v16 offset:0
    ds_read_b64_tr_b16 v[70:71], v16 offset:512
    s_branch L_k1_clA_mid
    .p2align 6
L_k1_clA:
    s_waitcnt lgkmcnt(9)
    v_mfma_f32_16x16x32_bf16 v[164:167], v[64:67], v[36:39], v[164:167]
    ds_read_b128 v[20:23], v12 offset:0
    v_mfma_f32_16x16x32_bf16 v[168:171], v[64:67], v[40:43], v[168:171]
    ds_read_b128 v[24:27], v12 offset:2048
    v_mfma_f32_16x16x32_bf16 v[172:175], v[64:67], v[44:47], v[172:175]
    ds_read_b64_tr_b16 v[52:53], v14 offset:0
    v_mfma_f32_16x16x32_bf16 v[176:179], v[64:67], v[48:51], v[176:179]
    ds_read_b64_tr_b16 v[54:55], v14 offset:512
    s_waitcnt lgkmcnt(11)
    v_mfma_f32_16x16x32_bf16 v[116:119], v[68:71], v[36:39], v[116:119]
    ds_read_b128 v[28:31], v12 offset:4096
    v_mfma_f32_16x16x32_bf16 v[120:123], v[68:71], v[40:43], v[120:123]
    ds_read_b128 v[32:35], v12 offset:6144
    v_mfma_f32_16x16x32_bf16 v[124:127], v[68:71], v[44:47], v[124:127]
    ds_read_b64_tr_b16 v[56:57], v14 offset:8192
    v_mfma_f32_16x16x32_bf16 v[128:131], v[68:71], v[48:51], v[128:131]
    ds_read_b64_tr_b16 v[58:59], v14 offset:8704
    s_waitcnt lgkmcnt(13)
    v_mfma_f32_16x16x32_bf16 v[180:183], v[72:75], v[36:39], v[180:183]
    ds_read_b64_tr_b16 v[60:61], v15 offset:0
    v_mfma_f32_16x16x32_bf16 v[184:187], v[72:75], v[40:43], v[184:187]
    ds_read_b64_tr_b16 v[62:63], v15 offset:512
    v_mfma_f32_16x16x32_bf16 v[188:191], v[72:75], v[44:47], v[188:191]
    s_waitcnt lgkmcnt(10)
    global_load_lds_dword v9, s[56:57]
    v_mfma_f32_16x16x32_bf16 v[192:195], v[72:75], v[48:51], v[192:195]
    v_mfma_f32_16x16x32_bf16 v[132:135], v[76:79], v[36:39], v[132:135]
    ds_read_b64_tr_b16 v[64:65], v15 offset:8192
    v_mfma_f32_16x16x32_bf16 v[136:139], v[76:79], v[40:43], v[136:139]
    ds_read_b64_tr_b16 v[66:67], v15 offset:8704
    v_mfma_f32_16x16x32_bf16 v[140:143], v[76:79], v[44:47], v[140:143]
    v_mfma_f32_16x16x32_bf16 v[144:147], v[76:79], v[48:51], v[144:147]
    v_mfma_f32_16x16x32_bf16 v[196:199], v[80:83], v[36:39], v[196:199]
    ds_read_b64_tr_b16 v[68:69], v16 offset:0
    v_mfma_f32_16x16x32_bf16 v[200:203], v[80:83], v[40:43], v[200:203]
    ds_read_b64_tr_b16 v[70:71], v16 offset:512
    v_mfma_f32_16x16x32_bf16 v[204:207], v[80:83], v[44:47], v[204:207]
    v_mfma_f32_16x16x32_bf16 v[208:211], v[80:83], v[48:51], v[208:211]
L_k1_clA_mid:
    s_waitcnt lgkmcnt(8)
    v_mfma_f32_16x16x32_bf16 v[84:87], v[52:55], v[20:23], v[84:87]
    ds_read_b64_tr_b16 v[72:73], v16 offset:8192
    s_add_u32 s77, s77, 1
    v_mfma_f32_16x16x32_bf16 v[88:91], v[52:55], v[24:27], v[88:91]
    ds_read_b64_tr_b16 v[74:75], v16 offset:8704
    s_cmp_eq_u32 s77, 3
    v_mfma_f32_16x16x32_bf16 v[92:95], v[52:55], v[28:31], v[92:95]
    ds_read_b128 v[36:39], v13 offset:0
    s_cselect_b32 s75, s14, s15
    v_mfma_f32_16x16x32_bf16 v[96:99], v[52:55], v[32:35], v[96:99]
    s_cselect_b32 s77, 0, s77
    s_waitcnt lgkmcnt(9)
    v_mfma_f32_16x16x32_bf16 v[148:151], v[56:59], v[20:23], v[148:151]
    ds_read_b64_tr_b16 v[76:77], v17 offset:0
    s_add_u32 s76, s76, 1
    v_mfma_f32_16x16x32_bf16 v[152:155], v[56:59], v[24:27], v[152:155]
    ds_read_b64_tr_b16 v[78:79], v17 offset:512
    v_add_u32 v9, 4, v9
    v_mfma_f32_16x16x32_bf16 v[156:159], v[56:59], v[28:31], v[156:159]
    ds_read_b128 v[40:43], v13 offset:2048
    v_mfma_f32_16x16x32_bf16 v[160:163], v[56:59], v[32:35], v[160:163]
    s_waitcnt lgkmcnt(10)
    v_mfma_f32_16x16x32_bf16 v[100:103], v[60:63], v[20:23], v[100:103]
    ds_read_b64_tr_b16 v[80:81], v17 offset:8192
    v_mfma_f32_16x16x32_bf16 v[104:107], v[60:63], v[24:27], v[104:107]
    ds_read_b64_tr_b16 v[82:83], v17 offset:8704
    v_mfma_f32_16x16x32_bf16 v[108:111], v[60:63], v[28:31], v[108:111]
    ds_read_b128 v[44:47], v13 offset:4096
    v_mfma_f32_16x16x32_bf16 v[112:115], v[60:63], v[32:35], v[112:115]
    s_waitcnt lgkmcnt(11)
    v_mfma_f32_16x16x32_bf16 v[164:167], v[64:67], v[20:23], v[164:167]
    ds_read_b64_tr_b16 v[52:53], v14 offset:4096
    v_mfma_f32_16x16x32_bf16 v[168:171], v[64:67], v[24:27], v[168:171]
    ds_read_b64_tr_b16 v[54:55], v14 offset:4608
    v_mfma_f32_16x16x32_bf16 v[172:175], v[64:67], v[28:31], v[172:175]
    ds_read_b128 v[48:51], v13 offset:6144
    v_mfma_f32_16x16x32_bf16 v[176:179], v[64:67], v[32:35], v[176:179]
    s_waitcnt lgkmcnt(12)
    v_mfma_f32_16x16x32_bf16 v[116:119], v[68:71], v[20:23], v[116:119]
    ds_read_b64_tr_b16 v[56:57], v14 offset:12288
    v_mfma_f32_16x16x32_bf16 v[120:123], v[68:71], v[24:27], v[120:123]
    ds_read_b64_tr_b16 v[58:59], v14 offset:12800
    v_mfma_f32_16x16x32_bf16 v[124:127], v[68:71], v[28:31], v[124:127]
    v_add_u32 v12, s75, v12
    v_add_u32 v14, s75, v14
    v_mfma_f32_16x16x32_bf16 v[128:131], v[68:71], v[32:35], v[128:131]
    s_waitcnt lgkmcnt(12)
    v_mfma_f32_16x16x32_bf16 v[180:183], v[72:75], v[20:23], v[180:183]
    ds_read_b64_tr_b16 v[60:61], v15 offset:4096
    v_mfma_f32_16x16x32_bf16 v[184:187], v[72:75], v[24:27], v[184:187]
    ds_read_b64_tr_b16 v[62:63], v15 offset:4608
    v_mfma_f32_16x16x32_bf16 v[188:191], v[72:75], v[28:31], v[188:191]
    s_waitcnt lgkmcnt(4)
    global_load_lds_dword v9, s[56:57]
    v_mfma_f32_16x16x32_bf16 v[192:195], v[72:75], v[32:35], v[192:195]
    v_mfma_f32_16x16x32_bf16 v[132:135], v[76:79], v[20:23], v[132:135]
    ds_read_b64_tr_b16 v[64:65], v15 offset:12288
    v_mfma_f32_16x16x32_bf16 v[136:139], v[76:79], v[24:27], v[136:139]
    ds_read_b64_tr_b16 v[66:67], v15 offset:12800
    v_mfma_f32_16x16x32_bf16 v[140:143], v[76:79], v[28:31], v[140:143]
    v_add_u32 v9, 4, v9
    v_add_u32 v15, s75, v15
    v_mfma_f32_16x16x32_bf16 v[144:147], v[76:79], v[32:35], v[144:147]
    v_mfma_f32_16x16x32_bf16 v[196:199], v[80:83], v[20:23], v[196:199]
    ds_read_b64_tr_b16 v[68:69], v16 offset:4096
    v_mfma_f32_16x16x32_bf16 v[200:203], v[80:83], v[24:27], v[200:203]
    ds_read_b64_tr_b16 v[70:71], v16 offset:4608
    v_mfma_f32_16x16x32_bf16 v[204:207], v[80:83], v[28:31], v[204:207]
    v_add_u32 v13, s75, v13
    v_mfma_f32_16x16x32_bf16 v[208:211], v[80:83], v[32:35], v[208:211]
    v_mfma_f32_16x16x32_bf16 v[84:87], v[52:55], v[36:39], v[84:87]
    ds_read_b64_tr_b16 v[72:73], v16 offset:12288
    v_mfma_f32_16x16x32_bf16 v[88:91], v[52:55], v[40:43], v[88:91]
    ds_read_b64_tr_b16 v[74:75], v16 offset:12800
    v_mfma_f32_16x16x32_bf16 v[92:95], v[52:55], v[44:47], v[92:95]
    ds_read_b64 v[18:19], v7
    v_add_u32 v16, s75, v16
    v_mfma_f32_16x16x32_bf16 v[96:99], v[52:55], v[48:51], v[96:99]
    s_waitcnt lgkmcnt(9)
    v_mfma_f32_16x16x32_bf16 v[148:151], v[56:59], v[36:39], v[148:151]
    ds_read_b64_tr_b16 v[76:77], v17 offset:4096
    v_mfma_f32_16x16x32_bf16 v[152:155], v[56:59], v[40:43], v[152:155]
    ds_read_b64_tr_b16 v[78:79], v17 offset:4608
    v_mfma_f32_16x16x32_bf16 v[156:159], v[56:59], v[44:47], v[156:159]
    s_waitcnt lgkmcnt(2)
    v_min_u32 v18, v18, v19
    v_mfma_f32_16x16x32_bf16 v[160:163], v[56:59], v[48:51], v[160:163]
    v_readfirstlane_b32 s78, v18
    v_mfma_f32_16x16x32_bf16 v[100:103], v[60:63], v[36:39], v[100:103]
    ds_read_b64_tr_b16 v[80:81], v17 offset:12288
    v_mfma_f32_16x16x32_bf16 v[104:107], v[60:63], v[40:43], v[104:107]
    ds_read_b64_tr_b16 v[82:83], v17 offset:12800
    v_mfma_f32_16x16x32_bf16 v[108:111], v[60:63], v[44:47], v[108:111]
    s_cmp_gt_u32 s78, s76
    v_add_u32 v17, s75, v17
    v_mfma_f32_16x16x32_bf16 v[112:115], v[60:63], v[48:51], v[112:115]
    s_cbranch_scc1 L_k1_clA
    s_cmp_lt_u32 s76, 10
    s_cbranch_scc1 L_k1_clA_sp
    ds_read_b64 v[18:19], v7 offset:8
    s_waitcnt lgkmcnt(6)
    v_mfma_f32_16x16x32_bf16 v[164:167], v[64:67], v[36:39], v[164:167]
    v_mfma_f32_16x16x32_bf16 v[168:171], v[64:67], v[40:43], v[168:171]
    v_mfma_f32_16x16x32_bf16 v[172:175], v[64:67], v[44:47], v[172:175]
    v_mfma_f32_16x16x32_bf16 v[176:179], v[64:67], v[48:51], v[176:179]
    s_waitcnt lgkmcnt(0)
    global_load_lds_dword v9, s[56:57]
    s_branch L_k1_clA_ec
L_k1_clA_es:
    ds_read_b64 v[18:19], v7 offset:8
L_k1_clA_ec:
    s_waitcnt lgkmcnt(0)
    v_min_u32 v18, v18, v19
    s_nop 0
    v_readfirstlane_b32 s82, v18
    s_nop 0
    s_cmp_eq_u32 s82, 0
    s_cbranch_scc1 L_k1_clA_es
    s_lshl_b32 s9, s5, 9
    s_add_u32 s9, s9, 161280
    v_lshl_add_u32 v7, v3, 4, s9
    s_mul_i32 s9, s4, 768
    s_add_u32 s9, s9, 159744
    v_lshl_add_u32 v8, v2, 2, s9
    v_mfma_f32_16x16x32_bf16 v[116:119], v[68:71], v[36:39], v[116:119]
    ds_read2_b32 v[20:21], v8 offset0:0 offset1:16
    v_mfma_f32_16x16x32_bf16 v[120:123], v[68:71], v[40:43], v[120:123]
    ds_read2_b32 v[24:25], v8 offset0:64 offset1:80
    v_mfma_f32_16x16x32_bf16 v[124:127], v[68:71], v[44:47], v[124:127]
    ds_read2_b32 v[28:29], v8 offset0:128 offset1:144
    v_mfma_f32_16x16x32_bf16 v[128:131], v[68:71], v[48:51], v[128:131]
    ds_read2_b32 v[22:23], v8 offset0:32 offset1:48
    v_mfma_f32_16x16x32_bf16 v[180:183], v[72:75], v[36:39], v[180:183]
    ds_read2_b32 v[26:27], v8 offset0:96 offset1:112
    v_mfma_f32_16x16x32_bf16 v[184:187], v[72:75], v[40:43], v[184:187]
    ds_read2_b32 v[30:31], v8 offset0:160 offset1:176
    v_mfma_f32_16x16x32_bf16 v[188:191], v[72:75], v[44:47], v[188:191]
    ds_read_b128 v[212:215], v7 offset:0
    v_mfma_f32_16x16x32_bf16 v[192:195], v[72:75], v[48:51], v[192:195]
    ds_read_b128 v[216:219], v7 offset:64
    v_mfma_f32_16x16x32_bf16 v[132:135], v[76:79], v[36:39], v[132:135]
    ds_read_b128 v[220:223], v7 offset:128
    v_mfma_f32_16x16x32_bf16 v[136:139], v[76:79], v[40:43], v[136:139]
    ds_read_b128 v[224:227], v7 offset:192
    v_mfma_f32_16x16x32_bf16 v[140:143], v[76:79], v[44:47], v[140:143]
    ds_read_b128 v[228:231], v7 offset:256
    v_mfma_f32_16x16x32_bf16 v[144:147], v[76:79], v[48:51], v[144:147]
    ds_read_b128 v[232:235], v7 offset:320
    v_mfma_f32_16x16x32_bf16 v[196:199], v[80:83], v[36:39], v[196:199]
    ds_read_b128 v[236:239], v7 offset:384
    v_mfma_f32_16x16x32_bf16 v[200:203], v[80:83], v[40:43], v[200:203]
    ds_read_b128 v[240:243], v7 offset:448
    v_mfma_f32_16x16x32_bf16 v[204:207], v[80:83], v[44:47], v[204:207]
    v_lshlrev_b32 v9, 4, v1
    v_mfma_f32_16x16x32_bf16 v[208:211], v[80:83], v[48:51], v[208:211]
    v_mov_b32 v32, 0xbdd2d3e8
    v_mov_b32 v33, 0xc0135761
    s_waitcnt lgkmcnt(0)
    v_pk_fma_f32 v[84:85], v[20:21], v[212:213], v[84:85] op_sel:[0,0,0] op_sel_hi:[0,1,1] neg_lo:[1,0,0] neg_hi:[1,0,0]
    v_pk_fma_f32 v[86:87], v[20:21], v[214:215], v[86:87] op_sel:[0,0,0] op_sel_hi:[0,1,1] neg_lo:[1,0,0] neg_hi:[1,0,0]
    v_pk_fma_f32 v[100:101], v[20:21], v[216:217], v[100:101] op_sel:[0,0,0] op_sel_hi:[0,1,1] neg_lo:[1,0,0] neg_hi:[1,0,0]
    v_pk_fma_f32 v[102:103], v[20:21], v[218:219], v[102:103] op_sel:[0,0,0] op_sel_hi:[0,1,1] neg_lo:[1,0,0] neg_hi:[1,0,0]
    v_pk_mul_f32 v[84:85], v[24:25], v[84:85] op_sel:[0,0] op_sel_hi:[0,1]
    v_pk_mul_f32 v[86:87], v[24:25], v[86:87] op_sel:[0,0] op_sel_hi:[0,1]
    v_pk_mul_f32 v[100:101], v[24:25], v[100:101] op_sel:[0,0] op_sel_hi:[0,1]
    v_pk_mul_f32 v[102:103], v[24:25], v[102:103] op_sel:[0,0] op_sel_hi:[0,1]
    v_pk_mul_f32 v[244:245], v[84:85], v[84:85]
    v_pk_mul_f32 v[246:247], v[86:87], v[86:87]
    v_pk_mul_f32 v[248:249], v[100:101], v[100:101]
    v_pk_mul_f32 v[250:251], v[102:103], v[102:103]
    v_pk_fma_f32 v[244:245], v[244:245], v[32:33], v[32:33] op_sel:[0,0,1] op_sel_hi:[1,0,1]
    v_pk_fma_f32 v[246:247], v[246:247], v[32:33], v[32:33] op_sel:[0,0,1] op_sel_hi:[1,0,1]
    v_pk_fma_f32 v[248:249], v[248:249], v[32:33], v[32:33] op_sel:[0,0,1] op_sel_hi:[1,0,1]
    v_pk_fma_f32 v[250:251], v[250:251], v[32:33], v[32:33] op_sel:[0,0,1] op_sel_hi:[1,0,1]
    v_pk_mul_f32 v[244:245], v[244:245], v[84:85]
    v_pk_mul_f32 v[246:247], v[246:247], v[86:87]
    v_pk_mul_f32 v[248:249], v[248:249], v[100:101]
    v_pk_mul_f32 v[250:251], v[250:251], v[102:103]
    v_exp_f32 v244, v244
    v_exp_f32 v245, v245
    v_pk_fma_f32 v[148:149], v[20:21], v[228:229], v[148:149] op_sel:[0,0,0] op_sel_hi:[0,1,1] neg_lo:[1,0,0] neg_hi:[1,0,0]
    v_exp_f32 v246, v246
    v_exp_f32 v247, v247
    v_pk_fma_f32 v[150:151], v[20:21], v[230:231], v[150:151] op_sel:[0,0,0] op_sel_hi:[0,1,1] neg_lo:[1,0,0] neg_hi:[1,0,0]
    v_exp_f32 v248, v248
    v_exp_f32 v249, v249
    v_pk_fma_f32 v[164:165], v[20:21], v[232:233], v[164:165] op_sel:[0,0,0] op_sel_hi:[0,1,1] neg_lo:[1,0,0] neg_hi:[1,0,0]
    v_exp_f32 v250, v250
    v_exp_f32 v251, v251
    v_pk_fma_f32 v[166:167], v[20:21], v[234:235], v[166:167] op_sel:[0,0,0] op_sel_hi:[0,1,1] neg_lo:[1,0,0] neg_hi:[1,0,0]
    v_pk_fma_f32 v[244:245], v[244:245], v[28:29], v[28:29] op_sel:[0,0,0] op_sel_hi:[1,0,0]
    v_pk_fma_f32 v[246:247], v[246:247], v[28:29], v[28:29] op_sel:[0,0,0] op_sel_hi:[1,0,0]
    v_pk_fma_f32 v[248:249], v[248:249], v[28:29], v[28:29] op_sel:[0,0,0] op_sel_hi:[1,0,0]
    v_pk_fma_f32 v[250:251], v[250:251], v[28:29], v[28:29] op_sel:[0,0,0] op_sel_hi:[1,0,0]
    v_rcp_f32 v244, v244
    v_rcp_f32 v245, v245
    v_pk_mul_f32 v[84:85], v[84:85], v[148:149]
    v_rcp_f32 v246, v246
    v_rcp_f32 v247, v247
    v_pk_mul_f32 v[86:87], v[86:87], v[150:151]
    v_rcp_f32 v248, v248
    v_rcp_f32 v249, v249
    v_pk_mul_f32 v[100:101], v[100:101], v[164:165]
    v_rcp_f32 v250, v250
    v_rcp_f32 v251, v251
    v_pk_mul_f32 v[102:103], v[102:103], v[166:167]
    v_pk_mul_f32 v[84:85], v[84:85], v[244:245]
    v_pk_mul_f32 v[86:87], v[86:87], v[246:247]
    v_pk_mul_f32 v[100:101], v[100:101], v[248:249]
    v_pk_mul_f32 v[102:103], v[102:103], v[250:251]
    v_cvt_pk_bf16_f32 v36, v84, v85
    v_cvt_pk_bf16_f32 v37, v86, v87
    v_cvt_pk_bf16_f32 v38, v100, v101
    v_cvt_pk_bf16_f32 v39, v102, v103
    buffer_store_dwordx4 v[36:39], v9, s[60:63], s80 offen offset:0 sc1
    v_pk_fma_f32 v[88:89], v[20:21], v[212:213], v[88:89] op_sel:[1,0,0] op_sel_hi:[1,1,1] neg_lo:[1,0,0] neg_hi:[1,0,0]
    v_pk_fma_f32 v[90:91], v[20:21], v[214:215], v[90:91] op_sel:[1,0,0] op_sel_hi:[1,1,1] neg_lo:[1,0,0] neg_hi:[1,0,0]
    v_pk_fma_f32 v[104:105], v[20:21], v[216:217], v[104:105] op_sel:[1,0,0] op_sel_hi:[1,1,1] neg_lo:[1,0,0] neg_hi:[1,0,0]
    v_pk_fma_f32 v[106:107], v[20:21], v[218:219], v[106:107] op_sel:[1,0,0] op_sel_hi:[1,1,1] neg_lo:[1,0,0] neg_hi:[1,0,0]
    v_pk_mul_f32 v[88:89], v[24:25], v[88:89] op_sel:[1,0] op_sel_hi:[1,1]
    v_pk_mul_f32 v[90:91], v[24:25], v[90:91] op_sel:[1,0] op_sel_hi:[1,1]
    v_pk_mul_f32 v[104:105], v[24:25], v[104:105] op_sel:[1,0] op_sel_hi:[1,1]
    v_pk_mul_f32 v[106:107], v[24:25], v[106:107] op_sel:[1,0] op_sel_hi:[1,1]
    v_pk_mul_f32 v[244:245], v[88:89], v[88:89]
    v_pk_mul_f32 v[246:247], v[90:91], v[90:91]
    v_pk_mul_f32 v[248:249], v[104:105], v[104:105]
    v_pk_mul_f32 v[250:251], v[106:107], v[106:107]
    v_pk_fma_f32 v[244:245], v[244:245], v[32:33], v[32:33] op_sel:[0,0,1] op_sel_hi:[1,0,1]
    v_pk_fma_f32 v[246:247], v[246:247], v[32:33], v[32:33] op_sel:[0,0,1] op_sel_hi:[1,0,1]
    v_pk_fma_f32 v[248:249], v[248:249], v[32:33], v[32:33] op_sel:[0,0,1] op_sel_hi:[1,0,1]
    v_pk_fma_f32 v[250:251], v[250:251], v[32:33], v[32:33] op_sel:[0,0,1] op_sel_hi:[1,0,1]
    v_pk_mul_f32 v[244:245], v[244:245], v[88:89]
    v_pk_mul_f32 v[246:247], v[246:247], v[90:91]
    v_pk_mul_f32 v[248:249], v[248:249], v[104:105]
    v_pk_mul_f32 v[250:251], v[250:251], v[106:107]
    v_exp_f32 v244, v244
    v_exp_f32 v245, v245
    v_pk_fma_f32 v[152:153], v[20:21], v[228:229], v[152:153] op_sel:[1,0,0] op_sel_hi:[1,1,1] neg_lo:[1,0,0] neg_hi:[1,0,0]
    v_exp_f32 v246, v246
    v_exp_f32 v247, v247
    v_pk_fma_f32 v[154:155], v[20:21], v[230:231], v[154:155] op_sel:[1,0,0] op_sel_hi:[1,1,1] neg_lo:[1,0,0] neg_hi:[1,0,0]
    v_exp_f32 v248, v248
    v_exp_f32 v249, v249
    v_pk_fma_f32 v[168:169], v[20:21], v[232:233], v[168:169] op_sel:[1,0,0] op_sel_hi:[1,1,1] neg_lo:[1,0,0] neg_hi:[1,0,0]
    v_exp_f32 v250, v250
    v_exp_f32 v251, v251
    v_pk_fma_f32 v[170:171], v[20:21], v[234:235], v[170:171] op_sel:[1,0,0] op_sel_hi:[1,1,1] neg_lo:[1,0,0] neg_hi:[1,0,0]
    v_pk_fma_f32 v[244:245], v[244:245], v[28:29], v[28:29] op_sel:[0,1,1] op_sel_hi:[1,1,1]
    v_pk_fma_f32 v[246:247], v[246:247], v[28:29], v[28:29] op_sel:[0,1,1] op_sel_hi:[1,1,1]
    v_pk_fma_f32 v[248:249], v[248:249], v[28:29], v[28:29] op_sel:[0,1,1] op_sel_hi:[1,1,1]
    v_pk_fma_f32 v[250:251], v[250:251], v[28:29], v[28:29] op_sel:[0,1,1] op_sel_hi:[1,1,1]
    v_rcp_f32 v244, v244
    v_rcp_f32 v245, v245
    v_pk_mul_f32 v[88:89], v[88:89], v[152:153]
    v_rcp_f32 v246, v246
    v_rcp_f32 v247, v247
    v_pk_mul_f32 v[90:91], v[90:91], v[154:155]
    v_rcp_f32 v248, v248
    v_rcp_f32 v249, v249
    v_pk_mul_f32 v[104:105], v[104:105], v[168:169]
    v_rcp_f32 v250, v250
    v_rcp_f32 v251, v251
    v_pk_mul_f32 v[106:107], v[106:107], v[170:171]
    v_pk_mul_f32 v[88:89], v[88:89], v[244:245]
    v_pk_mul_f32 v[90:91], v[90:91], v[246:247]
    v_pk_mul_f32 v[104:105], v[104:105], v[248:249]
    v_pk_mul_f32 v[106:107], v[106:107], v[250:251]
    v_cvt_pk_bf16_f32 v40, v88, v89
    v_cvt_pk_bf16_f32 v41, v90, v91
    v_cvt_pk_bf16_f32 v42, v104, v105
    v_cvt_pk_bf16_f32 v43, v106, v107
    buffer_store_dwordx4 v[40:43], v9, s[60:63], s80 offen offset:1024 sc1
    v_pk_fma_f32 v[92:93], v[22:23], v[212:213], v[92:93] op_sel:[0,0,0] op_sel_hi:[0,1,1] neg_lo:[1,0,0] neg_hi:[1,0,0]
    v_pk_fma_f32 v[94:95], v[22:23], v[214:215], v[94:95] op_sel:[0,0,0] op_sel_hi:[0,1,1] neg_lo:[1,0,0] neg_hi:[1,0,0]
    v_pk_fma_f32 v[108:109], v[22:23], v[216:217], v[108:109] op_sel:[0,0,0] op_sel_hi:[0,1,1] neg_lo:[1,0,0] neg_hi:[1,0,0]
    v_pk_fma_f32 v[110:111], v[22:23], v[218:219], v[110:111] op_sel:[0,0,0] op_sel_hi:[0,1,1] neg_lo:[1,0,0] neg_hi:[1,0,0]
    v_pk_mul_f32 v[92:93], v[26:27], v[92:93] op_sel:[0,0] op_sel_hi:[0,1]
    v_pk_mul_f32 v[94:95], v[26:27], v[94:95] op_sel:[0,0] op_sel_hi:[0,1]
    v_pk_mul_f32 v[108:109], v[26:27], v[108:109] op_sel:[0,0] op_sel_hi:[0,1]
    v_pk_mul_f32 v[110:111], v[26:27], v[110:111] op_sel:[0,0] op_sel_hi:[0,1]
    v_pk_mul_f32 v[244:245], v[92:93], v[92:93]
    v_pk_mul_f32 v[246:247], v[94:95], v[94:95]
    v_pk_mul_f32 v[248:249], v[108:109], v[108:109]
    v_pk_mul_f32 v[250:251], v[110:111], v[110:111]
    v_pk_fma_f32 v[244:245], v[244:245], v[32:33], v[32:33] op_sel:[0,0,1] op_sel_hi:[1,0,1]
    v_pk_fma_f32 v[246:247], v[246:247], v[32:33], v[32:33] op_sel:[0,0,1] op_sel_hi:[1,0,1]
    v_pk_fma_f32 v[248:249], v[248:249], v[32:33], v[32:33] op_sel:[0,0,1] op_sel_hi:[1,0,1]
    v_pk_fma_f32 v[250:251], v[250:251], v[32:33], v[32:33] op_sel:[0,0,1] op_sel_hi:[1,0,1]
    v_pk_mul_f32 v[244:245], v[244:245], v[92:93]
    v_pk_mul_f32 v[246:247], v[246:247], v[94:95]
    v_pk_mul_f32 v[248:249], v[248:249], v[108:109]
    v_pk_mul_f32 v[250:251], v[250:251], v[110:111]
    v_exp_f32 v244, v244
    v_exp_f32 v245, v245
    v_pk_fma_f32 v[156:157], v[22:23], v[228:229], v[156:157] op_sel:[0,0,0] op_sel_hi:[0,1,1] neg_lo:[1,0,0] neg_hi:[1,0,0]
    v_exp_f32 v246, v246
    v_exp_f32 v247, v247
    v_pk_fma_f32 v[158:159], v[22:23], v[230:231], v[158:159] op_sel:[0,0,0] op_sel_hi:[0,1,1] neg_lo:[1,0,0] neg_hi:[1,0,0]
    v_exp_f32 v248, v248
    v_exp_f32 v249, v249
    v_pk_fma_f32 v[172:173], v[22:23], v[232:233], v[172:173] op_sel:[0,0,0] op_sel_hi:[0,1,1] neg_lo:[1,0,0] neg_hi:[1,0,0]
    v_exp_f32 v250, v250
    v_exp_f32 v251, v251
    v_pk_fma_f32 v[174:175], v[22:23], v[234:235], v[174:175] op_sel:[0,0,0] op_sel_hi:[0,1,1] neg_lo:[1,0,0] neg_hi:[1,0,0]
    v_pk_fma_f32 v[244:245], v[244:245], v[30:31], v[30:31] op_sel:[0,0,0] op_sel_hi:[1,0,0]
    v_pk_fma_f32 v[246:247], v[246:247], v[30:31], v[30:31] op_sel:[0,0,0] op_sel_hi:[1,0,0]
    v_pk_fma_f32 v[248:249], v[248:249], v[30:31], v[30:31] op_sel:[0,0,0] op_sel_hi:[1,0,0]
    v_pk_fma_f32 v[250:251], v[250:251], v[30:31], v[30:31] op_sel:[0,0,0] op_sel_hi:[1,0,0]
    v_rcp_f32 v244, v244
    v_rcp_f32 v245, v245
    v_pk_mul_f32 v[92:93], v[92:93], v[156:157]
    v_rcp_f32 v246, v246
    v_rcp_f32 v247, v247
    v_pk_mul_f32 v[94:95], v[94:95], v[158:159]
    v_rcp_f32 v248, v248
    v_rcp_f32 v249, v249
    v_pk_mul_f32 v[108:109], v[108:109], v[172:173]
    v_rcp_f32 v250, v250
    v_rcp_f32 v251, v251
    v_pk_mul_f32 v[110:111], v[110:111], v[174:175]
    v_pk_mul_f32 v[92:93], v[92:93], v[244:245]
    v_pk_mul_f32 v[94:95], v[94:95], v[246:247]
    v_pk_mul_f32 v[108:109], v[108:109], v[248:249]
    v_pk_mul_f32 v[110:111], v[110:111], v[250:251]
    v_cvt_pk_bf16_f32 v36, v92, v93
    v_cvt_pk_bf16_f32 v37, v94, v95
    v_cvt_pk_bf16_f32 v38, v108, v109
    v_cvt_pk_bf16_f32 v39, v110, v111
    buffer_store_dwordx4 v[36:39], v9, s[60:63], s80 offen offset:2048 sc1
    v_pk_fma_f32 v[96:97], v[22:23], v[212:213], v[96:97] op_sel:[1,0,0] op_sel_hi:[1,1,1] neg_lo:[1,0,0] neg_hi:[1,0,0]
    v_pk_fma_f32 v[98:99], v[22:23], v[214:215], v[98:99] op_sel:[1,0,0] op_sel_hi:[1,1,1] neg_lo:[1,0,0] neg_hi:[1,0,0]
    v_pk_fma_f32 v[112:113], v[22:23], v[216:217], v[112:113] op_sel:[1,0,0] op_sel_hi:[1,1,1] neg_lo:[1,0,0] neg_hi:[1,0,0]
    v_pk_fma_f32 v[114:115], v[22:23], v[218:219], v[114:115] op_sel:[1,0,0] op_sel_hi:[1,1,1] neg_lo:[1,0,0] neg_hi:[1,0,0]
    v_pk_mul_f32 v[96:97], v[26:27], v[96:97] op_sel:[1,0] op_sel_hi:[1,1]
    v_pk_mul_f32 v[98:99], v[26:27], v[98:99] op_sel:[1,0] op_sel_hi:[1,1]
    v_pk_mul_f32 v[112:113], v[26:27], v[112:113] op_sel:[1,0] op_sel_hi:[1,1]
    v_pk_mul_f32 v[114:115], v[26:27], v[114:115] op_sel:[1,0] op_sel_hi:[1,1]
    v_pk_mul_f32 v[244:245], v[96:97], v[96:97]
    v_pk_mul_f32 v[246:247], v[98:99], v[98:99]
    v_pk_mul_f32 v[248:249], v[112:113], v[112:113]
    v_pk_mul_f32 v[250:251], v[114:115], v[114:115]
    v_pk_fma_f32 v[244:245], v[244:245], v[32:33], v[32:33] op_sel:[0,0,1] op_sel_hi:[1,0,1]
    v_pk_fma_f32 v[246:247], v[246:247], v[32:33], v[32:33] op_sel:[0,0,1] op_sel_hi:[1,0,1]
    v_pk_fma_f32 v[248:249], v[248:249], v[32:33], v[32:33] op_sel:[0,0,1] op_sel_hi:[1,0,1]
    v_pk_fma_f32 v[250:251], v[250:251], v[32:33], v[32:33] op_sel:[0,0,1] op_sel_hi:[1,0,1]
    v_pk_mul_f32 v[244:245], v[244:245], v[96:97]
    v_pk_mul_f32 v[246:247], v[246:247], v[98:99]
    v_pk_mul_f32 v[248:249], v[248:249], v[112:113]
    v_pk_mul_f32 v[250:251], v[250:251], v[114:115]
    v_exp_f32 v244, v244
    v_exp_f32 v245, v245
    v_pk_fma_f32 v[160:161], v[22:23], v[228:229], v[160:161] op_sel:[1,0,0] op_sel_hi:[1,1,1] neg_lo:[1,0,0] neg_hi:[1,0,0]
    v_exp_f32 v246, v246
    v_exp_f32 v247, v247
    v_pk_fma_f32 v[162:163], v[22:23], v[230:231], v[162:163] op_sel:[1,0,0] op_sel_hi:[1,1,1] neg_lo:[1,0,0] neg_hi:[1,0,0]
    v_exp_f32 v248, v248
    v_exp_f32 v249, v249
    v_pk_fma_f32 v[176:177], v[22:23], v[232:233], v[176:177] op_sel:[1,0,0] op_sel_hi:[1,1,1] neg_lo:[1,0,0] neg_hi:[1,0,0]
    v_exp_f32 v250, v250
    v_exp_f32 v251, v251
    v_pk_fma_f32 v[178:179], v[22:23], v[234:235], v[178:179] op_sel:[1,0,0] op_sel_hi:[1,1,1] neg_lo:[1,0,0] neg_hi:[1,0,0]
    v_pk_fma_f32 v[244:245], v[244:245], v[30:31], v[30:31] op_sel:[0,1,1] op_sel_hi:[1,1,1]
    v_pk_fma_f32 v[246:247], v[246:247], v[30:31], v[30:31] op_sel:[0,1,1] op_sel_hi:[1,1,1]
    v_pk_fma_f32 v[248:249], v[248:249], v[30:31], v[30:31] op_sel:[0,1,1] op_sel_hi:[1,1,1]
    v_pk_fma_f32 v[250:251], v[250:251], v[30:31], v[30:31] op_sel:[0,1,1] op_sel_hi:[1,1,1]
    v_rcp_f32 v244, v244
    v_rcp_f32 v245, v245
    v_pk_mul_f32 v[96:97], v[96:97], v[160:161]
    v_rcp_f32 v246, v246
    v_rcp_f32 v247, v247
    v_pk_mul_f32 v[98:99], v[98:99], v[162:163]
    v_rcp_f32 v248, v248
    v_rcp_f32 v249, v249
    v_pk_mul_f32 v[112:113], v[112:113], v[176:177]
    v_rcp_f32 v250, v250
    v_rcp_f32 v251, v251
    v_pk_mul_f32 v[114:115], v[114:115], v[178:179]
    v_pk_mul_f32 v[96:97], v[96:97], v[244:245]
    v_pk_mul_f32 v[98:99], v[98:99], v[246:247]
    v_pk_mul_f32 v[112:113], v[112:113], v[248:249]
    v_pk_mul_f32 v[114:115], v[114:115], v[250:251]
    v_cvt_pk_bf16_f32 v40, v96, v97
    v_cvt_pk_bf16_f32 v41, v98, v99
    v_cvt_pk_bf16_f32 v42, v112, v113
    v_cvt_pk_bf16_f32 v43, v114, v115
    buffer_store_dwordx4 v[40:43], v9, s[60:63], s80 offen offset:3072 sc1
    v_pk_fma_f32 v[116:117], v[20:21], v[220:221], v[116:117] op_sel:[0,0,0] op_sel_hi:[0,1,1] neg_lo:[1,0,0] neg_hi:[1,0,0]
    v_pk_fma_f32 v[118:119], v[20:21], v[222:223], v[118:119] op_sel:[0,0,0] op_sel_hi:[0,1,1] neg_lo:[1,0,0] neg_hi:[1,0,0]
    v_pk_fma_f32 v[132:133], v[20:21], v[224:225], v[132:133] op_sel:[0,0,0] op_sel_hi:[0,1,1] neg_lo:[1,0,0] neg_hi:[1,0,0]
    v_pk_fma_f32 v[134:135], v[20:21], v[226:227], v[134:135] op_sel:[0,0,0] op_sel_hi:[0,1,1] neg_lo:[1,0,0] neg_hi:[1,0,0]
    v_pk_mul_f32 v[116:117], v[24:25], v[116:117] op_sel:[0,0] op_sel_hi:[0,1]
    v_pk_mul_f32 v[118:119], v[24:25], v[118:119] op_sel:[0,0] op_sel_hi:[0,1]
    v_pk_mul_f32 v[132:133], v[24:25], v[132:133] op_sel:[0,0] op_sel_hi:[0,1]
    v_pk_mul_f32 v[134:135], v[24:25], v[134:135] op_sel:[0,0] op_sel_hi:[0,1]
    v_pk_mul_f32 v[244:245], v[116:117], v[116:117]
    v_pk_mul_f32 v[246:247], v[118:119], v[118:119]
    v_pk_mul_f32 v[248:249], v[132:133], v[132:133]
    v_pk_mul_f32 v[250:251], v[134:135], v[134:135]
    v_pk_fma_f32 v[244:245], v[244:245], v[32:33], v[32:33] op_sel:[0,0,1] op_sel_hi:[1,0,1]
    v_pk_fma_f32 v[246:247], v[246:247], v[32:33], v[32:33] op_sel:[0,0,1] op_sel_hi:[1,0,1]
    v_pk_fma_f32 v[248:249], v[248:249], v[32:33], v[32:33] op_sel:[0,0,1] op_sel_hi:[1,0,1]
    v_pk_fma_f32 v[250:251], v[250:251], v[32:33], v[32:33] op_sel:[0,0,1] op_sel_hi:[1,0,1]
    v_pk_mul_f32 v[244:245], v[244:245], v[116:117]
    v_pk_mul_f32 v[246:247], v[246:247], v[118:119]
    v_pk_mul_f32 v[248:249], v[248:249], v[132:133]
    v_pk_mul_f32 v[250:251], v[250:251], v[134:135]
    v_exp_f32 v244, v244
    v_exp_f32 v245, v245
    v_pk_fma_f32 v[180:181], v[20:21], v[236:237], v[180:181] op_sel:[0,0,0] op_sel_hi:[0,1,1] neg_lo:[1,0,0] neg_hi:[1,0,0]
    v_exp_f32 v246, v246
    v_exp_f32 v247, v247
    v_pk_fma_f32 v[182:183], v[20:21], v[238:239], v[182:183] op_sel:[0,0,0] op_sel_hi:[0,1,1] neg_lo:[1,0,0] neg_hi:[1,0,0]
    v_exp_f32 v248, v248
    v_exp_f32 v249, v249
    v_pk_fma_f32 v[196:197], v[20:21], v[240:241], v[196:197] op_sel:[0,0,0] op_sel_hi:[0,1,1] neg_lo:[1,0,0] neg_hi:[1,0,0]
    v_exp_f32 v250, v250
    v_exp_f32 v251, v251
    v_pk_fma_f32 v[198:199], v[20:21], v[242:243], v[198:199] op_sel:[0,0,0] op_sel_hi:[0,1,1] neg_lo:[1,0,0] neg_hi:[1,0,0]
    v_pk_fma_f32 v[244:245], v[244:245], v[28:29], v[28:29] op_sel:[0,0,0] op_sel_hi:[1,0,0]
    v_pk_fma_f32 v[246:247], v[246:247], v[28:29], v[28:29] op_sel:[0,0,0] op_sel_hi:[1,0,0]
    v_pk_fma_f32 v[248:249], v[248:249], v[28:29], v[28:29] op_sel:[0,0,0] op_sel_hi:[1,0,0]
    v_pk_fma_f32 v[250:251], v[250:251], v[28:29], v[28:29] op_sel:[0,0,0] op_sel_hi:[1,0,0]
    v_rcp_f32 v244, v244
    v_rcp_f32 v245, v245
    v_pk_mul_f32 v[116:117], v[116:117], v[180:181]
    v_rcp_f32 v246, v246
    v_rcp_f32 v247, v247
    v_pk_mul_f32 v[118:119], v[118:119], v[182:183]
    v_rcp_f32 v248, v248
    v_rcp_f32 v249, v249
    v_pk_mul_f32 v[132:133], v[132:133], v[196:197]
    v_rcp_f32 v250, v250
    v_rcp_f32 v251, v251
    v_pk_mul_f32 v[134:135], v[134:135], v[198:199]
    v_pk_mul_f32 v[116:117], v[116:117], v[244:245]
    v_pk_mul_f32 v[118:119], v[118:119], v[246:247]
    v_pk_mul_f32 v[132:133], v[132:133], v[248:249]
    v_pk_mul_f32 v[134:135], v[134:135], v[250:251]
    v_cvt_pk_bf16_f32 v36, v116, v117
    v_cvt_pk_bf16_f32 v37, v118, v119
    v_cvt_pk_bf16_f32 v38, v132, v133
    v_cvt_pk_bf16_f32 v39, v134, v135
    s_add_u32 s9, s80, 4096
    buffer_store_dwordx4 v[36:39], v9, s[60:63], s9 offen offset:0 sc1
    v_pk_fma_f32 v[120:121], v[20:21], v[220:221], v[120:121] op_sel:[1,0,0] op_sel_hi:[1,1,1] neg_lo:[1,0,0] neg_hi:[1,0,0]
    v_pk_fma_f32 v[122:123], v[20:21], v[222:223], v[122:123] op_sel:[1,0,0] op_sel_hi:[1,1,1] neg_lo:[1,0,0] neg_hi:[1,0,0]
    v_pk_fma_f32 v[136:137], v[20:21], v[224:225], v[136:137] op_sel:[1,0,0] op_sel_hi:[1,1,1] neg_lo:[1,0,0] neg_hi:[1,0,0]
    v_pk_fma_f32 v[138:139], v[20:21], v[226:227], v[138:139] op_sel:[1,0,0] op_sel_hi:[1,1,1] neg_lo:[1,0,0] neg_hi:[1,0,0]
    v_pk_mul_f32 v[120:121], v[24:25], v[120:121] op_sel:[1,0] op_sel_hi:[1,1]
    v_pk_mul_f32 v[122:123], v[24:25], v[122:123] op_sel:[1,0] op_sel_hi:[1,1]
    v_pk_mul_f32 v[136:137], v[24:25], v[136:137] op_sel:[1,0] op_sel_hi:[1,1]
    v_pk_mul_f32 v[138:139], v[24:25], v[138:139] op_sel:[1,0] op_sel_hi:[1,1]
    v_pk_mul_f32 v[244:245], v[120:121], v[120:121]
    v_pk_mul_f32 v[246:247], v[122:123], v[122:123]
    v_pk_mul_f32 v[248:249], v[136:137], v[136:137]
    v_pk_mul_f32 v[250:251], v[138:139], v[138:139]
    v_pk_fma_f32 v[244:245], v[244:245], v[32:33], v[32:33] op_sel:[0,0,1] op_sel_hi:[1,0,1]
    v_pk_fma_f32 v[246:247], v[246:247], v[32:33], v[32:33] op_sel:[0,0,1] op_sel_hi:[1,0,1]
    v_pk_fma_f32 v[248:249], v[248:249], v[32:33], v[32:33] op_sel:[0,0,1] op_sel_hi:[1,0,1]
    v_pk_fma_f32 v[250:251], v[250:251], v[32:33], v[32:33] op_sel:[0,0,1] op_sel_hi:[1,0,1]
    v_pk_mul_f32 v[244:245], v[244:245], v[120:121]
    v_pk_mul_f32 v[246:247], v[246:247], v[122:123]
    v_pk_mul_f32 v[248:249], v[248:249], v[136:137]
    v_pk_mul_f32 v[250:251], v[250:251], v[138:139]
    v_exp_f32 v244, v244
    v_exp_f32 v245, v245
    v_pk_fma_f32 v[184:185], v[20:21], v[236:237], v[184:185] op_sel:[1,0,0] op_sel_hi:[1,1,1] neg_lo:[1,0,0] neg_hi:[1,0,0]
    v_exp_f32 v246, v246
    v_exp_f32 v247, v247
    v_pk_fma_f32 v[186:187], v[20:21], v[238:239], v[186:187] op_sel:[1,0,0] op_sel_hi:[1,1,1] neg_lo:[1,0,0] neg_hi:[1,0,0]
    v_exp_f32 v248, v248
    v_exp_f32 v249, v249
    v_pk_fma_f32 v[200:201], v[20:21], v[240:241], v[200:201] op_sel:[1,0,0] op_sel_hi:[1,1,1] neg_lo:[1,0,0] neg_hi:[1,0,0]
    v_exp_f32 v250, v250
    v_exp_f32 v251, v251
    v_pk_fma_f32 v[202:203], v[20:21], v[242:243], v[202:203] op_sel:[1,0,0] op_sel_hi:[1,1,1] neg_lo:[1,0,0] neg_hi:[1,0,0]
    v_pk_fma_f32 v[244:245], v[244:245], v[28:29], v[28:29] op_sel:[0,1,1] op_sel_hi:[1,1,1]
    v_pk_fma_f32 v[246:247], v[246:247], v[28:29], v[28:29] op_sel:[0,1,1] op_sel_hi:[1,1,1]
    v_pk_fma_f32 v[248:249], v[248:249], v[28:29], v[28:29] op_sel:[0,1,1] op_sel_hi:[1,1,1]
    v_pk_fma_f32 v[250:251], v[250:251], v[28:29], v[28:29] op_sel:[0,1,1] op_sel_hi:[1,1,1]
    v_rcp_f32 v244, v244
    v_rcp_f32 v245, v245
    v_pk_mul_f32 v[120:121], v[120:121], v[184:185]
    v_rcp_f32 v246, v246
    v_rcp_f32 v247, v247
    v_pk_mul_f32 v[122:123], v[122:123], v[186:187]
    v_rcp_f32 v248, v248
    v_rcp_f32 v249, v249
    v_pk_mul_f32 v[136:137], v[136:137], v[200:201]
    v_rcp_f32 v250, v250
    v_rcp_f32 v251, v251
    v_pk_mul_f32 v[138:139], v[138:139], v[202:203]
    v_pk_mul_f32 v[120:121], v[120:121], v[244:245]
    v_pk_mul_f32 v[122:123], v[122:123], v[246:247]
    v_pk_mul_f32 v[136:137], v[136:137], v[248:249]
    v_pk_mul_f32 v[138:139], v[138:139], v[250:251]
    v_cvt_pk_bf16_f32 v40, v120, v121
    v_cvt_pk_bf16_f32 v41, v122, v123
    v_cvt_pk_bf16_f32 v42, v136, v137
    v_cvt_pk_bf16_f32 v43, v138, v139
    s_add_u32 s9, s80, 4096
    buffer_store_dwordx4 v[40:43], v9, s[60:63], s9 offen offset:1024 sc1
    s_lshl_b32 s9, s81, 2
    s_lshr_b32 s10, s7, 1
    s_add_u32 s9, s9, s10
    s_mul_i32 s9, s9, 4224
    s_and_b32 s10, s7, 1
    s_lshl_b32 s10, s10, 1
    s_add_u32 s10, s10, s5
    s_mul_i32 s10, s10, 4
    s_add_u32 s9, s9, s10
    s_add_u32 s9, s9, 0x1160000
    v_mov_b32 v6, s9
    v_mov_b32 v7, s82
    s_waitcnt vmcnt(2)
    s_mov_b64 exec, 1
    buffer_store_dword v7, v6, s[60:63], 0 offen sc1
    s_mov_b64 exec, -1
    v_pk_fma_f32 v[124:125], v[22:23], v[220:221], v[124:125] op_sel:[0,0,0] op_sel_hi:[0,1,1] neg_lo:[1,0,0] neg_hi:[1,0,0]
    v_pk_fma_f32 v[126:127], v[22:23], v[222:223], v[126:127] op_sel:[0,0,0] op_sel_hi:[0,1,1] neg_lo:[1,0,0] neg_hi:[1,0,0]
    v_pk_fma_f32 v[140:141], v[22:23], v[224:225], v[140:141] op_sel:[0,0,0] op_sel_hi:[0,1,1] neg_lo:[1,0,0] neg_hi:[1,0,0]
    v_pk_fma_f32 v[142:143], v[22:23], v[226:227], v[142:143] op_sel:[0,0,0] op_sel_hi:[0,1,1] neg_lo:[1,0,0] neg_hi:[1,0,0]
    v_pk_mul_f32 v[124:125], v[26:27], v[124:125] op_sel:[0,0] op_sel_hi:[0,1]
    v_pk_mul_f32 v[126:127], v[26:27], v[126:127] op_sel:[0,0] op_sel_hi:[0,1]
    v_pk_mul_f32 v[140:141], v[26:27], v[140:141] op_sel:[0,0] op_sel_hi:[0,1]
    v_pk_mul_f32 v[142:143], v[26:27], v[142:143] op_sel:[0,0] op_sel_hi:[0,1]
    v_pk_mul_f32 v[244:245], v[124:125], v[124:125]
    v_pk_mul_f32 v[246:247], v[126:127], v[126:127]
    v_pk_mul_f32 v[248:249], v[140:141], v[140:141]
    v_pk_mul_f32 v[250:251], v[142:143], v[142:143]
    v_pk_fma_f32 v[244:245], v[244:245], v[32:33], v[32:33] op_sel:[0,0,1] op_sel_hi:[1,0,1]
    v_pk_fma_f32 v[246:247], v[246:247], v[32:33], v[32:33] op_sel:[0,0,1] op_sel_hi:[1,0,1]
    v_pk_fma_f32 v[248:249], v[248:249], v[32:33], v[32:33] op_sel:[0,0,1] op_sel_hi:[1,0,1]
    v_pk_fma_f32 v[250:251], v[250:251], v[32:33], v[32:33] op_sel:[0,0,1] op_sel_hi:[1,0,1]
    v_pk_mul_f32 v[244:245], v[244:245], v[124:125]
    v_pk_mul_f32 v[246:247], v[246:247], v[126:127]
    v_pk_mul_f32 v[248:249], v[248:249], v[140:141]
    v_pk_mul_f32 v[250:251], v[250:251], v[142:143]
    v_exp_f32 v244, v244
    v_exp_f32 v245, v245
    v_pk_fma_f32 v[188:189], v[22:23], v[236:237], v[188:189] op_sel:[0,0,0] op_sel_hi:[0,1,1] neg_lo:[1,0,0] neg_hi:[1,0,0]
    v_exp_f32 v246, v246
    v_exp_f32 v247, v247
    v_pk_fma_f32 v[190:191], v[22:23], v[238:239], v[190:191] op_sel:[0,0,0] op_sel_hi:[0,1,1] neg_lo:[1,0,0] neg_hi:[1,0,0]
    v_exp_f32 v248, v248
    v_exp_f32 v249, v249
    v_pk_fma_f32 v[204:205], v[22:23], v[240:241], v[204:205] op_sel:[0,0,0] op_sel_hi:[0,1,1] neg_lo:[1,0,0] neg_hi:[1,0,0]
    v_exp_f32 v250, v250
    v_exp_f32 v251, v251
    v_pk_fma_f32 v[206:207], v[22:23], v[242:243], v[206:207] op_sel:[0,0,0] op_sel_hi:[0,1,1] neg_lo:[1,0,0] neg_hi:[1,0,0]
    v_pk_fma_f32 v[244:245], v[244:245], v[30:31], v[30:31] op_sel:[0,0,0] op_sel_hi:[1,0,0]
    v_pk_fma_f32 v[246:247], v[246:247], v[30:31], v[30:31] op_sel:[0,0,0] op_sel_hi:[1,0,0]
    v_pk_fma_f32 v[248:249], v[248:249], v[30:31], v[30:31] op_sel:[0,0,0] op_sel_hi:[1,0,0]
    v_pk_fma_f32 v[250:251], v[250:251], v[30:31], v[30:31] op_sel:[0,0,0] op_sel_hi:[1,0,0]
    v_rcp_f32 v244, v244
    v_rcp_f32 v245, v245
    v_pk_mul_f32 v[124:125], v[124:125], v[188:189]
    v_rcp_f32 v246, v246
    v_rcp_f32 v247, v247
    v_pk_mul_f32 v[126:127], v[126:127], v[190:191]
    v_rcp_f32 v248, v248
    v_rcp_f32 v249, v249
    v_pk_mul_f32 v[140:141], v[140:141], v[204:205]
    v_rcp_f32 v250, v250
    v_rcp_f32 v251, v251
    v_pk_mul_f32 v[142:143], v[142:143], v[206:207]
    v_pk_mul_f32 v[124:125], v[124:125], v[244:245]
    v_pk_mul_f32 v[126:127], v[126:127], v[246:247]
    v_pk_mul_f32 v[140:141], v[140:141], v[248:249]
    v_pk_mul_f32 v[142:143], v[142:143], v[250:251]
    v_cvt_pk_bf16_f32 v36, v124, v125
    v_cvt_pk_bf16_f32 v37, v126, v127
    v_cvt_pk_bf16_f32 v38, v140, v141
    v_cvt_pk_bf16_f32 v39, v142, v143
    s_add_u32 s9, s80, 4096
    buffer_store_dwordx4 v[36:39], v9, s[60:63], s9 offen offset:2048 sc1
    v_pk_fma_f32 v[128:129], v[22:23], v[220:221], v[128:129] op_sel:[1,0,0] op_sel_hi:[1,1,1] neg_lo:[1,0,0] neg_hi:[1,0,0]
    v_pk_fma_f32 v[130:131], v[22:23], v[222:223], v[130:131] op_sel:[1,0,0] op_sel_hi:[1,1,1] neg_lo:[1,0,0] neg_hi:[1,0,0]
    v_pk_fma_f32 v[144:145], v[22:23], v[224:225], v[144:145] op_sel:[1,0,0] op_sel_hi:[1,1,1] neg_lo:[1,0,0] neg_hi:[1,0,0]
    v_pk_fma_f32 v[146:147], v[22:23], v[226:227], v[146:147] op_sel:[1,0,0] op_sel_hi:[1,1,1] neg_lo:[1,0,0] neg_hi:[1,0,0]
    v_pk_mul_f32 v[128:129], v[26:27], v[128:129] op_sel:[1,0] op_sel_hi:[1,1]
    v_pk_mul_f32 v[130:131], v[26:27], v[130:131] op_sel:[1,0] op_sel_hi:[1,1]
    v_pk_mul_f32 v[144:145], v[26:27], v[144:145] op_sel:[1,0] op_sel_hi:[1,1]
    v_pk_mul_f32 v[146:147], v[26:27], v[146:147] op_sel:[1,0] op_sel_hi:[1,1]
    v_pk_mul_f32 v[244:245], v[128:129], v[128:129]
    v_pk_mul_f32 v[246:247], v[130:131], v[130:131]
    v_pk_mul_f32 v[248:249], v[144:145], v[144:145]
    v_pk_mul_f32 v[250:251], v[146:147], v[146:147]
    v_pk_fma_f32 v[244:245], v[244:245], v[32:33], v[32:33] op_sel:[0,0,1] op_sel_hi:[1,0,1]
    v_pk_fma_f32 v[246:247], v[246:247], v[32:33], v[32:33] op_sel:[0,0,1] op_sel_hi:[1,0,1]
    v_pk_fma_f32 v[248:249], v[248:249], v[32:33], v[32:33] op_sel:[0,0,1] op_sel_hi:[1,0,1]
    v_pk_fma_f32 v[250:251], v[250:251], v[32:33], v[32:33] op_sel:[0,0,1] op_sel_hi:[1,0,1]
    v_pk_mul_f32 v[244:245], v[244:245], v[128:129]
    v_pk_mul_f32 v[246:247], v[246:247], v[130:131]
    v_pk_mul_f32 v[248:249], v[248:249], v[144:145]
    v_pk_mul_f32 v[250:251], v[250:251], v[146:147]
    v_exp_f32 v244, v244
    v_exp_f32 v245, v245
    v_pk_fma_f32 v[192:193], v[22:23], v[236:237], v[192:193] op_sel:[1,0,0] op_sel_hi:[1,1,1] neg_lo:[1,0,0] neg_hi:[1,0,0]
    v_exp_f32 v246, v246
    v_exp_f32 v247, v247
    v_pk_fma_f32 v[194:195], v[22:23], v[238:239], v[194:195] op_sel:[1,0,0] op_sel_hi:[1,1,1] neg_lo:[1,0,0] neg_hi:[1,0,0]
    v_exp_f32 v248, v248
    v_exp_f32 v249, v249
    v_pk_fma_f32 v[208:209], v[22:23], v[240:241], v[208:209] op_sel:[1,0,0] op_sel_hi:[1,1,1] neg_lo:[1,0,0] neg_hi:[1,0,0]
    v_exp_f32 v250, v250
    v_exp_f32 v251, v251
    v_pk_fma_f32 v[210:211], v[22:23], v[242:243], v[210:211] op_sel:[1,0,0] op_sel_hi:[1,1,1] neg_lo:[1,0,0] neg_hi:[1,0,0]
    v_pk_fma_f32 v[244:245], v[244:245], v[30:31], v[30:31] op_sel:[0,1,1] op_sel_hi:[1,1,1]
    v_pk_fma_f32 v[246:247], v[246:247], v[30:31], v[30:31] op_sel:[0,1,1] op_sel_hi:[1,1,1]
    v_pk_fma_f32 v[248:249], v[248:249], v[30:31], v[30:31] op_sel:[0,1,1] op_sel_hi:[1,1,1]
    v_pk_fma_f32 v[250:251], v[250:251], v[30:31], v[30:31] op_sel:[0,1,1] op_sel_hi:[1,1,1]
    v_rcp_f32 v244, v244
    v_rcp_f32 v245, v245
    v_pk_mul_f32 v[128:129], v[128:129], v[192:193]
    v_rcp_f32 v246, v246
    v_rcp_f32 v247, v247
    v_pk_mul_f32 v[130:131], v[130:131], v[194:195]
    v_rcp_f32 v248, v248
    v_rcp_f32 v249, v249
    v_pk_mul_f32 v[144:145], v[144:145], v[208:209]
    v_rcp_f32 v250, v250
    v_rcp_f32 v251, v251
    v_pk_mul_f32 v[146:147], v[146:147], v[210:211]
    v_pk_mul_f32 v[128:129], v[128:129], v[244:245]
    v_pk_mul_f32 v[130:131], v[130:131], v[246:247]
    v_pk_mul_f32 v[144:145], v[144:145], v[248:249]
    v_pk_mul_f32 v[146:147], v[146:147], v[250:251]
    v_cvt_pk_bf16_f32 v40, v128, v129
    v_cvt_pk_bf16_f32 v41, v130, v131
    v_cvt_pk_bf16_f32 v42, v144, v145
    v_cvt_pk_bf16_f32 v43, v146, v147
    s_add_u32 s9, s80, 4096
    buffer_store_dwordx4 v[40:43], v9, s[60:63], s9 offen offset:3072 sc1
    s_lshl_b32 s9, s3, 2
    s_add_u32 s9, s9, 163776
    v_mov_b32 v6, s9
    v_mov_b32 v7, 1
    ds_write_b32 v6, v7
    s_lshl_b32 s9, s81, 2
    s_lshr_b32 s10, s7, 1
    s_add_u32 s9, s9, s10
    s_mul_i32 s9, s9, 4224
    s_and_b32 s10, s7, 1
    s_lshl_b32 s10, s10, 1
    s_add_u32 s10, s10, s5
    s_mul_i32 s10, s10, 4
    s_add_u32 s9, s9, s10
    s_add_u32 s9, s9, 0x1160030
    v_mov_b32 v6, s9
    v_mov_b32 v7, s82
    s_waitcnt vmcnt(0)
    s_mov_b64 exec, 1
    buffer_store_dword v7, v6, s[60:63], 0 offen sc1
    s_mov_b64 exec, -1
    s_branch L_k1_base
L_k1_CB:
    s_lshl_b32 s9, s5, 6
    v_xor_b32 v14, s9, v6
    v_xor_b32 v15, 32, v14
    s_mul_i32 s9, s5, 10240
    s_add_u32 s9, s9, 32768
    v_add_u32 v16, s9, v11
    v_xor_b32 v17, 64, v16
    s_lshr_b32 s9, s83, 5
    s_add_u32 s9, s9, s5
    s_mul_i32 s10, s81, 88
    s_add_u32 s9, s9, s10
    s_lshl_b32 s80, s9, 12
    s_mov_b32 s60, s46
    s_mov_b32 s61, s47
    s_mov_b32 s62, 19922944
    s_mov_b32 s63, 0x20000
    v_mov_b64 v[76:77], 0
    v_mov_b64 v[78:79], 0
    v_mov_b64 v[80:81], 0
    v_mov_b64 v[82:83], 0
    v_mov_b64 v[84:85], 0
    v_mov_b64 v[86:87], 0
    v_mov_b64 v[88:89], 0
    v_mov_b64 v[90:91], 0
    v_mov_b64 v[92:93], 0
    v_mov_b64 v[94:95], 0
    v_mov_b64 v[96:97], 0
    v_mov_b64 v[98:99], 0
    v_mov_b64 v[100:101], 0
    v_mov_b64 v[102:103], 0
    v_mov_b64 v[104:105], 0
    v_mov_b64 v[106:107], 0
    v_mov_b64 v[108:109], 0
    v_mov_b64 v[110:111], 0
    v_mov_b64 v[112:113], 0
    v_mov_b64 v[114:115], 0
    v_mov_b64 v[116:117], 0
    v_mov_b64 v[118:119], 0
    v_mov_b64 v[120:121], 0
    v_mov_b64 v[122:123], 0
    v_mov_b64 v[124:125], 0
    v_mov_b64 v[126:127], 0
    v_mov_b64 v[128:129], 0
    v_mov_b64 v[130:131], 0
    v_mov_b64 v[132:133], 0
    v_mov_b64 v[134:135], 0
    v_mov_b64 v[136:137], 0
    v_mov_b64 v[138:139], 0
    v_mov_b64 v[140:141], 0
    v_mov_b64 v[142:143], 0
    v_mov_b64 v[144:145], 0
    v_mov_b64 v[146:147], 0
    v_mov_b64 v[148:149], 0
    v_mov_b64 v[150:151], 0
    v_mov_b64 v[152:153], 0
    v_mov_b64 v[154:155], 0
    v_mov_b64 v[156:157], 0
    v_mov_b64 v[158:159], 0
    v_mov_b64 v[160:161], 0
    v_mov_b64 v[162:163], 0
    v_mov_b64 v[164:165], 0
    v_mov_b64 v[166:167], 0
    v_mov_b64 v[168:169], 0
    v_mov_b64 v[170:171], 0
    v_mov_b64 v[172:173], 0
    v_mov_b64 v[174:175], 0
    v_mov_b64 v[176:177], 0
    v_mov_b64 v[178:179], 0
    v_mov_b64 v[180:181], 0
    v_mov_b64 v[182:183], 0
    v_mov_b64 v[184:185], 0
    v_mov_b64 v[186:187], 0
    v_mov_b64 v[188:189], 0
    v_mov_b64 v[190:191], 0
    v_mov_b64 v[192:193], 0
    v_mov_b64 v[194:195], 0
    v_mov_b64 v[196:197], 0
    v_mov_b64 v[198:199], 0
    v_mov_b64 v[200:201], 0
    v_mov_b64 v[202:203], 0
    v_mov_b64 v[204:205], 0
    v_mov_b64 v[206:207], 0
    v_mov_b64 v[208:209], 0
    v_mov_b64 v[210:211], 0
    v_mov_b64 v[212:213], 0
    v_mov_b64 v[214:215], 0
    v_mov_b64 v[216:217], 0
    v_mov_b64 v[218:219], 0
    s_lshl_b32 s11, s7, 1
    s_add_u32 s11, s11, s5
    s_lshl_b32 s9, s11, 14
    s_add_u32 s9, s9, 0x1000000
    s_add_u32 s64, s46, s9
    s_addc_u32 s65, s47, 0
    s_mov_b32 s66, 16384
    s_mov_b32 s67, 0x20000
    s_mul_i32 s9, s11, 33792
    s_add_u32 s58, s9, 0x1040000
    s_lshr_b32 s9, s81, 2
    s_mul_i32 s9, s9, 4224
    s_add_u32 s9, s9, s58
    s_add_u32 s54, s46, s9
    s_addc_u32 s55, s47, 0
    s_lshl_b32 s9, s81, 2
    s_add_u32 s58, s58, s9
    s_add_u32 s9, s81, 1
    s_lshr_b32 s9, s9, 1
    s_lshl_b32 s59, 1, s9
    s_sub_u32 s59, s59, 1
    s_mul_i32 s12, s81, 88
    s_add_u32 s12, s12, 48
    s_lshl_b32 s12, s12, 12
    s_mul_i32 s11, s7, 10
    s_mul_i32 s9, s5, 5
    s_add_u32 s11, s11, s9
    s_add_u32 s9, s11, 0
    s_lshr_b32 s10, s9, 1
    s_lshl_b32 s10, s10, 12
    s_and_b32 s9, s9, 1
    s_lshl_b32 s9, s9, 9
    s_add_u32 s9, s9, s10
    s_add_u32 s68, s9, s12
    s_add_u32 s9, s11, 1
    s_lshr_b32 s10, s9, 1
    s_lshl_b32 s10, s10, 12
    s_and_b32 s9, s9, 1
    s_lshl_b32 s9, s9, 9
    s_add_u32 s9, s9, s10
    s_add_u32 s69, s9, s12
    s_add_u32 s9, s11, 2
    s_lshr_b32 s10, s9, 1
    s_lshl_b32 s10, s10, 12
    s_and_b32 s9, s9, 1
    s_lshl_b32 s9, s9, 9
    s_add_u32 s9, s9, s10
    s_add_u32 s70, s9, s12
    s_add_u32 s9, s11, 3
    s_lshr_b32 s10, s9, 1
    s_lshl_b32 s10, s10, 12
    s_and_b32 s9, s9, 1
    s_lshl_b32 s9, s9, 9
    s_add_u32 s9, s9, s10
    s_add_u32 s71, s9, s12
    s_add_u32 s9, s11, 4
    s_lshr_b32 s10, s9, 1
    s_lshl_b32 s10, s10, 12
    s_and_b32 s9, s9, 1
    s_lshl_b32 s9, s9, 9
    s_add_u32 s9, s9, s10
    s_add_u32 s79, s9, s12
    v_cmp_eq_u32 s[18:19], 1, v3
    v_cmp_eq_u32 s[20:21], 2, v3
    v_cmp_eq_u32 s[22:23], 3, v3
    v_mov_b32 v7, 163728
    v_mov_b32 v9, 0
    s_mov_b32 s14, 4294860800
    s_mov_b32 s15, 53248
L_k1_clB_sp:
    ds_read_b64 v[18:19], v7
    s_waitcnt lgkmcnt(0)
    v_min_u32 v18, v18, v19
    s_nop 0
    v_readfirstlane_b32 s78, v18
    s_nop 0
    s_cmp_gt_u32 s78, s76
    s_cbranch_scc0 L_k1_clB_sp
    s_cmp_lg_u32 s76, 0
    s_cbranch_scc1 L_k1_clB
    ds_read_b128 v[20:23], v12 offset:0
    ds_read_b128 v[24:27], v12 offset:2048
    ds_read_b128 v[52:55], v16 offset:0
    ds_read_b128 v[28:31], v12 offset:4096
    ds_read_b128 v[32:35], v12 offset:6144
    ds_read_b128 v[56:59], v16 offset:2048
    ds_read_b128 v[60:63], v16 offset:4096
    ds_read_b128 v[64:67], v16 offset:6144
    ds_read_b128 v[68:71], v16 offset:8192
    s_branch L_k1_clB_mid
    .p2align 6
L_k1_clB:
    s_waitcnt lgkmcnt(9)
    v_mfma_f32_16x16x32_bf16 v[204:207], v[36:39], v[56:59], v[204:207]
    ds_read_b128 v[20:23], v12 offset:0
    v_mfma_f32_16x16x32_bf16 v[208:211], v[40:43], v[56:59], v[208:211]
    ds_read_b128 v[24:27], v12 offset:2048
    v_mfma_f32_16x16x32_bf16 v[212:215], v[44:47], v[56:59], v[212:215]
    ds_read_b128 v[52:55], v16 offset:0
    v_mfma_f32_16x16x32_bf16 v[216:219], v[48:51], v[56:59], v[216:219]
    s_waitcnt lgkmcnt(10)
    v_mfma_f32_16x16x32_bf16 v[76:79], v[60:63], v[36:39], v[76:79]
    ds_read_b128 v[28:31], v12 offset:4096
    v_mfma_f32_16x16x32_bf16 v[80:83], v[60:63], v[40:43], v[80:83]
    ds_read_b128 v[32:35], v12 offset:6144
    v_mfma_f32_16x16x32_bf16 v[84:87], v[60:63], v[44:47], v[84:87]
    ds_read_b128 v[56:59], v16 offset:2048
    v_mfma_f32_16x16x32_bf16 v[88:91], v[60:63], v[48:51], v[88:91]
    s_waitcnt lgkmcnt(11)
    v_mfma_f32_16x16x32_bf16 v[108:111], v[64:67], v[36:39], v[108:111]
    ds_read_b128 v[60:63], v16 offset:4096
    v_mfma_f32_16x16x32_bf16 v[112:115], v[64:67], v[40:43], v[112:115]
    s_waitcnt lgkmcnt(7)
    global_load_lds_dword v9, s[56:57]
    v_mfma_f32_16x16x32_bf16 v[116:119], v[64:67], v[44:47], v[116:119]
    v_mfma_f32_16x16x32_bf16 v[120:123], v[64:67], v[48:51], v[120:123]
    v_mfma_f32_16x16x32_bf16 v[92:95], v[68:71], v[36:39], v[92:95]
    ds_read_b128 v[64:67], v16 offset:6144
    v_mfma_f32_16x16x32_bf16 v[96:99], v[68:71], v[40:43], v[96:99]
    v_mfma_f32_16x16x32_bf16 v[100:103], v[68:71], v[44:47], v[100:103]
    v_mfma_f32_16x16x32_bf16 v[104:107], v[68:71], v[48:51], v[104:107]
    v_mfma_f32_16x16x32_bf16 v[124:127], v[72:75], v[36:39], v[124:127]
    ds_read_b128 v[68:71], v16 offset:8192
    v_mfma_f32_16x16x32_bf16 v[128:131], v[72:75], v[40:43], v[128:131]
    v_mfma_f32_16x16x32_bf16 v[132:135], v[72:75], v[44:47], v[132:135]
    v_mfma_f32_16x16x32_bf16 v[136:139], v[72:75], v[48:51], v[136:139]
L_k1_clB_mid:
    s_waitcnt lgkmcnt(4)
    v_mfma_f32_16x16x32_bf16 v[140:143], v[20:23], v[52:55], v[140:143]
    ds_read_b64_tr_b16 v[72:73], v14 offset:0
    s_add_u32 s77, s77, 1
    v_mfma_f32_16x16x32_bf16 v[144:147], v[24:27], v[52:55], v[144:147]
    ds_read_b64_tr_b16 v[74:75], v14 offset:512
    s_cmp_eq_u32 s77, 3
    v_mfma_f32_16x16x32_bf16 v[148:151], v[28:31], v[52:55], v[148:151]
    ds_read_b128 v[36:39], v13 offset:0
    s_cselect_b32 s75, s14, s15
    v_mfma_f32_16x16x32_bf16 v[152:155], v[32:35], v[52:55], v[152:155]
    s_cselect_b32 s77, 0, s77
    s_waitcnt lgkmcnt(6)
    v_mfma_f32_16x16x32_bf16 v[156:159], v[20:23], v[56:59], v[156:159]
    ds_read_b64_tr_b16 v[52:53], v14 offset:8192
    s_add_u32 s76, s76, 1
    v_mfma_f32_16x16x32_bf16 v[160:163], v[24:27], v[56:59], v[160:163]
    ds_read_b64_tr_b16 v[54:55], v14 offset:8704
    v_add_u32 v9, 4, v9
    v_mfma_f32_16x16x32_bf16 v[164:167], v[28:31], v[56:59], v[164:167]
    ds_read_b128 v[40:43], v13 offset:2048
    v_mfma_f32_16x16x32_bf16 v[168:171], v[32:35], v[56:59], v[168:171]
    s_waitcnt lgkmcnt(8)
    v_mfma_f32_16x16x32_bf16 v[172:175], v[20:23], v[60:63], v[172:175]
    ds_read_b64_tr_b16 v[56:57], v15 offset:0
    v_mfma_f32_16x16x32_bf16 v[176:179], v[24:27], v[60:63], v[176:179]
    ds_read_b64_tr_b16 v[58:59], v15 offset:512
    v_mfma_f32_16x16x32_bf16 v[180:183], v[28:31], v[60:63], v[180:183]
    ds_read_b128 v[44:47], v13 offset:4096
    v_mfma_f32_16x16x32_bf16 v[184:187], v[32:35], v[60:63], v[184:187]
    s_waitcnt lgkmcnt(10)
    v_mfma_f32_16x16x32_bf16 v[188:191], v[20:23], v[64:67], v[188:191]
    ds_read_b64_tr_b16 v[60:61], v15 offset:8192
    v_mfma_f32_16x16x32_bf16 v[192:195], v[24:27], v[64:67], v[192:195]
    ds_read_b64_tr_b16 v[62:63], v15 offset:8704
    v_mfma_f32_16x16x32_bf16 v[196:199], v[28:31], v[64:67], v[196:199]
    ds_read_b128 v[48:51], v13 offset:6144
    v_mfma_f32_16x16x32_bf16 v[200:203], v[32:35], v[64:67], v[200:203]
    s_waitcnt lgkmcnt(12)
    v_mfma_f32_16x16x32_bf16 v[204:207], v[20:23], v[68:71], v[204:207]
    ds_read_b128 v[64:67], v17 offset:0
    v_mfma_f32_16x16x32_bf16 v[208:211], v[24:27], v[68:71], v[208:211]
    v_add_u32 v12, s75, v12
    v_mfma_f32_16x16x32_bf16 v[212:215], v[28:31], v[68:71], v[212:215]
    v_add_u32 v13, s75, v13
    v_mfma_f32_16x16x32_bf16 v[216:219], v[32:35], v[68:71], v[216:219]
    s_waitcnt lgkmcnt(11)
    v_mfma_f32_16x16x32_bf16 v[76:79], v[72:75], v[20:23], v[76:79]
    ds_read_b128 v[68:71], v17 offset:2048
    v_mfma_f32_16x16x32_bf16 v[80:83], v[72:75], v[24:27], v[80:83]
    v_add_u32 v16, s75, v16
    v_mfma_f32_16x16x32_bf16 v[84:87], v[72:75], v[28:31], v[84:87]
    s_waitcnt lgkmcnt(2)
    global_load_lds_dword v9, s[56:57]
    v_mfma_f32_16x16x32_bf16 v[88:91], v[72:75], v[32:35], v[88:91]
    v_mfma_f32_16x16x32_bf16 v[108:111], v[52:55], v[20:23], v[108:111]
    ds_read_b128 v[72:75], v17 offset:4096
    v_mfma_f32_16x16x32_bf16 v[112:115], v[52:55], v[24:27], v[112:115]
    v_add_u32 v9, 4, v9
    v_mfma_f32_16x16x32_bf16 v[116:119], v[52:55], v[28:31], v[116:119]
    v_mfma_f32_16x16x32_bf16 v[120:123], v[52:55], v[32:35], v[120:123]
    v_mfma_f32_16x16x32_bf16 v[92:95], v[56:59], v[20:23], v[92:95]
    ds_read_b128 v[52:55], v17 offset:6144
    v_mfma_f32_16x16x32_bf16 v[96:99], v[56:59], v[24:27], v[96:99]
    v_mfma_f32_16x16x32_bf16 v[100:103], v[56:59], v[28:31], v[100:103]
    v_mfma_f32_16x16x32_bf16 v[104:107], v[56:59], v[32:35], v[104:107]
    v_mfma_f32_16x16x32_bf16 v[124:127], v[60:63], v[20:23], v[124:127]
    ds_read_b128 v[56:59], v17 offset:8192
    v_mfma_f32_16x16x32_bf16 v[128:131], v[60:63], v[24:27], v[128:131]
    v_add_u32 v17, s75, v17
    v_mfma_f32_16x16x32_bf16 v[132:135], v[60:63], v[28:31], v[132:135]
    v_mfma_f32_16x16x32_bf16 v[136:139], v[60:63], v[32:35], v[136:139]
    s_waitcnt lgkmcnt(4)
    v_mfma_f32_16x16x32_bf16 v[140:143], v[36:39], v[64:67], v[140:143]
    ds_read_b64_tr_b16 v[60:61], v14 offset:4096
    v_mfma_f32_16x16x32_bf16 v[144:147], v[40:43], v[64:67], v[144:147]
    ds_read_b64_tr_b16 v[62:63], v14 offset:4608
    v_mfma_f32_16x16x32_bf16 v[148:151], v[44:47], v[64:67], v[148:151]
    v_mfma_f32_16x16x32_bf16 v[152:155], v[48:51], v[64:67], v[152:155]
    s_waitcnt lgkmcnt(5)
    v_mfma_f32_16x16x32_bf16 v[156:159], v[36:39], v[68:71], v[156:159]
    ds_read_b64_tr_b16 v[64:65], v14 offset:12288
    v_mfma_f32_16x16x32_bf16 v[160:163], v[40:43], v[68:71], v[160:163]
    ds_read_b64_tr_b16 v[66:67], v14 offset:12800
    v_mfma_f32_16x16x32_bf16 v[164:167], v[44:47], v[68:71], v[164:167]
    ds_read_b64 v[18:19], v7
    v_add_u32 v14, s75, v14
    v_mfma_f32_16x16x32_bf16 v[168:171], v[48:51], v[68:71], v[168:171]
    s_waitcnt lgkmcnt(7)
    v_mfma_f32_16x16x32_bf16 v[172:175], v[36:39], v[72:75], v[172:175]
    ds_read_b64_tr_b16 v[68:69], v15 offset:4096
    v_mfma_f32_16x16x32_bf16 v[176:179], v[40:43], v[72:75], v[176:179]
    ds_read_b64_tr_b16 v[70:71], v15 offset:4608
    v_mfma_f32_16x16x32_bf16 v[180:183], v[44:47], v[72:75], v[180:183]
    s_waitcnt lgkmcnt(2)
    v_min_u32 v18, v18, v19
    v_mfma_f32_16x16x32_bf16 v[184:187], v[48:51], v[72:75], v[184:187]
    v_readfirstlane_b32 s78, v18
    v_mfma_f32_16x16x32_bf16 v[188:191], v[36:39], v[52:55], v[188:191]
    ds_read_b64_tr_b16 v[72:73], v15 offset:12288
    v_mfma_f32_16x16x32_bf16 v[192:195], v[40:43], v[52:55], v[192:195]
    ds_read_b64_tr_b16 v[74:75], v15 offset:12800
    v_mfma_f32_16x16x32_bf16 v[196:199], v[44:47], v[52:55], v[196:199]
    s_cmp_gt_u32 s78, s76
    v_add_u32 v15, s75, v15
    v_mfma_f32_16x16x32_bf16 v[200:203], v[48:51], v[52:55], v[200:203]
    s_cbranch_scc1 L_k1_clB
    s_cmp_lt_u32 s76, 10
    s_cbranch_scc1 L_k1_clB_sp
    ds_read_b64 v[18:19], v7 offset:8
    s_waitcnt lgkmcnt(6)
    v_mfma_f32_16x16x32_bf16 v[204:207], v[36:39], v[56:59], v[204:207]
    v_mfma_f32_16x16x32_bf16 v[208:211], v[40:43], v[56:59], v[208:211]
    v_mfma_f32_16x16x32_bf16 v[212:215], v[44:47], v[56:59], v[212:215]
    v_mfma_f32_16x16x32_bf16 v[216:219], v[48:51], v[56:59], v[216:219]
    s_waitcnt lgkmcnt(0)
    global_load_lds_dword v9, s[56:57]
    s_branch L_k1_clB_ec
L_k1_clB_es:
    ds_read_b64 v[18:19], v7 offset:8
L_k1_clB_ec:
    s_waitcnt lgkmcnt(0)
    v_min_u32 v18, v18, v19
    s_nop 0
    v_readfirstlane_b32 s82, v18
    s_nop 0
    s_cmp_eq_u32 s82, 0
    s_cbranch_scc1 L_k1_clB_es
    s_mul_i32 s9, s4, 768
    s_add_u32 s9, s9, 159744
    v_lshl_add_u32 v9, v3, 4, s9
    v_lshl_add_u32 v8, v2, 2, s9
    s_mul_i32 s9, s5, 3072
    s_add_u32 s9, s9, 99328
    v_lshl_add_u32 v11, v2, 4, s9
    v_mfma_f32_16x16x32_bf16 v[76:79], v[60:63], v[36:39], v[76:79]
    ds_read_b128 v[20:23], v9 offset:0
    v_mfma_f32_16x16x32_bf16 v[80:83], v[60:63], v[40:43], v[80:83]
    ds_read_b128 v[24:27], v9 offset:64
    v_mfma_f32_16x16x32_bf16 v[84:87], v[60:63], v[44:47], v[84:87]
    ds_read_b128 v[28:31], v9 offset:128
    v_mfma_f32_16x16x32_bf16 v[88:91], v[60:63], v[48:51], v[88:91]
    ds_read_b128 v[32:35], v9 offset:192
    v_mfma_f32_16x16x32_bf16 v[108:111], v[64:67], v[36:39], v[108:111]
    ds_read_b128 v[244:247], v11 offset:1536
    v_mfma_f32_16x16x32_bf16 v[112:115], v[64:67], v[40:43], v[112:115]
    ds_read_b128 v[248:251], v11 offset:1792
    v_mfma_f32_16x16x32_bf16 v[116:119], v[64:67], v[44:47], v[116:119]
    ds_read_b128 v[252:255], v11 offset:2048
    v_mfma_f32_16x16x32_bf16 v[120:123], v[64:67], v[48:51], v[120:123]
    ds_read_b128 v[220:223], v11 offset:0
    v_mfma_f32_16x16x32_bf16 v[92:95], v[68:71], v[36:39], v[92:95]
    ds_read_b128 v[224:227], v11 offset:256
    v_mfma_f32_16x16x32_bf16 v[96:99], v[68:71], v[40:43], v[96:99]
    ds_read_b128 v[228:231], v11 offset:512
    v_mfma_f32_16x16x32_bf16 v[100:103], v[68:71], v[44:47], v[100:103]
    ds_read_b128 v[232:235], v11 offset:768
    v_mfma_f32_16x16x32_bf16 v[104:107], v[68:71], v[48:51], v[104:107]
    ds_read_b128 v[236:239], v11 offset:1024
    v_mfma_f32_16x16x32_bf16 v[124:127], v[72:75], v[36:39], v[124:127]
    ds_read_b128 v[240:243], v11 offset:1280
    v_mfma_f32_16x16x32_bf16 v[128:131], v[72:75], v[40:43], v[128:131]
    v_mfma_f32_16x16x32_bf16 v[132:135], v[72:75], v[44:47], v[132:135]
    v_mfma_f32_16x16x32_bf16 v[136:139], v[72:75], v[48:51], v[136:139]
    ds_read_b128 v[36:39], v9 offset:256
    ds_read_b128 v[40:43], v9 offset:320
    ds_read_b128 v[44:47], v9 offset:384
    ds_read_b128 v[48:51], v9 offset:448
    s_waitcnt lgkmcnt(4)
    v_pk_fma_f32 v[140:141], v[20:21], v[246:247], v[140:141] op_sel:[0,1,0] op_sel_hi:[1,1,1] neg_lo:[1,0,0] neg_hi:[1,0,0]
    v_pk_fma_f32 v[156:157], v[20:21], v[248:249], v[156:157] op_sel:[0,1,0] op_sel_hi:[1,1,1] neg_lo:[1,0,0] neg_hi:[1,0,0]
    v_pk_fma_f32 v[172:173], v[20:21], v[250:251], v[172:173] op_sel:[0,1,0] op_sel_hi:[1,1,1] neg_lo:[1,0,0] neg_hi:[1,0,0]
    v_pk_fma_f32 v[188:189], v[20:21], v[252:253], v[188:189] op_sel:[0,1,0] op_sel_hi:[1,1,1] neg_lo:[1,0,0] neg_hi:[1,0,0]
    v_pk_fma_f32 v[204:205], v[20:21], v[244:245], v[204:205] op_sel:[0,1,0] op_sel_hi:[1,1,1] neg_lo:[1,0,0] neg_hi:[1,0,0]
    v_pk_fma_f32 v[142:143], v[22:23], v[246:247], v[142:143] op_sel:[0,1,0] op_sel_hi:[1,1,1] neg_lo:[1,0,0] neg_hi:[1,0,0]
    v_pk_fma_f32 v[158:159], v[22:23], v[248:249], v[158:159] op_sel:[0,1,0] op_sel_hi:[1,1,1] neg_lo:[1,0,0] neg_hi:[1,0,0]
    v_pk_fma_f32 v[174:175], v[22:23], v[250:251], v[174:175] op_sel:[0,1,0] op_sel_hi:[1,1,1] neg_lo:[1,0,0] neg_hi:[1,0,0]
    v_pk_fma_f32 v[190:191], v[22:23], v[252:253], v[190:191] op_sel:[0,1,0] op_sel_hi:[1,1,1] neg_lo:[1,0,0] neg_hi:[1,0,0]
    v_pk_fma_f32 v[206:207], v[22:23], v[244:245], v[206:207] op_sel:[0,1,0] op_sel_hi:[1,1,1] neg_lo:[1,0,0] neg_hi:[1,0,0]
    v_pk_fma_f32 v[144:145], v[24:25], v[246:247], v[144:145] op_sel:[0,1,0] op_sel_hi:[1,1,1] neg_lo:[1,0,0] neg_hi:[1,0,0]
    v_pk_fma_f32 v[160:161], v[24:25], v[248:249], v[160:161] op_sel:[0,1,0] op_sel_hi:[1,1,1] neg_lo:[1,0,0] neg_hi:[1,0,0]
    v_pk_fma_f32 v[176:177], v[24:25], v[250:251], v[176:177] op_sel:[0,1,0] op_sel_hi:[1,1,1] neg_lo:[1,0,0] neg_hi:[1,0,0]
    v_pk_fma_f32 v[192:193], v[24:25], v[252:253], v[192:193] op_sel:[0,1,0] op_sel_hi:[1,1,1] neg_lo:[1,0,0] neg_hi:[1,0,0]
    v_pk_fma_f32 v[208:209], v[24:25], v[244:245], v[208:209] op_sel:[0,1,0] op_sel_hi:[1,1,1] neg_lo:[1,0,0] neg_hi:[1,0,0]
    v_pk_fma_f32 v[146:147], v[26:27], v[246:247], v[146:147] op_sel:[0,1,0] op_sel_hi:[1,1,1] neg_lo:[1,0,0] neg_hi:[1,0,0]
    v_pk_fma_f32 v[162:163], v[26:27], v[248:249], v[162:163] op_sel:[0,1,0] op_sel_hi:[1,1,1] neg_lo:[1,0,0] neg_hi:[1,0,0]
    v_pk_fma_f32 v[178:179], v[26:27], v[250:251], v[178:179] op_sel:[0,1,0] op_sel_hi:[1,1,1] neg_lo:[1,0,0] neg_hi:[1,0,0]
    v_pk_fma_f32 v[194:195], v[26:27], v[252:253], v[194:195] op_sel:[0,1,0] op_sel_hi:[1,1,1] neg_lo:[1,0,0] neg_hi:[1,0,0]
    v_pk_fma_f32 v[210:211], v[26:27], v[244:245], v[210:211] op_sel:[0,1,0] op_sel_hi:[1,1,1] neg_lo:[1,0,0] neg_hi:[1,0,0]
    v_pk_fma_f32 v[148:149], v[28:29], v[246:247], v[148:149] op_sel:[0,1,0] op_sel_hi:[1,1,1] neg_lo:[1,0,0] neg_hi:[1,0,0]
    v_pk_fma_f32 v[164:165], v[28:29], v[248:249], v[164:165] op_sel:[0,1,0] op_sel_hi:[1,1,1] neg_lo:[1,0,0] neg_hi:[1,0,0]
    v_pk_fma_f32 v[180:181], v[28:29], v[250:251], v[180:181] op_sel:[0,1,0] op_sel_hi:[1,1,1] neg_lo:[1,0,0] neg_hi:[1,0,0]
    v_pk_fma_f32 v[196:197], v[28:29], v[252:253], v[196:197] op_sel:[0,1,0] op_sel_hi:[1,1,1] neg_lo:[1,0,0] neg_hi:[1,0,0]
    v_pk_fma_f32 v[212:213], v[28:29], v[244:245], v[212:213] op_sel:[0,1,0] op_sel_hi:[1,1,1] neg_lo:[1,0,0] neg_hi:[1,0,0]
    v_pk_fma_f32 v[150:151], v[30:31], v[246:247], v[150:151] op_sel:[0,1,0] op_sel_hi:[1,1,1] neg_lo:[1,0,0] neg_hi:[1,0,0]
    v_pk_fma_f32 v[166:167], v[30:31], v[248:249], v[166:167] op_sel:[0,1,0] op_sel_hi:[1,1,1] neg_lo:[1,0,0] neg_hi:[1,0,0]
    v_pk_fma_f32 v[182:183], v[30:31], v[250:251], v[182:183] op_sel:[0,1,0] op_sel_hi:[1,1,1] neg_lo:[1,0,0] neg_hi:[1,0,0]
    v_pk_fma_f32 v[198:199], v[30:31], v[252:253], v[198:199] op_sel:[0,1,0] op_sel_hi:[1,1,1] neg_lo:[1,0,0] neg_hi:[1,0,0]
    v_pk_fma_f32 v[214:215], v[30:31], v[244:245], v[214:215] op_sel:[0,1,0] op_sel_hi:[1,1,1] neg_lo:[1,0,0] neg_hi:[1,0,0]
    v_pk_fma_f32 v[152:153], v[32:33], v[246:247], v[152:153] op_sel:[0,1,0] op_sel_hi:[1,1,1] neg_lo:[1,0,0] neg_hi:[1,0,0]
    v_pk_fma_f32 v[168:169], v[32:33], v[248:249], v[168:169] op_sel:[0,1,0] op_sel_hi:[1,1,1] neg_lo:[1,0,0] neg_hi:[1,0,0]
    v_pk_fma_f32 v[184:185], v[32:33], v[250:251], v[184:185] op_sel:[0,1,0] op_sel_hi:[1,1,1] neg_lo:[1,0,0] neg_hi:[1,0,0]
    v_pk_fma_f32 v[200:201], v[32:33], v[252:253], v[200:201] op_sel:[0,1,0] op_sel_hi:[1,1,1] neg_lo:[1,0,0] neg_hi:[1,0,0]
    v_pk_fma_f32 v[216:217], v[32:33], v[244:245], v[216:217] op_sel:[0,1,0] op_sel_hi:[1,1,1] neg_lo:[1,0,0] neg_hi:[1,0,0]
    v_pk_fma_f32 v[154:155], v[34:35], v[246:247], v[154:155] op_sel:[0,1,0] op_sel_hi:[1,1,1] neg_lo:[1,0,0] neg_hi:[1,0,0]
    v_pk_fma_f32 v[170:171], v[34:35], v[248:249], v[170:171] op_sel:[0,1,0] op_sel_hi:[1,1,1] neg_lo:[1,0,0] neg_hi:[1,0,0]
    v_pk_fma_f32 v[186:187], v[34:35], v[250:251], v[186:187] op_sel:[0,1,0] op_sel_hi:[1,1,1] neg_lo:[1,0,0] neg_hi:[1,0,0]
    v_pk_fma_f32 v[202:203], v[34:35], v[252:253], v[202:203] op_sel:[0,1,0] op_sel_hi:[1,1,1] neg_lo:[1,0,0] neg_hi:[1,0,0]
    v_pk_fma_f32 v[218:219], v[34:35], v[244:245], v[218:219] op_sel:[0,1,0] op_sel_hi:[1,1,1] neg_lo:[1,0,0] neg_hi:[1,0,0]
    s_waitcnt lgkmcnt(0)
    v_pk_mul_f32 v[140:141], v[36:37], v[140:141]
    v_pk_mul_f32 v[156:157], v[36:37], v[156:157]
    v_pk_mul_f32 v[172:173], v[36:37], v[172:173]
    v_pk_mul_f32 v[188:189], v[36:37], v[188:189]
    v_pk_mul_f32 v[204:205], v[36:37], v[204:205]
    v_fma_f32 v52, v220, v140, v141
    v_fma_f32 v53, v221, v156, v157
    v_fma_f32 v54, v222, v172, v173
    v_fma_f32 v55, v223, v188, v189
    v_fma_f32 v56, v224, v204, v205
    v_fmac_f32_dpp v52, v140, v225 row_ror:8 row_mask:0xf bank_mask:0xf
    v_fmac_f32_dpp v53, v156, v226 row_ror:8 row_mask:0xf bank_mask:0xf
    v_fmac_f32_dpp v54, v172, v227 row_ror:8 row_mask:0xf bank_mask:0xf
    v_fmac_f32_dpp v55, v188, v228 row_ror:8 row_mask:0xf bank_mask:0xf
    v_fmac_f32_dpp v56, v204, v229 row_ror:8 row_mask:0xf bank_mask:0xf
    v_pk_mul_f32 v[142:143], v[38:39], v[142:143]
    v_pk_mul_f32 v[158:159], v[38:39], v[158:159]
    v_pk_mul_f32 v[174:175], v[38:39], v[174:175]
    v_pk_mul_f32 v[190:191], v[38:39], v[190:191]
    v_pk_mul_f32 v[206:207], v[38:39], v[206:207]
    v_fma_f32 v57, v220, v52, v142
    v_fma_f32 v58, v221, v53, v158
    v_fma_f32 v59, v222, v54, v174
    v_fma_f32 v60, v223, v55, v190
    v_fma_f32 v61, v224, v56, v206
    v_fmac_f32_dpp v57, v52, v225 row_ror:8 row_mask:0xf bank_mask:0xf
    v_fmac_f32_dpp v58, v53, v226 row_ror:8 row_mask:0xf bank_mask:0xf
    v_fmac_f32_dpp v59, v54, v227 row_ror:8 row_mask:0xf bank_mask:0xf
    v_fmac_f32_dpp v60, v55, v228 row_ror:8 row_mask:0xf bank_mask:0xf
    v_fmac_f32_dpp v61, v56, v229 row_ror:8 row_mask:0xf bank_mask:0xf
    v_fma_f32 v52, v220, v57, v143
    v_fma_f32 v53, v221, v58, v159
    v_fma_f32 v54, v222, v59, v175
    v_fma_f32 v55, v223, v60, v191
    v_fma_f32 v56, v224, v61, v207
    v_fmac_f32_dpp v52, v57, v225 row_ror:8 row_mask:0xf bank_mask:0xf
    v_fmac_f32_dpp v53, v58, v226 row_ror:8 row_mask:0xf bank_mask:0xf
    v_fmac_f32_dpp v54, v59, v227 row_ror:8 row_mask:0xf bank_mask:0xf
    v_fmac_f32_dpp v55, v60, v228 row_ror:8 row_mask:0xf bank_mask:0xf
    v_fmac_f32_dpp v56, v61, v229 row_ror:8 row_mask:0xf bank_mask:0xf
    v_pk_mul_f32 v[144:145], v[40:41], v[144:145]
    v_pk_mul_f32 v[160:161], v[40:41], v[160:161]
    v_pk_mul_f32 v[176:177], v[40:41], v[176:177]
    v_pk_mul_f32 v[192:193], v[40:41], v[192:193]
    v_pk_mul_f32 v[208:209], v[40:41], v[208:209]
    v_fma_f32 v57, v220, v52, v144
    v_fma_f32 v58, v221, v53, v160
    v_fma_f32 v59, v222, v54, v176
    v_fma_f32 v60, v223, v55, v192
    v_fma_f32 v61, v224, v56, v208
    v_fmac_f32_dpp v57, v52, v225 row_ror:8 row_mask:0xf bank_mask:0xf
    v_fmac_f32_dpp v58, v53, v226 row_ror:8 row_mask:0xf bank_mask:0xf
    v_fmac_f32_dpp v59, v54, v227 row_ror:8 row_mask:0xf bank_mask:0xf
    v_fmac_f32_dpp v60, v55, v228 row_ror:8 row_mask:0xf bank_mask:0xf
    v_fmac_f32_dpp v61, v56, v229 row_ror:8 row_mask:0xf bank_mask:0xf
    v_fma_f32 v52, v220, v57, v145
    v_fma_f32 v53, v221, v58, v161
    v_fma_f32 v54, v222, v59, v177
    v_fma_f32 v55, v223, v60, v193
    v_fma_f32 v56, v224, v61, v209
    v_fmac_f32_dpp v52, v57, v225 row_ror:8 row_mask:0xf bank_mask:0xf
    v_fmac_f32_dpp v53, v58, v226 row_ror:8 row_mask:0xf bank_mask:0xf
    v_fmac_f32_dpp v54, v59, v227 row_ror:8 row_mask:0xf bank_mask:0xf
    v_fmac_f32_dpp v55, v60, v228 row_ror:8 row_mask:0xf bank_mask:0xf
    v_fmac_f32_dpp v56, v61, v229 row_ror:8 row_mask:0xf bank_mask:0xf
    v_pk_mul_f32 v[146:147], v[42:43], v[146:147]
    v_pk_mul_f32 v[162:163], v[42:43], v[162:163]
    v_pk_mul_f32 v[178:179], v[42:43], v[178:179]
    v_pk_mul_f32 v[194:195], v[42:43], v[194:195]
    v_pk_mul_f32 v[210:211], v[42:43], v[210:211]
    v_fma_f32 v57, v220, v52, v146
    v_fma_f32 v58, v221, v53, v162
    v_fma_f32 v59, v222, v54, v178
    v_fma_f32 v60, v223, v55, v194
    v_fma_f32 v61, v224, v56, v210
    v_fmac_f32_dpp v57, v52, v225 row_ror:8 row_mask:0xf bank_mask:0xf
    v_fmac_f32_dpp v58, v53, v226 row_ror:8 row_mask:0xf bank_mask:0xf
    v_fmac_f32_dpp v59, v54, v227 row_ror:8 row_mask:0xf bank_mask:0xf
    v_fmac_f32_dpp v60, v55, v228 row_ror:8 row_mask:0xf bank_mask:0xf
    v_fmac_f32_dpp v61, v56, v229 row_ror:8 row_mask:0xf bank_mask:0xf
    v_fma_f32 v52, v220, v57, v147
    v_fma_f32 v53, v221, v58, v163
    v_fma_f32 v54, v222, v59, v179
    v_fma_f32 v55, v223, v60, v195
    v_fma_f32 v56, v224, v61, v211
    v_fmac_f32_dpp v52, v57, v225 row_ror:8 row_mask:0xf bank_mask:0xf
    v_fmac_f32_dpp v53, v58, v226 row_ror:8 row_mask:0xf bank_mask:0xf
    v_fmac_f32_dpp v54, v59, v227 row_ror:8 row_mask:0xf bank_mask:0xf
    v_fmac_f32_dpp v55, v60, v228 row_ror:8 row_mask:0xf bank_mask:0xf
    v_fmac_f32_dpp v56, v61, v229 row_ror:8 row_mask:0xf bank_mask:0xf
    v_pk_mul_f32 v[148:149], v[44:45], v[148:149]
    v_pk_mul_f32 v[164:165], v[44:45], v[164:165]
    v_pk_mul_f32 v[180:181], v[44:45], v[180:181]
    v_pk_mul_f32 v[196:197], v[44:45], v[196:197]
    v_pk_mul_f32 v[212:213], v[44:45], v[212:213]
    v_fma_f32 v57, v220, v52, v148
    v_fma_f32 v58, v221, v53, v164
    v_fma_f32 v59, v222, v54, v180
    v_fma_f32 v60, v223, v55, v196
    v_fma_f32 v61, v224, v56, v212
    v_fmac_f32_dpp v57, v52, v225 row_ror:8 row_mask:0xf bank_mask:0xf
    v_fmac_f32_dpp v58, v53, v226 row_ror:8 row_mask:0xf bank_mask:0xf
    v_fmac_f32_dpp v59, v54, v227 row_ror:8 row_mask:0xf bank_mask:0xf
    v_fmac_f32_dpp v60, v55, v228 row_ror:8 row_mask:0xf bank_mask:0xf
    v_fmac_f32_dpp v61, v56, v229 row_ror:8 row_mask:0xf bank_mask:0xf
    v_fma_f32 v52, v220, v57, v149
    v_fma_f32 v53, v221, v58, v165
    v_fma_f32 v54, v222, v59, v181
    v_fma_f32 v55, v223, v60, v197
    v_fma_f32 v56, v224, v61, v213
    v_fmac_f32_dpp v52, v57, v225 row_ror:8 row_mask:0xf bank_mask:0xf
    v_fmac_f32_dpp v53, v58, v226 row_ror:8 row_mask:0xf bank_mask:0xf
    v_fmac_f32_dpp v54, v59, v227 row_ror:8 row_mask:0xf bank_mask:0xf
    v_fmac_f32_dpp v55, v60, v228 row_ror:8 row_mask:0xf bank_mask:0xf
    v_fmac_f32_dpp v56, v61, v229 row_ror:8 row_mask:0xf bank_mask:0xf
    v_pk_mul_f32 v[150:151], v[46:47], v[150:151]
    v_pk_mul_f32 v[166:167], v[46:47], v[166:167]
    v_pk_mul_f32 v[182:183], v[46:47], v[182:183]
    v_pk_mul_f32 v[198:199], v[46:47], v[198:199]
    v_pk_mul_f32 v[214:215], v[46:47], v[214:215]
    v_fma_f32 v57, v220, v52, v150
    v_fma_f32 v58, v221, v53, v166
    v_fma_f32 v59, v222, v54, v182
    v_fma_f32 v60, v223, v55, v198
    v_fma_f32 v61, v224, v56, v214
    v_fmac_f32_dpp v57, v52, v225 row_ror:8 row_mask:0xf bank_mask:0xf
    v_fmac_f32_dpp v58, v53, v226 row_ror:8 row_mask:0xf bank_mask:0xf
    v_fmac_f32_dpp v59, v54, v227 row_ror:8 row_mask:0xf bank_mask:0xf
    v_fmac_f32_dpp v60, v55, v228 row_ror:8 row_mask:0xf bank_mask:0xf
    v_fmac_f32_dpp v61, v56, v229 row_ror:8 row_mask:0xf bank_mask:0xf
    v_fma_f32 v52, v220, v57, v151
    v_fma_f32 v53, v221, v58, v167
    v_fma_f32 v54, v222, v59, v183
    v_fma_f32 v55, v223, v60, v199
    v_fma_f32 v56, v224, v61, v215
    v_fmac_f32_dpp v52, v57, v225 row_ror:8 row_mask:0xf bank_mask:0xf
    v_fmac_f32_dpp v53, v58, v226 row_ror:8 row_mask:0xf bank_mask:0xf
    v_fmac_f32_dpp v54, v59, v227 row_ror:8 row_mask:0xf bank_mask:0xf
    v_fmac_f32_dpp v55, v60, v228 row_ror:8 row_mask:0xf bank_mask:0xf
    v_fmac_f32_dpp v56, v61, v229 row_ror:8 row_mask:0xf bank_mask:0xf
    v_pk_mul_f32 v[152:153], v[48:49], v[152:153]
    v_pk_mul_f32 v[168:169], v[48:49], v[168:169]
    v_pk_mul_f32 v[184:185], v[48:49], v[184:185]
    v_pk_mul_f32 v[200:201], v[48:49], v[200:201]
    v_pk_mul_f32 v[216:217], v[48:49], v[216:217]
    v_fma_f32 v57, v220, v52, v152
    v_fma_f32 v58, v221, v53, v168
    v_fma_f32 v59, v222, v54, v184
    v_fma_f32 v60, v223, v55, v200
    v_fma_f32 v61, v224, v56, v216
    v_fmac_f32_dpp v57, v52, v225 row_ror:8 row_mask:0xf bank_mask:0xf
    v_fmac_f32_dpp v58, v53, v226 row_ror:8 row_mask:0xf bank_mask:0xf
    v_fmac_f32_dpp v59, v54, v227 row_ror:8 row_mask:0xf bank_mask:0xf
    v_fmac_f32_dpp v60, v55, v228 row_ror:8 row_mask:0xf bank_mask:0xf
    v_fmac_f32_dpp v61, v56, v229 row_ror:8 row_mask:0xf bank_mask:0xf
    v_fma_f32 v52, v220, v57, v153
    v_fma_f32 v53, v221, v58, v169
    v_fma_f32 v54, v222, v59, v185
    v_fma_f32 v55, v223, v60, v201
    v_fma_f32 v56, v224, v61, v217
    v_fmac_f32_dpp v52, v57, v225 row_ror:8 row_mask:0xf bank_mask:0xf
    v_fmac_f32_dpp v53, v58, v226 row_ror:8 row_mask:0xf bank_mask:0xf
    v_fmac_f32_dpp v54, v59, v227 row_ror:8 row_mask:0xf bank_mask:0xf
    v_fmac_f32_dpp v55, v60, v228 row_ror:8 row_mask:0xf bank_mask:0xf
    v_fmac_f32_dpp v56, v61, v229 row_ror:8 row_mask:0xf bank_mask:0xf
    v_pk_mul_f32 v[154:155], v[50:51], v[154:155]
    v_pk_mul_f32 v[170:171], v[50:51], v[170:171]
    v_pk_mul_f32 v[186:187], v[50:51], v[186:187]
    v_pk_mul_f32 v[202:203], v[50:51], v[202:203]
    v_pk_mul_f32 v[218:219], v[50:51], v[218:219]
    v_fma_f32 v57, v220, v52, v154
    v_fma_f32 v58, v221, v53, v170
    v_fma_f32 v59, v222, v54, v186
    v_fma_f32 v60, v223, v55, v202
    v_fma_f32 v61, v224, v56, v218
    v_fmac_f32_dpp v57, v52, v225 row_ror:8 row_mask:0xf bank_mask:0xf
    v_fmac_f32_dpp v58, v53, v226 row_ror:8 row_mask:0xf bank_mask:0xf
    v_fmac_f32_dpp v59, v54, v227 row_ror:8 row_mask:0xf bank_mask:0xf
    v_fmac_f32_dpp v60, v55, v228 row_ror:8 row_mask:0xf bank_mask:0xf
    v_fmac_f32_dpp v61, v56, v229 row_ror:8 row_mask:0xf bank_mask:0xf
    v_fma_f32 v52, v220, v57, v155
    v_fma_f32 v53, v221, v58, v171
    v_fma_f32 v54, v222, v59, v187
    v_fma_f32 v55, v223, v60, v203
    v_fma_f32 v56, v224, v61, v219
    v_fmac_f32_dpp v52, v57, v225 row_ror:8 row_mask:0xf bank_mask:0xf
    v_fmac_f32_dpp v53, v58, v226 row_ror:8 row_mask:0xf bank_mask:0xf
    v_fmac_f32_dpp v54, v59, v227 row_ror:8 row_mask:0xf bank_mask:0xf
    v_fmac_f32_dpp v55, v60, v228 row_ror:8 row_mask:0xf bank_mask:0xf
    v_fmac_f32_dpp v56, v61, v229 row_ror:8 row_mask:0xf bank_mask:0xf
    s_lshl_b32 s9, s5, 9
    s_add_u32 s9, s9, 161280
    v_lshl_add_u32 v6, v3, 4, s9
    ds_read2_b32 v[62:63], v8 offset0:0 offset1:16
    ds_read2_b32 v[66:67], v8 offset0:64 offset1:80
    ds_read2_b32 v[70:71], v8 offset0:128 offset1:144
    ds_read2_b32 v[64:65], v8 offset0:32 offset1:48
    ds_read2_b32 v[68:69], v8 offset0:96 offset1:112
    ds_read2_b32 v[72:73], v8 offset0:160 offset1:176
    ds_read_b128 v[36:39], v6 offset:0
    ds_read_b128 v[40:43], v6 offset:64
    ds_read_b128 v[44:47], v6 offset:128
    ds_read_b128 v[48:51], v6 offset:192
    v_mov_b32 v74, 0xbdd2d3e8
    v_mov_b32 v75, 0xc0135761
    v_mov_b32 v57, v52
    v_mov_b32 v58, v53
    v_mov_b32 v59, v54
    v_mov_b32 v60, v55
    v_mov_b32 v61, v56
    v_permlane16_swap_b32 v52, v57
    v_permlane16_swap_b32 v53, v58
    v_permlane16_swap_b32 v54, v59
    v_permlane16_swap_b32 v55, v60
    v_permlane16_swap_b32 v56, v61
    v_mov_b32 v20, v52
    v_mov_b32 v28, v57
    v_mov_b32 v21, v53
    v_mov_b32 v29, v58
    v_mov_b32 v22, v54
    v_mov_b32 v30, v59
    v_mov_b32 v23, v55
    v_mov_b32 v32, v60
    v_mov_b32 v24, v56
    v_mov_b32 v33, v61
    v_permlane32_swap_b32 v52, v20
    v_permlane32_swap_b32 v57, v28
    v_permlane32_swap_b32 v53, v21
    v_permlane32_swap_b32 v58, v29
    v_permlane32_swap_b32 v54, v22
    v_permlane32_swap_b32 v59, v30
    v_permlane32_swap_b32 v55, v23
    v_permlane32_swap_b32 v60, v32
    v_permlane32_swap_b32 v56, v24
    v_permlane32_swap_b32 v61, v33
    v_mov_b32 v31, s82
    v_mov_b32 v35, s82
    s_lshl_b32 s9, s81, 9
    v_lshlrev_b32 v7, 4, v2
    v_mul_u32_u24 v19, 4224, v2
    v_fmac_f32 v57, v235, v52
    v_fmac_f32 v58, v236, v53
    v_fmac_f32 v59, v237, v54
    v_fmac_f32 v60, v238, v55
    v_fmac_f32 v61, v239, v56
    v_fmac_f32_dpp v57, v52, v240 row_ror:8 row_mask:0xf bank_mask:0xf
    v_fmac_f32_dpp v58, v53, v241 row_ror:8 row_mask:0xf bank_mask:0xf
    v_fmac_f32_dpp v59, v54, v242 row_ror:8 row_mask:0xf bank_mask:0xf
    v_fmac_f32_dpp v60, v55, v243 row_ror:8 row_mask:0xf bank_mask:0xf
    v_fmac_f32_dpp v61, v56, v244 row_ror:8 row_mask:0xf bank_mask:0xf
    v_fmac_f32 v20, v235, v57
    v_fmac_f32 v21, v236, v58
    v_fmac_f32 v22, v237, v59
    v_fmac_f32 v23, v238, v60
    v_fmac_f32 v24, v239, v61
    v_fmac_f32_dpp v20, v57, v240 row_ror:8 row_mask:0xf bank_mask:0xf
    v_fmac_f32_dpp v21, v58, v241 row_ror:8 row_mask:0xf bank_mask:0xf
    v_fmac_f32_dpp v22, v59, v242 row_ror:8 row_mask:0xf bank_mask:0xf
    v_fmac_f32_dpp v23, v60, v243 row_ror:8 row_mask:0xf bank_mask:0xf
    v_fmac_f32_dpp v24, v61, v244 row_ror:8 row_mask:0xf bank_mask:0xf
    v_fmac_f32 v28, v235, v20
    v_fmac_f32 v29, v236, v21
    v_fmac_f32 v30, v237, v22
    v_fmac_f32 v32, v238, v23
    v_fmac_f32 v33, v239, v24
    v_fmac_f32_dpp v28, v20, v240 row_ror:8 row_mask:0xf bank_mask:0xf
    v_fmac_f32_dpp v29, v21, v241 row_ror:8 row_mask:0xf bank_mask:0xf
    v_fmac_f32_dpp v30, v22, v242 row_ror:8 row_mask:0xf bank_mask:0xf
    v_fmac_f32_dpp v32, v23, v243 row_ror:8 row_mask:0xf bank_mask:0xf
    v_fmac_f32_dpp v33, v24, v244 row_ror:8 row_mask:0xf bank_mask:0xf
    s_mov_b64 exec, 0xffff
    buffer_store_dwordx4 v[28:31], v7, s[64:67], s9 offen sc1
    buffer_store_dwordx4 v[32:35], v7, s[64:67], s9 offen offset:256 sc1
    s_mov_b64 exec, -1
    s_mov_b32 s56, s82
    s_mov_b32 s57, s82
    s_lshl_b32 s9, s3, 2
    s_add_u32 s9, s9, 163776
    v_mov_b32 v17, s9
    v_mov_b32 v18, 1
    ds_write_b32 v17, v18
    v_cndmask_b32 v12, 0, v52, s[18:19]
    v_cndmask_b32 v13, 0, v53, s[18:19]
    v_cndmask_b32 v14, 0, v54, s[18:19]
    v_cndmask_b32 v15, 0, v55, s[18:19]
    v_cndmask_b32 v16, 0, v56, s[18:19]
    v_cndmask_b32 v12, v12, v57, s[20:21]
    v_cndmask_b32 v13, v13, v58, s[20:21]
    v_cndmask_b32 v14, v14, v59, s[20:21]
    v_cndmask_b32 v15, v15, v60, s[20:21]
    v_cndmask_b32 v16, v16, v61, s[20:21]
    v_cndmask_b32 v12, v12, v20, s[22:23]
    v_cndmask_b32 v13, v13, v21, s[22:23]
    v_cndmask_b32 v14, v14, v22, s[22:23]
    v_cndmask_b32 v15, v15, v23, s[22:23]
    v_cndmask_b32 v16, v16, v24, s[22:23]
    v_lshlrev_b32 v9, 4, v1
    s_waitcnt lgkmcnt(0)
    v_pk_fma_f32 v[76:77], v[62:63], v[36:37], v[76:77] op_sel:[0,0,0] op_sel_hi:[0,1,1] neg_lo:[1,0,0] neg_hi:[1,0,0]
    v_pk_fma_f32 v[78:79], v[62:63], v[38:39], v[78:79] op_sel:[0,0,0] op_sel_hi:[0,1,1] neg_lo:[1,0,0] neg_hi:[1,0,0]
    v_pk_fma_f32 v[92:93], v[62:63], v[40:41], v[92:93] op_sel:[0,0,0] op_sel_hi:[0,1,1] neg_lo:[1,0,0] neg_hi:[1,0,0]
    v_pk_fma_f32 v[94:95], v[62:63], v[42:43], v[94:95] op_sel:[0,0,0] op_sel_hi:[0,1,1] neg_lo:[1,0,0] neg_hi:[1,0,0]
    v_pk_mul_f32 v[76:77], v[66:67], v[76:77] op_sel:[0,0] op_sel_hi:[0,1]
    v_pk_mul_f32 v[78:79], v[66:67], v[78:79] op_sel:[0,0] op_sel_hi:[0,1]
    v_pk_mul_f32 v[92:93], v[66:67], v[92:93] op_sel:[0,0] op_sel_hi:[0,1]
    v_pk_mul_f32 v[94:95], v[66:67], v[94:95] op_sel:[0,0] op_sel_hi:[0,1]
    v_pk_mul_f32 v[20:21], v[76:77], v[76:77]
    v_pk_mul_f32 v[22:23], v[78:79], v[78:79]
    v_pk_mul_f32 v[24:25], v[92:93], v[92:93]
    v_pk_mul_f32 v[26:27], v[94:95], v[94:95]
    v_pk_fma_f32 v[20:21], v[20:21], v[74:75], v[74:75] op_sel:[0,0,1] op_sel_hi:[1,0,1]
    v_pk_fma_f32 v[22:23], v[22:23], v[74:75], v[74:75] op_sel:[0,0,1] op_sel_hi:[1,0,1]
    v_pk_fma_f32 v[24:25], v[24:25], v[74:75], v[74:75] op_sel:[0,0,1] op_sel_hi:[1,0,1]
    v_pk_fma_f32 v[26:27], v[26:27], v[74:75], v[74:75] op_sel:[0,0,1] op_sel_hi:[1,0,1]
    v_pk_mul_f32 v[20:21], v[20:21], v[76:77]
    v_pk_mul_f32 v[22:23], v[22:23], v[78:79]
    v_pk_mul_f32 v[24:25], v[24:25], v[92:93]
    v_pk_mul_f32 v[26:27], v[26:27], v[94:95]
    v_exp_f32 v20, v20
    v_exp_f32 v21, v21
    v_pk_fma_f32 v[108:109], v[62:63], v[44:45], v[108:109] op_sel:[0,0,0] op_sel_hi:[0,1,1] neg_lo:[1,0,0] neg_hi:[1,0,0]
    v_exp_f32 v22, v22
    v_exp_f32 v23, v23
    v_pk_fma_f32 v[110:111], v[62:63], v[46:47], v[110:111] op_sel:[0,0,0] op_sel_hi:[0,1,1] neg_lo:[1,0,0] neg_hi:[1,0,0]
    v_exp_f32 v24, v24
    v_exp_f32 v25, v25
    v_pk_fma_f32 v[124:125], v[62:63], v[48:49], v[124:125] op_sel:[0,0,0] op_sel_hi:[0,1,1] neg_lo:[1,0,0] neg_hi:[1,0,0]
    v_exp_f32 v26, v26
    v_exp_f32 v27, v27
    v_pk_fma_f32 v[126:127], v[62:63], v[50:51], v[126:127] op_sel:[0,0,0] op_sel_hi:[0,1,1] neg_lo:[1,0,0] neg_hi:[1,0,0]
    v_pk_fma_f32 v[20:21], v[20:21], v[70:71], v[70:71] op_sel:[0,0,0] op_sel_hi:[1,0,0]
    v_pk_fma_f32 v[22:23], v[22:23], v[70:71], v[70:71] op_sel:[0,0,0] op_sel_hi:[1,0,0]
    v_pk_fma_f32 v[24:25], v[24:25], v[70:71], v[70:71] op_sel:[0,0,0] op_sel_hi:[1,0,0]
    v_pk_fma_f32 v[26:27], v[26:27], v[70:71], v[70:71] op_sel:[0,0,0] op_sel_hi:[1,0,0]
    v_rcp_f32 v20, v20
    v_rcp_f32 v21, v21
    v_pk_mul_f32 v[76:77], v[76:77], v[108:109]
    v_rcp_f32 v22, v22
    v_rcp_f32 v23, v23
    v_pk_mul_f32 v[78:79], v[78:79], v[110:111]
    v_rcp_f32 v24, v24
    v_rcp_f32 v25, v25
    v_pk_mul_f32 v[92:93], v[92:93], v[124:125]
    v_rcp_f32 v26, v26
    v_rcp_f32 v27, v27
    v_pk_mul_f32 v[94:95], v[94:95], v[126:127]
    v_pk_mul_f32 v[76:77], v[76:77], v[20:21]
    v_pk_mul_f32 v[78:79], v[78:79], v[22:23]
    v_pk_mul_f32 v[92:93], v[92:93], v[24:25]
    v_pk_mul_f32 v[94:95], v[94:95], v[26:27]
    v_cvt_pk_bf16_f32 v236, v76, v77
    v_cvt_pk_bf16_f32 v237, v78, v79
    v_cvt_pk_bf16_f32 v238, v92, v93
    v_cvt_pk_bf16_f32 v239, v94, v95
    v_pk_fma_f32 v[80:81], v[62:63], v[36:37], v[80:81] op_sel:[1,0,0] op_sel_hi:[1,1,1] neg_lo:[1,0,0] neg_hi:[1,0,0]
    v_pk_fma_f32 v[82:83], v[62:63], v[38:39], v[82:83] op_sel:[1,0,0] op_sel_hi:[1,1,1] neg_lo:[1,0,0] neg_hi:[1,0,0]
    v_pk_fma_f32 v[96:97], v[62:63], v[40:41], v[96:97] op_sel:[1,0,0] op_sel_hi:[1,1,1] neg_lo:[1,0,0] neg_hi:[1,0,0]
    v_pk_fma_f32 v[98:99], v[62:63], v[42:43], v[98:99] op_sel:[1,0,0] op_sel_hi:[1,1,1] neg_lo:[1,0,0] neg_hi:[1,0,0]
    v_pk_mul_f32 v[80:81], v[66:67], v[80:81] op_sel:[1,0] op_sel_hi:[1,1]
    v_pk_mul_f32 v[82:83], v[66:67], v[82:83] op_sel:[1,0] op_sel_hi:[1,1]
    v_pk_mul_f32 v[96:97], v[66:67], v[96:97] op_sel:[1,0] op_sel_hi:[1,1]
    v_pk_mul_f32 v[98:99], v[66:67], v[98:99] op_sel:[1,0] op_sel_hi:[1,1]
    v_pk_mul_f32 v[20:21], v[80:81], v[80:81]
    v_pk_mul_f32 v[22:23], v[82:83], v[82:83]
    v_pk_mul_f32 v[24:25], v[96:97], v[96:97]
    v_pk_mul_f32 v[26:27], v[98:99], v[98:99]
    v_pk_fma_f32 v[20:21], v[20:21], v[74:75], v[74:75] op_sel:[0,0,1] op_sel_hi:[1,0,1]
    v_pk_fma_f32 v[22:23], v[22:23], v[74:75], v[74:75] op_sel:[0,0,1] op_sel_hi:[1,0,1]
    v_pk_fma_f32 v[24:25], v[24:25], v[74:75], v[74:75] op_sel:[0,0,1] op_sel_hi:[1,0,1]
    v_pk_fma_f32 v[26:27], v[26:27], v[74:75], v[74:75] op_sel:[0,0,1] op_sel_hi:[1,0,1]
    v_pk_mul_f32 v[20:21], v[20:21], v[80:81]
    v_pk_mul_f32 v[22:23], v[22:23], v[82:83]
    v_pk_mul_f32 v[24:25], v[24:25], v[96:97]
    v_pk_mul_f32 v[26:27], v[26:27], v[98:99]
    v_exp_f32 v20, v20
    v_exp_f32 v21, v21
    v_pk_fma_f32 v[112:113], v[62:63], v[44:45], v[112:113] op_sel:[1,0,0] op_sel_hi:[1,1,1] neg_lo:[1,0,0] neg_hi:[1,0,0]
    v_exp_f32 v22, v22
    v_exp_f32 v23, v23
    v_pk_fma_f32 v[114:115], v[62:63], v[46:47], v[114:115] op_sel:[1,0,0] op_sel_hi:[1,1,1] neg_lo:[1,0,0] neg_hi:[1,0,0]
    v_exp_f32 v24, v24
    v_exp_f32 v25, v25
    v_pk_fma_f32 v[128:129], v[62:63], v[48:49], v[128:129] op_sel:[1,0,0] op_sel_hi:[1,1,1] neg_lo:[1,0,0] neg_hi:[1,0,0]
    v_exp_f32 v26, v26
    v_exp_f32 v27, v27
    v_pk_fma_f32 v[130:131], v[62:63], v[50:51], v[130:131] op_sel:[1,0,0] op_sel_hi:[1,1,1] neg_lo:[1,0,0] neg_hi:[1,0,0]
    v_pk_fma_f32 v[20:21], v[20:21], v[70:71], v[70:71] op_sel:[0,1,1] op_sel_hi:[1,1,1]
    v_pk_fma_f32 v[22:23], v[22:23], v[70:71], v[70:71] op_sel:[0,1,1] op_sel_hi:[1,1,1]
    v_pk_fma_f32 v[24:25], v[24:25], v[70:71], v[70:71] op_sel:[0,1,1] op_sel_hi:[1,1,1]
    v_pk_fma_f32 v[26:27], v[26:27], v[70:71], v[70:71] op_sel:[0,1,1] op_sel_hi:[1,1,1]
    v_rcp_f32 v20, v20
    v_rcp_f32 v21, v21
    v_pk_mul_f32 v[80:81], v[80:81], v[112:113]
    v_rcp_f32 v22, v22
    v_rcp_f32 v23, v23
    v_pk_mul_f32 v[82:83], v[82:83], v[114:115]
    v_rcp_f32 v24, v24
    v_rcp_f32 v25, v25
    v_pk_mul_f32 v[96:97], v[96:97], v[128:129]
    v_rcp_f32 v26, v26
    v_rcp_f32 v27, v27
    v_pk_mul_f32 v[98:99], v[98:99], v[130:131]
    v_pk_mul_f32 v[80:81], v[80:81], v[20:21]
    v_pk_mul_f32 v[82:83], v[82:83], v[22:23]
    v_pk_mul_f32 v[96:97], v[96:97], v[24:25]
    v_pk_mul_f32 v[98:99], v[98:99], v[26:27]
    v_cvt_pk_bf16_f32 v240, v80, v81
    v_cvt_pk_bf16_f32 v241, v82, v83
    v_cvt_pk_bf16_f32 v242, v96, v97
    v_cvt_pk_bf16_f32 v243, v98, v99
    v_pk_fma_f32 v[84:85], v[64:65], v[36:37], v[84:85] op_sel:[0,0,0] op_sel_hi:[0,1,1] neg_lo:[1,0,0] neg_hi:[1,0,0]
    v_pk_fma_f32 v[86:87], v[64:65], v[38:39], v[86:87] op_sel:[0,0,0] op_sel_hi:[0,1,1] neg_lo:[1,0,0] neg_hi:[1,0,0]
    v_pk_fma_f32 v[100:101], v[64:65], v[40:41], v[100:101] op_sel:[0,0,0] op_sel_hi:[0,1,1] neg_lo:[1,0,0] neg_hi:[1,0,0]
    v_pk_fma_f32 v[102:103], v[64:65], v[42:43], v[102:103] op_sel:[0,0,0] op_sel_hi:[0,1,1] neg_lo:[1,0,0] neg_hi:[1,0,0]
    v_pk_mul_f32 v[84:85], v[68:69], v[84:85] op_sel:[0,0] op_sel_hi:[0,1]
    v_pk_mul_f32 v[86:87], v[68:69], v[86:87] op_sel:[0,0] op_sel_hi:[0,1]
    v_pk_mul_f32 v[100:101], v[68:69], v[100:101] op_sel:[0,0] op_sel_hi:[0,1]
    v_pk_mul_f32 v[102:103], v[68:69], v[102:103] op_sel:[0,0] op_sel_hi:[0,1]
    v_pk_mul_f32 v[20:21], v[84:85], v[84:85]
    v_pk_mul_f32 v[22:23], v[86:87], v[86:87]
    v_pk_mul_f32 v[24:25], v[100:101], v[100:101]
    v_pk_mul_f32 v[26:27], v[102:103], v[102:103]
    v_pk_fma_f32 v[20:21], v[20:21], v[74:75], v[74:75] op_sel:[0,0,1] op_sel_hi:[1,0,1]
    v_pk_fma_f32 v[22:23], v[22:23], v[74:75], v[74:75] op_sel:[0,0,1] op_sel_hi:[1,0,1]
    v_pk_fma_f32 v[24:25], v[24:25], v[74:75], v[74:75] op_sel:[0,0,1] op_sel_hi:[1,0,1]
    v_pk_fma_f32 v[26:27], v[26:27], v[74:75], v[74:75] op_sel:[0,0,1] op_sel_hi:[1,0,1]
    v_pk_mul_f32 v[20:21], v[20:21], v[84:85]
    v_pk_mul_f32 v[22:23], v[22:23], v[86:87]
    v_pk_mul_f32 v[24:25], v[24:25], v[100:101]
    v_pk_mul_f32 v[26:27], v[26:27], v[102:103]
    v_exp_f32 v20, v20
    v_exp_f32 v21, v21
    v_pk_fma_f32 v[116:117], v[64:65], v[44:45], v[116:117] op_sel:[0,0,0] op_sel_hi:[0,1,1] neg_lo:[1,0,0] neg_hi:[1,0,0]
    v_exp_f32 v22, v22
    v_exp_f32 v23, v23
    v_pk_fma_f32 v[118:119], v[64:65], v[46:47], v[118:119] op_sel:[0,0,0] op_sel_hi:[0,1,1] neg_lo:[1,0,0] neg_hi:[1,0,0]
    v_exp_f32 v24, v24
    v_exp_f32 v25, v25
    v_pk_fma_f32 v[132:133], v[64:65], v[48:49], v[132:133] op_sel:[0,0,0] op_sel_hi:[0,1,1] neg_lo:[1,0,0] neg_hi:[1,0,0]
    v_exp_f32 v26, v26
    v_exp_f32 v27, v27
    v_pk_fma_f32 v[134:135], v[64:65], v[50:51], v[134:135] op_sel:[0,0,0] op_sel_hi:[0,1,1] neg_lo:[1,0,0] neg_hi:[1,0,0]
    v_pk_fma_f32 v[20:21], v[20:21], v[72:73], v[72:73] op_sel:[0,0,0] op_sel_hi:[1,0,0]
    v_pk_fma_f32 v[22:23], v[22:23], v[72:73], v[72:73] op_sel:[0,0,0] op_sel_hi:[1,0,0]
    v_pk_fma_f32 v[24:25], v[24:25], v[72:73], v[72:73] op_sel:[0,0,0] op_sel_hi:[1,0,0]
    v_pk_fma_f32 v[26:27], v[26:27], v[72:73], v[72:73] op_sel:[0,0,0] op_sel_hi:[1,0,0]
    v_rcp_f32 v20, v20
    v_rcp_f32 v21, v21
    v_pk_mul_f32 v[84:85], v[84:85], v[116:117]
    v_rcp_f32 v22, v22
    v_rcp_f32 v23, v23
    v_pk_mul_f32 v[86:87], v[86:87], v[118:119]
    v_rcp_f32 v24, v24
    v_rcp_f32 v25, v25
    v_pk_mul_f32 v[100:101], v[100:101], v[132:133]
    v_rcp_f32 v26, v26
    v_rcp_f32 v27, v27
    v_pk_mul_f32 v[102:103], v[102:103], v[134:135]
    v_pk_mul_f32 v[84:85], v[84:85], v[20:21]
    v_pk_mul_f32 v[86:87], v[86:87], v[22:23]
    v_pk_mul_f32 v[100:101], v[100:101], v[24:25]
    v_pk_mul_f32 v[102:103], v[102:103], v[26:27]
    v_cvt_pk_bf16_f32 v52, v84, v85
    v_cvt_pk_bf16_f32 v53, v86, v87
    v_cvt_pk_bf16_f32 v54, v100, v101
    v_cvt_pk_bf16_f32 v55, v102, v103
    v_pk_fma_f32 v[88:89], v[64:65], v[36:37], v[88:89] op_sel:[1,0,0] op_sel_hi:[1,1,1] neg_lo:[1,0,0] neg_hi:[1,0,0]
    v_pk_fma_f32 v[90:91], v[64:65], v[38:39], v[90:91] op_sel:[1,0,0] op_sel_hi:[1,1,1] neg_lo:[1,0,0] neg_hi:[1,0,0]
    v_pk_fma_f32 v[104:105], v[64:65], v[40:41], v[104:105] op_sel:[1,0,0] op_sel_hi:[1,1,1] neg_lo:[1,0,0] neg_hi:[1,0,0]
    v_pk_fma_f32 v[106:107], v[64:65], v[42:43], v[106:107] op_sel:[1,0,0] op_sel_hi:[1,1,1] neg_lo:[1,0,0] neg_hi:[1,0,0]
    v_pk_mul_f32 v[88:89], v[68:69], v[88:89] op_sel:[1,0] op_sel_hi:[1,1]
    v_pk_mul_f32 v[90:91], v[68:69], v[90:91] op_sel:[1,0] op_sel_hi:[1,1]
    v_pk_mul_f32 v[104:105], v[68:69], v[104:105] op_sel:[1,0] op_sel_hi:[1,1]
    v_pk_mul_f32 v[106:107], v[68:69], v[106:107] op_sel:[1,0] op_sel_hi:[1,1]
    v_pk_mul_f32 v[20:21], v[88:89], v[88:89]
    v_pk_mul_f32 v[22:23], v[90:91], v[90:91]
    v_pk_mul_f32 v[24:25], v[104:105], v[104:105]
    v_pk_mul_f32 v[26:27], v[106:107], v[106:107]
    v_pk_fma_f32 v[20:21], v[20:21], v[74:75], v[74:75] op_sel:[0,0,1] op_sel_hi:[1,0,1]
    v_pk_fma_f32 v[22:23], v[22:23], v[74:75], v[74:75] op_sel:[0,0,1] op_sel_hi:[1,0,1]
    v_pk_fma_f32 v[24:25], v[24:25], v[74:75], v[74:75] op_sel:[0,0,1] op_sel_hi:[1,0,1]
    v_pk_fma_f32 v[26:27], v[26:27], v[74:75], v[74:75] op_sel:[0,0,1] op_sel_hi:[1,0,1]
    v_pk_mul_f32 v[20:21], v[20:21], v[88:89]
    v_pk_mul_f32 v[22:23], v[22:23], v[90:91]
    v_pk_mul_f32 v[24:25], v[24:25], v[104:105]
    v_pk_mul_f32 v[26:27], v[26:27], v[106:107]
    v_exp_f32 v20, v20
    v_exp_f32 v21, v21
    v_pk_fma_f32 v[120:121], v[64:65], v[44:45], v[120:121] op_sel:[1,0,0] op_sel_hi:[1,1,1] neg_lo:[1,0,0] neg_hi:[1,0,0]
    v_exp_f32 v22, v22
    v_exp_f32 v23, v23
    v_pk_fma_f32 v[122:123], v[64:65], v[46:47], v[122:123] op_sel:[1,0,0] op_sel_hi:[1,1,1] neg_lo:[1,0,0] neg_hi:[1,0,0]
    v_exp_f32 v24, v24
    v_exp_f32 v25, v25
    v_pk_fma_f32 v[136:137], v[64:65], v[48:49], v[136:137] op_sel:[1,0,0] op_sel_hi:[1,1,1] neg_lo:[1,0,0] neg_hi:[1,0,0]
    v_exp_f32 v26, v26
    v_exp_f32 v27, v27
    v_pk_fma_f32 v[138:139], v[64:65], v[50:51], v[138:139] op_sel:[1,0,0] op_sel_hi:[1,1,1] neg_lo:[1,0,0] neg_hi:[1,0,0]
    v_pk_fma_f32 v[20:21], v[20:21], v[72:73], v[72:73] op_sel:[0,1,1] op_sel_hi:[1,1,1]
    v_pk_fma_f32 v[22:23], v[22:23], v[72:73], v[72:73] op_sel:[0,1,1] op_sel_hi:[1,1,1]
    v_pk_fma_f32 v[24:25], v[24:25], v[72:73], v[72:73] op_sel:[0,1,1] op_sel_hi:[1,1,1]
    v_pk_fma_f32 v[26:27], v[26:27], v[72:73], v[72:73] op_sel:[0,1,1] op_sel_hi:[1,1,1]
    v_rcp_f32 v20, v20
    v_rcp_f32 v21, v21
    v_pk_mul_f32 v[88:89], v[88:89], v[120:121]
    v_rcp_f32 v22, v22
    v_rcp_f32 v23, v23
    v_pk_mul_f32 v[90:91], v[90:91], v[122:123]
    v_rcp_f32 v24, v24
    v_rcp_f32 v25, v25
    v_pk_mul_f32 v[104:105], v[104:105], v[136:137]
    v_rcp_f32 v26, v26
    v_rcp_f32 v27, v27
    v_pk_mul_f32 v[106:107], v[106:107], v[138:139]
    v_pk_mul_f32 v[88:89], v[88:89], v[20:21]
    v_pk_mul_f32 v[90:91], v[90:91], v[22:23]
    v_pk_mul_f32 v[104:105], v[104:105], v[24:25]
    v_pk_mul_f32 v[106:107], v[106:107], v[26:27]
    v_cvt_pk_bf16_f32 v56, v88, v89
    v_cvt_pk_bf16_f32 v57, v90, v91
    v_cvt_pk_bf16_f32 v58, v104, v105
    v_cvt_pk_bf16_f32 v59, v106, v107
    s_sub_u32 s9, s81, 1
    v_sub_u32 v7, s9, v3
    v_lshlrev_b32 v7, 9, v7
    v_lshl_add_u32 v7, v2, 4, v7
    s_mov_b32 s75, 1
    buffer_store_dwordx4 v[236:239], v9, s[60:63], s80 offen offset:0 sc1
    buffer_store_dwordx4 v[240:243], v9, s[60:63], s80 offen offset:1024 sc1
    buffer_store_dwordx4 v[52:55], v9, s[60:63], s80 offen offset:2048 sc1
    buffer_store_dwordx4 v[56:59], v9, s[60:63], s80 offen offset:3072 sc1
    s_mul_i32 s72, s3, 11520
    s_add_u32 s72, s72, 53248
    v_add_u32 v10, s72, v9
    ds_read_b128 v[32:35], v11 offset:2304
    ds_read_b128 v[36:39], v11 offset:2560
    ds_read_b128 v[40:43], v11 offset:2816
    v_pk_mul_f32 v[20:21], v[246:247], v[140:141] op_sel_hi:[0,1]
    v_pk_mul_f32 v[22:23], v[248:249], v[156:157] op_sel_hi:[0,1]
    v_pk_mul_f32 v[24:25], v[250:251], v[172:173] op_sel_hi:[0,1]
    v_pk_mul_f32 v[26:27], v[252:253], v[188:189] op_sel_hi:[0,1]
    v_pk_mul_f32 v[28:29], v[254:255], v[204:205] op_sel_hi:[0,1]
    v_fmac_f32_dpp v20, v140, v230 row_ror:8 row_mask:0xf bank_mask:0xf
    v_fmac_f32_dpp v22, v156, v231 row_ror:8 row_mask:0xf bank_mask:0xf
    v_fmac_f32_dpp v24, v172, v232 row_ror:8 row_mask:0xf bank_mask:0xf
    v_fmac_f32_dpp v26, v188, v233 row_ror:8 row_mask:0xf bank_mask:0xf
    v_fmac_f32_dpp v28, v204, v234 row_ror:8 row_mask:0xf bank_mask:0xf
    v_fmac_f32_dpp v21, v141, v230 row_ror:8 row_mask:0xf bank_mask:0xf
    v_fmac_f32_dpp v23, v157, v231 row_ror:8 row_mask:0xf bank_mask:0xf
    v_fmac_f32_dpp v25, v173, v232 row_ror:8 row_mask:0xf bank_mask:0xf
    v_fmac_f32_dpp v27, v189, v233 row_ror:8 row_mask:0xf bank_mask:0xf
    v_fmac_f32_dpp v29, v205, v234 row_ror:8 row_mask:0xf bank_mask:0xf
    v_pk_mul_f32 v[140:141], v[246:247], v[142:143] op_sel_hi:[0,1]
    v_pk_mul_f32 v[156:157], v[248:249], v[158:159] op_sel_hi:[0,1]
    v_pk_mul_f32 v[172:173], v[250:251], v[174:175] op_sel_hi:[0,1]
    v_pk_mul_f32 v[188:189], v[252:253], v[190:191] op_sel_hi:[0,1]
    v_pk_mul_f32 v[204:205], v[254:255], v[206:207] op_sel_hi:[0,1]
    v_fmac_f32_dpp v140, v142, v230 row_ror:8 row_mask:0xf bank_mask:0xf
    v_fmac_f32_dpp v156, v158, v231 row_ror:8 row_mask:0xf bank_mask:0xf
    v_fmac_f32_dpp v172, v174, v232 row_ror:8 row_mask:0xf bank_mask:0xf
    v_fmac_f32_dpp v188, v190, v233 row_ror:8 row_mask:0xf bank_mask:0xf
    v_fmac_f32_dpp v204, v206, v234 row_ror:8 row_mask:0xf bank_mask:0xf
    v_fmac_f32_dpp v141, v143, v230 row_ror:8 row_mask:0xf bank_mask:0xf
    v_fmac_f32_dpp v157, v159, v231 row_ror:8 row_mask:0xf bank_mask:0xf
    v_fmac_f32_dpp v173, v175, v232 row_ror:8 row_mask:0xf bank_mask:0xf
    v_fmac_f32_dpp v189, v191, v233 row_ror:8 row_mask:0xf bank_mask:0xf
    v_fmac_f32_dpp v205, v207, v234 row_ror:8 row_mask:0xf bank_mask:0xf
    v_pk_mul_f32 v[142:143], v[246:247], v[144:145] op_sel_hi:[0,1]
    v_pk_mul_f32 v[158:159], v[248:249], v[160:161] op_sel_hi:[0,1]
    v_pk_mul_f32 v[174:175], v[250:251], v[176:177] op_sel_hi:[0,1]
    v_pk_mul_f32 v[190:191], v[252:253], v[192:193] op_sel_hi:[0,1]
    v_pk_mul_f32 v[206:207], v[254:255], v[208:209] op_sel_hi:[0,1]
    v_fmac_f32_dpp v142, v144, v230 row_ror:8 row_mask:0xf bank_mask:0xf
    v_fmac_f32_dpp v158, v160, v231 row_ror:8 row_mask:0xf bank_mask:0xf
    v_fmac_f32_dpp v174, v176, v232 row_ror:8 row_mask:0xf bank_mask:0xf
    v_fmac_f32_dpp v190, v192, v233 row_ror:8 row_mask:0xf bank_mask:0xf
    v_fmac_f32_dpp v206, v208, v234 row_ror:8 row_mask:0xf bank_mask:0xf
    v_fmac_f32_dpp v143, v145, v230 row_ror:8 row_mask:0xf bank_mask:0xf
    v_fmac_f32_dpp v159, v161, v231 row_ror:8 row_mask:0xf bank_mask:0xf
    v_fmac_f32_dpp v175, v177, v232 row_ror:8 row_mask:0xf bank_mask:0xf
    v_fmac_f32_dpp v191, v193, v233 row_ror:8 row_mask:0xf bank_mask:0xf
    v_fmac_f32_dpp v207, v209, v234 row_ror:8 row_mask:0xf bank_mask:0xf
    v_pk_mul_f32 v[144:145], v[246:247], v[146:147] op_sel_hi:[0,1]
    v_pk_mul_f32 v[160:161], v[248:249], v[162:163] op_sel_hi:[0,1]
    v_pk_mul_f32 v[176:177], v[250:251], v[178:179] op_sel_hi:[0,1]
    v_pk_mul_f32 v[192:193], v[252:253], v[194:195] op_sel_hi:[0,1]
    v_pk_mul_f32 v[208:209], v[254:255], v[210:211] op_sel_hi:[0,1]
    v_fmac_f32_dpp v144, v146, v230 row_ror:8 row_mask:0xf bank_mask:0xf
    v_fmac_f32_dpp v160, v162, v231 row_ror:8 row_mask:0xf bank_mask:0xf
    v_fmac_f32_dpp v176, v178, v232 row_ror:8 row_mask:0xf bank_mask:0xf
    v_fmac_f32_dpp v192, v194, v233 row_ror:8 row_mask:0xf bank_mask:0xf
    v_fmac_f32_dpp v208, v210, v234 row_ror:8 row_mask:0xf bank_mask:0xf
    v_fmac_f32_dpp v145, v147, v230 row_ror:8 row_mask:0xf bank_mask:0xf
    v_fmac_f32_dpp v161, v163, v231 row_ror:8 row_mask:0xf bank_mask:0xf
    v_fmac_f32_dpp v177, v179, v232 row_ror:8 row_mask:0xf bank_mask:0xf
    v_fmac_f32_dpp v193, v195, v233 row_ror:8 row_mask:0xf bank_mask:0xf
    v_fmac_f32_dpp v209, v211, v234 row_ror:8 row_mask:0xf bank_mask:0xf
    v_pk_mul_f32 v[146:147], v[246:247], v[148:149] op_sel_hi:[0,1]
    v_pk_mul_f32 v[162:163], v[248:249], v[164:165] op_sel_hi:[0,1]
    v_pk_mul_f32 v[178:179], v[250:251], v[180:181] op_sel_hi:[0,1]
    v_pk_mul_f32 v[194:195], v[252:253], v[196:197] op_sel_hi:[0,1]
    v_pk_mul_f32 v[210:211], v[254:255], v[212:213] op_sel_hi:[0,1]
    v_fmac_f32_dpp v146, v148, v230 row_ror:8 row_mask:0xf bank_mask:0xf
    v_fmac_f32_dpp v162, v164, v231 row_ror:8 row_mask:0xf bank_mask:0xf
    v_fmac_f32_dpp v178, v180, v232 row_ror:8 row_mask:0xf bank_mask:0xf
    v_fmac_f32_dpp v194, v196, v233 row_ror:8 row_mask:0xf bank_mask:0xf
    v_fmac_f32_dpp v210, v212, v234 row_ror:8 row_mask:0xf bank_mask:0xf
    v_fmac_f32_dpp v147, v149, v230 row_ror:8 row_mask:0xf bank_mask:0xf
    v_fmac_f32_dpp v163, v165, v231 row_ror:8 row_mask:0xf bank_mask:0xf
    v_fmac_f32_dpp v179, v181, v232 row_ror:8 row_mask:0xf bank_mask:0xf
    v_fmac_f32_dpp v195, v197, v233 row_ror:8 row_mask:0xf bank_mask:0xf
    v_fmac_f32_dpp v211, v213, v234 row_ror:8 row_mask:0xf bank_mask:0xf
    v_pk_mul_f32 v[148:149], v[246:247], v[150:151] op_sel_hi:[0,1]
    v_pk_mul_f32 v[164:165], v[248:249], v[166:167] op_sel_hi:[0,1]
    v_pk_mul_f32 v[180:181], v[250:251], v[182:183] op_sel_hi:[0,1]
    v_pk_mul_f32 v[196:197], v[252:253], v[198:199] op_sel_hi:[0,1]
    v_pk_mul_f32 v[212:213], v[254:255], v[214:215] op_sel_hi:[0,1]
    v_fmac_f32_dpp v148, v150, v230 row_ror:8 row_mask:0xf bank_mask:0xf
    v_fmac_f32_dpp v164, v166, v231 row_ror:8 row_mask:0xf bank_mask:0xf
    v_fmac_f32_dpp v180, v182, v232 row_ror:8 row_mask:0xf bank_mask:0xf
    v_fmac_f32_dpp v196, v198, v233 row_ror:8 row_mask:0xf bank_mask:0xf
    v_fmac_f32_dpp v212, v214, v234 row_ror:8 row_mask:0xf bank_mask:0xf
    v_fmac_f32_dpp v149, v151, v230 row_ror:8 row_mask:0xf bank_mask:0xf
    v_fmac_f32_dpp v165, v167, v231 row_ror:8 row_mask:0xf bank_mask:0xf
    v_fmac_f32_dpp v181, v183, v232 row_ror:8 row_mask:0xf bank_mask:0xf
    v_fmac_f32_dpp v197, v199, v233 row_ror:8 row_mask:0xf bank_mask:0xf
    v_fmac_f32_dpp v213, v215, v234 row_ror:8 row_mask:0xf bank_mask:0xf
    v_pk_mul_f32 v[150:151], v[246:247], v[152:153] op_sel_hi:[0,1]
    v_pk_mul_f32 v[166:167], v[248:249], v[168:169] op_sel_hi:[0,1]
    v_pk_mul_f32 v[182:183], v[250:251], v[184:185] op_sel_hi:[0,1]
    v_pk_mul_f32 v[198:199], v[252:253], v[200:201] op_sel_hi:[0,1]
    v_pk_mul_f32 v[214:215], v[254:255], v[216:217] op_sel_hi:[0,1]
    v_fmac_f32_dpp v150, v152, v230 row_ror:8 row_mask:0xf bank_mask:0xf
    v_fmac_f32_dpp v166, v168, v231 row_ror:8 row_mask:0xf bank_mask:0xf
    v_fmac_f32_dpp v182, v184, v232 row_ror:8 row_mask:0xf bank_mask:0xf
    v_fmac_f32_dpp v198, v200, v233 row_ror:8 row_mask:0xf bank_mask:0xf
    v_fmac_f32_dpp v214, v216, v234 row_ror:8 row_mask:0xf bank_mask:0xf
    v_fmac_f32_dpp v151, v153, v230 row_ror:8 row_mask:0xf bank_mask:0xf
    v_fmac_f32_dpp v167, v169, v231 row_ror:8 row_mask:0xf bank_mask:0xf
    v_fmac_f32_dpp v183, v185, v232 row_ror:8 row_mask:0xf bank_mask:0xf
    v_fmac_f32_dpp v199, v201, v233 row_ror:8 row_mask:0xf bank_mask:0xf
    v_fmac_f32_dpp v215, v217, v234 row_ror:8 row_mask:0xf bank_mask:0xf
    v_pk_mul_f32 v[152:153], v[246:247], v[154:155] op_sel_hi:[0,1]
    v_pk_mul_f32 v[168:169], v[248:249], v[170:171] op_sel_hi:[0,1]
    v_pk_mul_f32 v[184:185], v[250:251], v[186:187] op_sel_hi:[0,1]
    v_pk_mul_f32 v[200:201], v[252:253], v[202:203] op_sel_hi:[0,1]
    v_pk_mul_f32 v[216:217], v[254:255], v[218:219] op_sel_hi:[0,1]
    v_fmac_f32_dpp v152, v154, v230 row_ror:8 row_mask:0xf bank_mask:0xf
    v_fmac_f32_dpp v168, v170, v231 row_ror:8 row_mask:0xf bank_mask:0xf
    v_fmac_f32_dpp v184, v186, v232 row_ror:8 row_mask:0xf bank_mask:0xf
    v_fmac_f32_dpp v200, v202, v233 row_ror:8 row_mask:0xf bank_mask:0xf
    v_fmac_f32_dpp v216, v218, v234 row_ror:8 row_mask:0xf bank_mask:0xf
    v_fmac_f32_dpp v153, v155, v230 row_ror:8 row_mask:0xf bank_mask:0xf
    v_fmac_f32_dpp v169, v171, v231 row_ror:8 row_mask:0xf bank_mask:0xf
    v_fmac_f32_dpp v185, v187, v232 row_ror:8 row_mask:0xf bank_mask:0xf
    v_fmac_f32_dpp v201, v203, v233 row_ror:8 row_mask:0xf bank_mask:0xf
    v_fmac_f32_dpp v217, v219, v234 row_ror:8 row_mask:0xf bank_mask:0xf
    s_mov_b32 s77, 0
    s_cmp_eq_u32 s75, 0
    s_cbranch_scc1 L_k1_early
    s_branch L_k1_hd
    s_lshl_b32 s9, s81, 2
    s_lshr_b32 s10, s7, 1
    s_add_u32 s9, s9, s10
    s_mul_i32 s9, s9, 4224
    s_and_b32 s10, s7, 1
    s_lshl_b32 s10, s10, 1
    s_add_u32 s10, s10, s5
    s_mul_i32 s10, s10, 4
    s_add_u32 s9, s9, s10
    s_add_u32 s9, s9, 0x1160010
    v_mov_b32 v30, s9
    v_mov_b32 v31, s82
    s_waitcnt vmcnt(0)
    s_mov_b64 exec, 1
    buffer_store_dword v31, v30, s[60:63], 0 offen sc1
    s_mov_b64 exec, -1
    s_mov_b32 s77, 1
    s_mov_b32 s12, 0
L_k1_hr:
    s_load_dwordx16 s[16:31], s[54:55], 0 glc
    s_load_dwordx16 s[32:47], s[54:55], 64 glc
    s_waitcnt lgkmcnt(0)
    s_mov_b32 s9, 0
    s_cmp_lg_u64 s[46:47], s[56:57]
    s_addc_u32 s9, s9, s9
    s_cmp_lg_u64 s[44:45], s[56:57]
    s_addc_u32 s9, s9, s9
    s_cmp_lg_u64 s[42:43], s[56:57]
    s_addc_u32 s9, s9, s9
    s_cmp_lg_u64 s[40:41], s[56:57]
    s_addc_u32 s9, s9, s9
    s_cmp_lg_u64 s[38:39], s[56:57]
    s_addc_u32 s9, s9, s9
    s_cmp_lg_u64 s[36:37], s[56:57]
    s_addc_u32 s9, s9, s9
    s_cmp_lg_u64 s[34:35], s[56:57]
    s_addc_u32 s9, s9, s9
    s_cmp_lg_u64 s[32:33], s[56:57]
    s_addc_u32 s9, s9, s9
    s_cmp_lg_u64 s[30:31], s[56:57]
    s_addc_u32 s9, s9, s9
    s_cmp_lg_u64 s[28:29], s[56:57]
    s_addc_u32 s9, s9, s9
    s_cmp_lg_u64 s[26:27], s[56:57]
    s_addc_u32 s9, s9, s9
    s_cmp_lg_u64 s[24:25], s[56:57]
    s_addc_u32 s9, s9, s9
    s_cmp_lg_u64 s[22:23], s[56:57]
    s_addc_u32 s9, s9, s9
    s_cmp_lg_u64 s[20:21], s[56:57]
    s_addc_u32 s9, s9, s9
    s_cmp_lg_u64 s[18:19], s[56:57]
    s_addc_u32 s9, s9, s9
    s_cmp_lg_u64 s[16:17], s[56:57]
    s_addc_u32 s9, s9, s9
    s_and_b32 s9, s9, s59
    s_cbranch_scc0 L_k1_hd
    s_sleep 3
    s_add_u32 s12, s12, 1
    s_cmp_lt_u32 s12, 0x100000
    s_cbranch_scc1 L_k1_hr
L_k1_hd:
    buffer_load_dwordx4 v[76:79], v7, s[64:67], 0 offen sc1
    buffer_load_dwordx4 v[80:83], v7, s[64:67], 0 offen offset:256 sc1
    v_subrev_u32 v6, 2048, v7
    buffer_load_dwordx4 v[84:87], v6, s[64:67], 0 offen sc1
    buffer_load_dwordx4 v[88:91], v6, s[64:67], 0 offen offset:256 sc1
    v_subrev_u32 v6, 4096, v7
    buffer_load_dwordx4 v[92:95], v6, s[64:67], 0 offen sc1
    buffer_load_dwordx4 v[96:99], v6, s[64:67], 0 offen offset:256 sc1
    v_subrev_u32 v6, 6144, v7
    buffer_load_dwordx4 v[100:103], v6, s[64:67], 0 offen sc1
    buffer_load_dwordx4 v[104:107], v6, s[64:67], 0 offen offset:256 sc1
    v_subrev_u32 v6, 8192, v7
    buffer_load_dwordx4 v[108:111], v6, s[64:67], 0 offen sc1
    buffer_load_dwordx4 v[112:115], v6, s[64:67], 0 offen offset:256 sc1
    v_subrev_u32 v6, 10240, v7
    buffer_load_dwordx4 v[116:119], v6, s[64:67], 0 offen sc1
    buffer_load_dwordx4 v[120:123], v6, s[64:67], 0 offen offset:256 sc1
    v_subrev_u32 v6, 12288, v7
    buffer_load_dwordx4 v[124:127], v6, s[64:67], 0 offen sc1
    buffer_load_dwordx4 v[128:131], v6, s[64:67], 0 offen offset:256 sc1
    v_subrev_u32 v6, 14336, v7
    buffer_load_dwordx4 v[132:135], v6, s[64:67], 0 offen sc1
    buffer_load_dwordx4 v[136:139], v6, s[64:67], 0 offen offset:256 sc1
    s_mov_b32 s12, 0
    s_branch L_k1_poll
L_k1_early:
    s_mov_b32 s12, 0
    s_waitcnt vmcnt(4)
    s_branch L_k1_poll2
L_k1_poll:
    s_waitcnt vmcnt(0)
L_k1_poll2:
    s_mov_b32 s11, 0
    v_cmp_ne_u32 s[24:25], s82, v79
    v_cmp_ne_u32 s[26:27], s82, v83
    v_cmp_le_i32 vcc, 0, v7
    s_or_b64 s[24:25], s[24:25], s[26:27]
    s_and_b64 s[24:25], s[24:25], vcc
    s_cbranch_scc0 L_k1_pu0
    s_cmp_lg_u32 s11, 0
    s_cbranch_scc1 L_k1_ps0
    s_sleep 8
L_k1_ps0:
    s_mov_b32 s11, 1
    v_subrev_u32 v6, 0, v7
    s_mov_b64 exec, s[24:25]
    buffer_load_dwordx4 v[76:79], v6, s[64:67], 0 offen sc1
    buffer_load_dwordx4 v[80:83], v6, s[64:67], 0 offen offset:256 sc1
    s_mov_b64 exec, -1
L_k1_pu0:
    v_cmp_ne_u32 s[24:25], s82, v87
    v_cmp_ne_u32 s[26:27], s82, v91
    v_cmp_le_i32 vcc, 2048, v7
    s_or_b64 s[24:25], s[24:25], s[26:27]
    s_and_b64 s[24:25], s[24:25], vcc
    s_cbranch_scc0 L_k1_pu1
    s_cmp_lg_u32 s11, 0
    s_cbranch_scc1 L_k1_ps1
    s_sleep 8
L_k1_ps1:
    s_mov_b32 s11, 1
    v_subrev_u32 v6, 2048, v7
    s_mov_b64 exec, s[24:25]
    buffer_load_dwordx4 v[84:87], v6, s[64:67], 0 offen sc1
    buffer_load_dwordx4 v[88:91], v6, s[64:67], 0 offen offset:256 sc1
    s_mov_b64 exec, -1
L_k1_pu1:
    v_cmp_ne_u32 s[24:25], s82, v95
    v_cmp_ne_u32 s[26:27], s82, v99
    v_cmp_le_i32 vcc, 4096, v7
    s_or_b64 s[24:25], s[24:25], s[26:27]
    s_and_b64 s[24:25], s[24:25], vcc
    s_cbranch_scc0 L_k1_pu2
    s_cmp_lg_u32 s11, 0
    s_cbranch_scc1 L_k1_ps2
    s_sleep 8
L_k1_ps2:
    s_mov_b32 s11, 1
    v_subrev_u32 v6, 4096, v7
    s_mov_b64 exec, s[24:25]
    buffer_load_dwordx4 v[92:95], v6, s[64:67], 0 offen sc1
    buffer_load_dwordx4 v[96:99], v6, s[64:67], 0 offen offset:256 sc1
    s_mov_b64 exec, -1
L_k1_pu2:
    v_cmp_ne_u32 s[24:25], s82, v103
    v_cmp_ne_u32 s[26:27], s82, v107
    v_cmp_le_i32 vcc, 6144, v7
    s_or_b64 s[24:25], s[24:25], s[26:27]
    s_and_b64 s[24:25], s[24:25], vcc
    s_cbranch_scc0 L_k1_pu3
    s_cmp_lg_u32 s11, 0
    s_cbranch_scc1 L_k1_ps3
    s_sleep 8
L_k1_ps3:
    s_mov_b32 s11, 1
    v_subrev_u32 v6, 6144, v7
    s_mov_b64 exec, s[24:25]
    buffer_load_dwordx4 v[100:103], v6, s[64:67], 0 offen sc1
    buffer_load_dwordx4 v[104:107], v6, s[64:67], 0 offen offset:256 sc1
    s_mov_b64 exec, -1
L_k1_pu3:
    v_cmp_ne_u32 s[24:25], s82, v111
    v_cmp_ne_u32 s[26:27], s82, v115
    v_cmp_le_i32 vcc, 8192, v7
    s_or_b64 s[24:25], s[24:25], s[26:27]
    s_and_b64 s[24:25], s[24:25], vcc
    s_cbranch_scc0 L_k1_pu4
    s_cmp_lg_u32 s11, 0
    s_cbranch_scc1 L_k1_ps4
    s_sleep 8
L_k1_ps4:
    s_mov_b32 s11, 1
    v_subrev_u32 v6, 8192, v7
    s_mov_b64 exec, s[24:25]
    buffer_load_dwordx4 v[108:111], v6, s[64:67], 0 offen sc1
    buffer_load_dwordx4 v[112:115], v6, s[64:67], 0 offen offset:256 sc1
    s_mov_b64 exec, -1
L_k1_pu4:
    v_cmp_ne_u32 s[24:25], s82, v119
    v_cmp_ne_u32 s[26:27], s82, v123
    v_cmp_le_i32 vcc, 10240, v7
    s_or_b64 s[24:25], s[24:25], s[26:27]
    s_and_b64 s[24:25], s[24:25], vcc
    s_cbranch_scc0 L_k1_pu5
    s_cmp_lg_u32 s11, 0
    s_cbranch_scc1 L_k1_ps5
    s_sleep 8
L_k1_ps5:
    s_mov_b32 s11, 1
    v_subrev_u32 v6, 10240, v7
    s_mov_b64 exec, s[24:25]
    buffer_load_dwordx4 v[116:119], v6, s[64:67], 0 offen sc1
    buffer_load_dwordx4 v[120:123], v6, s[64:67], 0 offen offset:256 sc1
    s_mov_b64 exec, -1
L_k1_pu5:
    v_cmp_ne_u32 s[24:25], s82, v127
    v_cmp_ne_u32 s[26:27], s82, v131
    v_cmp_le_i32 vcc, 12288, v7
    s_or_b64 s[24:25], s[24:25], s[26:27]
    s_and_b64 s[24:25], s[24:25], vcc
    s_cbranch_scc0 L_k1_pu6
    s_cmp_lg_u32 s11, 0
    s_cbranch_scc1 L_k1_ps6
    s_sleep 8
L_k1_ps6:
    s_mov_b32 s11, 1
    v_subrev_u32 v6, 12288, v7
    s_mov_b64 exec, s[24:25]
    buffer_load_dwordx4 v[124:127], v6, s[64:67], 0 offen sc1
    buffer_load_dwordx4 v[128:131], v6, s[64:67], 0 offen offset:256 sc1
    s_mov_b64 exec, -1
L_k1_pu6:
    v_cmp_ne_u32 s[24:25], s82, v135
    v_cmp_ne_u32 s[26:27], s82, v139
    v_cmp_le_i32 vcc, 14336, v7
    s_or_b64 s[24:25], s[24:25], s[26:27]
    s_and_b64 s[24:25], s[24:25], vcc
    s_cbranch_scc0 L_k1_pu7
    s_cmp_lg_u32 s11, 0
    s_cbranch_scc1 L_k1_ps7
    s_sleep 8
L_k1_ps7:
    s_mov_b32 s11, 1
    v_subrev_u32 v6, 14336, v7
    s_mov_b64 exec, s[24:25]
    buffer_load_dwordx4 v[132:135], v6, s[64:67], 0 offen sc1
    buffer_load_dwordx4 v[136:139], v6, s[64:67], 0 offen offset:256 sc1
    s_mov_b64 exec, -1
L_k1_pu7:
    s_add_u32 s12, s12, 1
    s_cmp_eq_u32 s11, 0
    s_cbranch_scc1 L_k1_polled
    s_cmp_lt_u32 s12, 0x40000
    s_cbranch_scc1 L_k1_poll
L_k1_polled:
    s_waitcnt lgkmcnt(0)
    v_fmac_f32 v124, v32, v132
    v_fmac_f32 v125, v33, v133
    v_fmac_f32 v126, v34, v134
    v_fmac_f32 v128, v35, v136
    v_fmac_f32 v129, v36, v137
    v_fmac_f32_dpp v124, v132, v37 row_ror:8 row_mask:0xf bank_mask:0xf
    v_fmac_f32_dpp v125, v133, v38 row_ror:8 row_mask:0xf bank_mask:0xf
    v_fmac_f32_dpp v126, v134, v39 row_ror:8 row_mask:0xf bank_mask:0xf
    v_fmac_f32_dpp v128, v136, v40 row_ror:8 row_mask:0xf bank_mask:0xf
    v_fmac_f32_dpp v129, v137, v41 row_ror:8 row_mask:0xf bank_mask:0xf
    v_fmac_f32 v116, v32, v124
    v_fmac_f32 v117, v33, v125
    v_fmac_f32 v118, v34, v126
    v_fmac_f32 v120, v35, v128
    v_fmac_f32 v121, v36, v129
    v_fmac_f32_dpp v116, v124, v37 row_ror:8 row_mask:0xf bank_mask:0xf
    v_fmac_f32_dpp v117, v125, v38 row_ror:8 row_mask:0xf bank_mask:0xf
    v_fmac_f32_dpp v118, v126, v39 row_ror:8 row_mask:0xf bank_mask:0xf
    v_fmac_f32_dpp v120, v128, v40 row_ror:8 row_mask:0xf bank_mask:0xf
    v_fmac_f32_dpp v121, v129, v41 row_ror:8 row_mask:0xf bank_mask:0xf
    v_fmac_f32 v108, v32, v116
    v_fmac_f32 v109, v33, v117
    v_fmac_f32 v110, v34, v118
    v_fmac_f32 v112, v35, v120
    v_fmac_f32 v113, v36, v121
    v_fmac_f32_dpp v108, v116, v37 row_ror:8 row_mask:0xf bank_mask:0xf
    v_fmac_f32_dpp v109, v117, v38 row_ror:8 row_mask:0xf bank_mask:0xf
    v_fmac_f32_dpp v110, v118, v39 row_ror:8 row_mask:0xf bank_mask:0xf
    v_fmac_f32_dpp v112, v120, v40 row_ror:8 row_mask:0xf bank_mask:0xf
    v_fmac_f32_dpp v113, v121, v41 row_ror:8 row_mask:0xf bank_mask:0xf
    ds_read_b128 v[116:119], v10 offset:0
    ds_read_b128 v[120:123], v10 offset:1024
    ds_read_b128 v[124:127], v10 offset:2048
    ds_read_b128 v[128:131], v10 offset:3072
    ds_read_b128 v[132:135], v10 offset:4096
    v_fmac_f32 v100, v32, v108
    v_fmac_f32 v101, v33, v109
    v_fmac_f32 v102, v34, v110
    v_fmac_f32 v104, v35, v112
    v_fmac_f32 v105, v36, v113
    v_fmac_f32_dpp v100, v108, v37 row_ror:8 row_mask:0xf bank_mask:0xf
    v_fmac_f32_dpp v101, v109, v38 row_ror:8 row_mask:0xf bank_mask:0xf
    v_fmac_f32_dpp v102, v110, v39 row_ror:8 row_mask:0xf bank_mask:0xf
    v_fmac_f32_dpp v104, v112, v40 row_ror:8 row_mask:0xf bank_mask:0xf
    v_fmac_f32_dpp v105, v113, v41 row_ror:8 row_mask:0xf bank_mask:0xf
    v_fmac_f32 v92, v32, v100
    v_fmac_f32 v93, v33, v101
    v_fmac_f32 v94, v34, v102
    v_fmac_f32 v96, v35, v104
    v_fmac_f32 v97, v36, v105
    v_fmac_f32_dpp v92, v100, v37 row_ror:8 row_mask:0xf bank_mask:0xf
    v_fmac_f32_dpp v93, v101, v38 row_ror:8 row_mask:0xf bank_mask:0xf
    v_fmac_f32_dpp v94, v102, v39 row_ror:8 row_mask:0xf bank_mask:0xf
    v_fmac_f32_dpp v96, v104, v40 row_ror:8 row_mask:0xf bank_mask:0xf
    v_fmac_f32_dpp v97, v105, v41 row_ror:8 row_mask:0xf bank_mask:0xf
    v_fmac_f32 v84, v32, v92
    v_fmac_f32 v85, v33, v93
    v_fmac_f32 v86, v34, v94
    v_fmac_f32 v88, v35, v96
    v_fmac_f32 v89, v36, v97
    v_fmac_f32_dpp v84, v92, v37 row_ror:8 row_mask:0xf bank_mask:0xf
    v_fmac_f32_dpp v85, v93, v38 row_ror:8 row_mask:0xf bank_mask:0xf
    v_fmac_f32_dpp v86, v94, v39 row_ror:8 row_mask:0xf bank_mask:0xf
    v_fmac_f32_dpp v88, v96, v40 row_ror:8 row_mask:0xf bank_mask:0xf
    v_fmac_f32_dpp v89, v97, v41 row_ror:8 row_mask:0xf bank_mask:0xf
    v_fmac_f32 v76, v32, v84
    v_fmac_f32 v77, v33, v85
    v_fmac_f32 v78, v34, v86
    v_fmac_f32 v80, v35, v88
    v_fmac_f32 v81, v36, v89
    v_fmac_f32_dpp v76, v84, v37 row_ror:8 row_mask:0xf bank_mask:0xf
    v_fmac_f32_dpp v77, v85, v38 row_ror:8 row_mask:0xf bank_mask:0xf
    v_fmac_f32_dpp v78, v86, v39 row_ror:8 row_mask:0xf bank_mask:0xf
    v_fmac_f32_dpp v80, v88, v40 row_ror:8 row_mask:0xf bank_mask:0xf
    v_fmac_f32_dpp v81, v89, v41 row_ror:8 row_mask:0xf bank_mask:0xf
    s_waitcnt lgkmcnt(0)
    v_mul_f32 v84, v116, v76
    v_mul_f32 v85, v117, v77
    v_mul_f32 v86, v118, v78
    v_mul_f32 v88, v119, v80
    v_mul_f32 v89, v120, v81
    v_fmac_f32_dpp v84, v76, v121 row_ror:8 row_mask:0xf bank_mask:0xf
    v_fmac_f32_dpp v85, v77, v122 row_ror:8 row_mask:0xf bank_mask:0xf
    v_fmac_f32_dpp v86, v78, v123 row_ror:8 row_mask:0xf bank_mask:0xf
    v_fmac_f32_dpp v88, v80, v124 row_ror:8 row_mask:0xf bank_mask:0xf
    v_fmac_f32_dpp v89, v81, v125 row_ror:8 row_mask:0xf bank_mask:0xf
    v_mov_b32 v92, v84
    v_mov_b32 v93, v85
    v_mov_b32 v94, v86
    v_mov_b32 v96, v88
    v_mov_b32 v97, v89
    v_permlane16_swap_b32 v84, v92
    v_permlane16_swap_b32 v85, v93
    v_permlane16_swap_b32 v86, v94
    v_permlane16_swap_b32 v88, v96
    v_permlane16_swap_b32 v89, v97
    v_add_f32 v84, v84, v92
    v_add_f32 v85, v85, v93
    v_add_f32 v86, v86, v94
    v_add_f32 v88, v88, v96
    v_add_f32 v89, v89, v97
    v_mov_b32 v92, v84
    v_mov_b32 v93, v85
    v_mov_b32 v94, v86
    v_mov_b32 v96, v88
    v_mov_b32 v97, v89
    v_permlane32_swap_b32 v84, v92
    v_permlane32_swap_b32 v85, v93
    v_permlane32_swap_b32 v86, v94
    v_permlane32_swap_b32 v88, v96
    v_permlane32_swap_b32 v89, v97
    v_add_f32 v84, v84, v92
    v_add_f32 v85, v85, v93
    v_add_f32 v86, v86, v94
    v_add_f32 v88, v88, v96
    v_add_f32 v89, v89, v97
    v_fmac_f32 v12, v126, v84
    v_fmac_f32 v13, v127, v85
    v_fmac_f32 v14, v128, v86
    v_fmac_f32 v15, v129, v88
    v_fmac_f32 v16, v130, v89
    v_fmac_f32_dpp v12, v84, v131 row_ror:8 row_mask:0xf bank_mask:0xf
    v_fmac_f32_dpp v13, v85, v132 row_ror:8 row_mask:0xf bank_mask:0xf
    v_fmac_f32_dpp v14, v86, v133 row_ror:8 row_mask:0xf bank_mask:0xf
    v_fmac_f32_dpp v15, v88, v134 row_ror:8 row_mask:0xf bank_mask:0xf
    v_fmac_f32_dpp v16, v89, v135 row_ror:8 row_mask:0xf bank_mask:0xf
    v_mul_f32 v154, v246, v12
    v_mul_f32 v170, v248, v13
    v_mul_f32 v186, v250, v14
    v_mul_f32 v202, v252, v15
    v_mul_f32 v218, v254, v16
    v_fmac_f32_dpp v154, v12, v230 row_ror:8 row_mask:0xf bank_mask:0xf
    v_fmac_f32_dpp v170, v13, v231 row_ror:8 row_mask:0xf bank_mask:0xf
    v_fmac_f32_dpp v186, v14, v232 row_ror:8 row_mask:0xf bank_mask:0xf
    v_fmac_f32_dpp v202, v15, v233 row_ror:8 row_mask:0xf bank_mask:0xf
    v_fmac_f32_dpp v218, v16, v234 row_ror:8 row_mask:0xf bank_mask:0xf
    v_mul_u32_u24 v7, 144, v2
    v_lshl_add_u32 v7, v3, 5, v7
    v_add_u32 v7, s72, v7
    v_and_b32 v6, 1, v3
    v_lshrrev_b32 v10, 2, v2
    v_lshl_add_u32 v6, v6, 3, v10
    v_mul_u32_u24 v6, 144, v6
    v_and_b32 v10, 3, v2
    v_lshl_add_u32 v6, v10, 5, v6
    v_lshrrev_b32 v11, 1, v3
    v_lshl_add_u32 v6, v11, 3, v6
    v_add_u32 v6, s72, v6
    v_and_b32 v10, 31, v1
    v_lshlrev_b32 v10, 4, v10
    v_lshl_add_u32 v10, v11, 10, v10
    v_fmac_f32 v20, v220, v154
    v_fmac_f32 v22, v221, v170
    v_fmac_f32 v24, v222, v186
    v_fmac_f32 v26, v223, v202
    v_fmac_f32 v28, v224, v218
    v_fmac_f32_dpp v20, v154, v225 row_ror:8 row_mask:0xf bank_mask:0xf
    v_fmac_f32_dpp v22, v170, v226 row_ror:8 row_mask:0xf bank_mask:0xf
    v_fmac_f32_dpp v24, v186, v227 row_ror:8 row_mask:0xf bank_mask:0xf
    v_fmac_f32_dpp v26, v202, v228 row_ror:8 row_mask:0xf bank_mask:0xf
    v_fmac_f32_dpp v28, v218, v229 row_ror:8 row_mask:0xf bank_mask:0xf
    v_fmac_f32 v21, v220, v20
    v_fmac_f32 v23, v221, v22
    v_fmac_f32 v25, v222, v24
    v_fmac_f32 v27, v223, v26
    v_fmac_f32 v29, v224, v28
    v_fmac_f32_dpp v21, v20, v225 row_ror:8 row_mask:0xf bank_mask:0xf
    v_fmac_f32_dpp v23, v22, v226 row_ror:8 row_mask:0xf bank_mask:0xf
    v_fmac_f32_dpp v25, v24, v227 row_ror:8 row_mask:0xf bank_mask:0xf
    v_fmac_f32_dpp v27, v26, v228 row_ror:8 row_mask:0xf bank_mask:0xf
    v_fmac_f32_dpp v29, v28, v229 row_ror:8 row_mask:0xf bank_mask:0xf
    v_cvt_pk_bf16_f32 v32, v20, v21
    v_cvt_pk_bf16_f32 v40, v22, v23
    v_cvt_pk_bf16_f32 v48, v24, v25
    v_cvt_pk_bf16_f32 v56, v26, v27
    v_cvt_pk_bf16_f32 v64, v28, v29
    s_cmp_lg_u32 s77, 0
    s_cbranch_scc1 L_k1_ffd
    s_lshl_b32 s9, s81, 2
    s_lshr_b32 s10, s7, 1
    s_add_u32 s9, s9, s10
    s_mul_i32 s9, s9, 4224
    s_and_b32 s10, s7, 1
    s_lshl_b32 s10, s10, 1
    s_add_u32 s10, s10, s5
    s_mul_i32 s10, s10, 4
    s_add_u32 s9, s9, s10
    s_add_u32 s9, s9, 0x1160010
    v_mov_b32 v30, s9
    v_mov_b32 v31, s82
    s_waitcnt vmcnt(0)
    s_mov_b64 exec, 1
    buffer_store_dword v31, v30, s[60:63], 0 offen sc1
    s_mov_b64 exec, -1
L_k1_ffd:
    v_fmac_f32 v140, v220, v21
    v_fmac_f32 v156, v221, v23
    v_fmac_f32 v172, v222, v25
    v_fmac_f32 v188, v223, v27
    v_fmac_f32 v204, v224, v29
    v_fmac_f32_dpp v140, v21, v225 row_ror:8 row_mask:0xf bank_mask:0xf
    v_fmac_f32_dpp v156, v23, v226 row_ror:8 row_mask:0xf bank_mask:0xf
    v_fmac_f32_dpp v172, v25, v227 row_ror:8 row_mask:0xf bank_mask:0xf
    v_fmac_f32_dpp v188, v27, v228 row_ror:8 row_mask:0xf bank_mask:0xf
    v_fmac_f32_dpp v204, v29, v229 row_ror:8 row_mask:0xf bank_mask:0xf
    v_fmac_f32 v141, v220, v140
    v_fmac_f32 v157, v221, v156
    v_fmac_f32 v173, v222, v172
    v_fmac_f32 v189, v223, v188
    v_fmac_f32 v205, v224, v204
    v_fmac_f32_dpp v141, v140, v225 row_ror:8 row_mask:0xf bank_mask:0xf
    v_fmac_f32_dpp v157, v156, v226 row_ror:8 row_mask:0xf bank_mask:0xf
    v_fmac_f32_dpp v173, v172, v227 row_ror:8 row_mask:0xf bank_mask:0xf
    v_fmac_f32_dpp v189, v188, v228 row_ror:8 row_mask:0xf bank_mask:0xf
    v_fmac_f32_dpp v205, v204, v229 row_ror:8 row_mask:0xf bank_mask:0xf
    v_cvt_pk_bf16_f32 v33, v140, v141
    v_cvt_pk_bf16_f32 v41, v156, v157
    v_cvt_pk_bf16_f32 v49, v172, v173
    v_cvt_pk_bf16_f32 v57, v188, v189
    v_cvt_pk_bf16_f32 v65, v204, v205
    v_fmac_f32 v142, v220, v141
    v_fmac_f32 v158, v221, v157
    v_fmac_f32 v174, v222, v173
    v_fmac_f32 v190, v223, v189
    v_fmac_f32 v206, v224, v205
    v_fmac_f32_dpp v142, v141, v225 row_ror:8 row_mask:0xf bank_mask:0xf
    v_fmac_f32_dpp v158, v157, v226 row_ror:8 row_mask:0xf bank_mask:0xf
    v_fmac_f32_dpp v174, v173, v227 row_ror:8 row_mask:0xf bank_mask:0xf
    v_fmac_f32_dpp v190, v189, v228 row_ror:8 row_mask:0xf bank_mask:0xf
    v_fmac_f32_dpp v206, v205, v229 row_ror:8 row_mask:0xf bank_mask:0xf
    v_fmac_f32 v143, v220, v142
    v_fmac_f32 v159, v221, v158
    v_fmac_f32 v175, v222, v174
    v_fmac_f32 v191, v223, v190
    v_fmac_f32 v207, v224, v206
    v_fmac_f32_dpp v143, v142, v225 row_ror:8 row_mask:0xf bank_mask:0xf
    v_fmac_f32_dpp v159, v158, v226 row_ror:8 row_mask:0xf bank_mask:0xf
    v_fmac_f32_dpp v175, v174, v227 row_ror:8 row_mask:0xf bank_mask:0xf
    v_fmac_f32_dpp v191, v190, v228 row_ror:8 row_mask:0xf bank_mask:0xf
    v_fmac_f32_dpp v207, v206, v229 row_ror:8 row_mask:0xf bank_mask:0xf
    v_cvt_pk_bf16_f32 v34, v142, v143
    v_cvt_pk_bf16_f32 v42, v158, v159
    v_cvt_pk_bf16_f32 v50, v174, v175
    v_cvt_pk_bf16_f32 v58, v190, v191
    v_cvt_pk_bf16_f32 v66, v206, v207
    v_fmac_f32 v144, v220, v143
    v_fmac_f32 v160, v221, v159
    v_fmac_f32 v176, v222, v175
    v_fmac_f32 v192, v223, v191
    v_fmac_f32 v208, v224, v207
    v_fmac_f32_dpp v144, v143, v225 row_ror:8 row_mask:0xf bank_mask:0xf
    v_fmac_f32_dpp v160, v159, v226 row_ror:8 row_mask:0xf bank_mask:0xf
    v_fmac_f32_dpp v176, v175, v227 row_ror:8 row_mask:0xf bank_mask:0xf
    v_fmac_f32_dpp v192, v191, v228 row_ror:8 row_mask:0xf bank_mask:0xf
    v_fmac_f32_dpp v208, v207, v229 row_ror:8 row_mask:0xf bank_mask:0xf
    v_fmac_f32 v145, v220, v144
    v_fmac_f32 v161, v221, v160
    v_fmac_f32 v177, v222, v176
    v_fmac_f32 v193, v223, v192
    v_fmac_f32 v209, v224, v208
    v_fmac_f32_dpp v145, v144, v225 row_ror:8 row_mask:0xf bank_mask:0xf
    v_fmac_f32_dpp v161, v160, v226 row_ror:8 row_mask:0xf bank_mask:0xf
    v_fmac_f32_dpp v177, v176, v227 row_ror:8 row_mask:0xf bank_mask:0xf
    v_fmac_f32_dpp v193, v192, v228 row_ror:8 row_mask:0xf bank_mask:0xf
    v_fmac_f32_dpp v209, v208, v229 row_ror:8 row_mask:0xf bank_mask:0xf
    v_cvt_pk_bf16_f32 v35, v144, v145
    v_cvt_pk_bf16_f32 v43, v160, v161
    v_cvt_pk_bf16_f32 v51, v176, v177
    v_cvt_pk_bf16_f32 v59, v192, v193
    v_cvt_pk_bf16_f32 v67, v208, v209
    v_fmac_f32 v146, v220, v145
    v_fmac_f32 v162, v221, v161
    v_fmac_f32 v178, v222, v177
    v_fmac_f32 v194, v223, v193
    v_fmac_f32 v210, v224, v209
    v_fmac_f32_dpp v146, v145, v225 row_ror:8 row_mask:0xf bank_mask:0xf
    v_fmac_f32_dpp v162, v161, v226 row_ror:8 row_mask:0xf bank_mask:0xf
    v_fmac_f32_dpp v178, v177, v227 row_ror:8 row_mask:0xf bank_mask:0xf
    v_fmac_f32_dpp v194, v193, v228 row_ror:8 row_mask:0xf bank_mask:0xf
    v_fmac_f32_dpp v210, v209, v229 row_ror:8 row_mask:0xf bank_mask:0xf
    ds_write_b128 v7, v[32:35] offset:0
    ds_write_b128 v7, v[40:43] offset:2304
    ds_write_b128 v7, v[48:51] offset:4608
    ds_write_b128 v7, v[56:59] offset:6912
    ds_write_b128 v7, v[64:67] offset:9216
    v_fmac_f32 v147, v220, v146
    v_fmac_f32 v163, v221, v162
    v_fmac_f32 v179, v222, v178
    v_fmac_f32 v195, v223, v194
    v_fmac_f32 v211, v224, v210
    v_fmac_f32_dpp v147, v146, v225 row_ror:8 row_mask:0xf bank_mask:0xf
    v_fmac_f32_dpp v163, v162, v226 row_ror:8 row_mask:0xf bank_mask:0xf
    v_fmac_f32_dpp v179, v178, v227 row_ror:8 row_mask:0xf bank_mask:0xf
    v_fmac_f32_dpp v195, v194, v228 row_ror:8 row_mask:0xf bank_mask:0xf
    v_fmac_f32_dpp v211, v210, v229 row_ror:8 row_mask:0xf bank_mask:0xf
    v_cvt_pk_bf16_f32 v36, v146, v147
    v_cvt_pk_bf16_f32 v44, v162, v163
    v_cvt_pk_bf16_f32 v52, v178, v179
    v_cvt_pk_bf16_f32 v60, v194, v195
    v_cvt_pk_bf16_f32 v68, v210, v211
    v_fmac_f32 v148, v220, v147
    v_fmac_f32 v164, v221, v163
    v_fmac_f32 v180, v222, v179
    v_fmac_f32 v196, v223, v195
    v_fmac_f32 v212, v224, v211
    v_fmac_f32_dpp v148, v147, v225 row_ror:8 row_mask:0xf bank_mask:0xf
    v_fmac_f32_dpp v164, v163, v226 row_ror:8 row_mask:0xf bank_mask:0xf
    v_fmac_f32_dpp v180, v179, v227 row_ror:8 row_mask:0xf bank_mask:0xf
    v_fmac_f32_dpp v196, v195, v228 row_ror:8 row_mask:0xf bank_mask:0xf
    v_fmac_f32_dpp v212, v211, v229 row_ror:8 row_mask:0xf bank_mask:0xf
    ds_read_b64_tr_b16 v[76:77], v6 offset:0
    ds_read_b64_tr_b16 v[78:79], v6 offset:576
    ds_read_b64_tr_b16 v[80:81], v6 offset:2304
    ds_read_b64_tr_b16 v[82:83], v6 offset:2880
    ds_read_b64_tr_b16 v[84:85], v6 offset:4608
    ds_read_b64_tr_b16 v[86:87], v6 offset:5184
    ds_read_b64_tr_b16 v[88:89], v6 offset:6912
    ds_read_b64_tr_b16 v[90:91], v6 offset:7488
    ds_read_b64_tr_b16 v[92:93], v6 offset:9216
    ds_read_b64_tr_b16 v[94:95], v6 offset:9792
    v_fmac_f32 v149, v220, v148
    v_fmac_f32 v165, v221, v164
    v_fmac_f32 v181, v222, v180
    v_fmac_f32 v197, v223, v196
    v_fmac_f32 v213, v224, v212
    v_fmac_f32_dpp v149, v148, v225 row_ror:8 row_mask:0xf bank_mask:0xf
    v_fmac_f32_dpp v165, v164, v226 row_ror:8 row_mask:0xf bank_mask:0xf
    v_fmac_f32_dpp v181, v180, v227 row_ror:8 row_mask:0xf bank_mask:0xf
    v_fmac_f32_dpp v197, v196, v228 row_ror:8 row_mask:0xf bank_mask:0xf
    v_fmac_f32_dpp v213, v212, v229 row_ror:8 row_mask:0xf bank_mask:0xf
    v_cvt_pk_bf16_f32 v37, v148, v149
    v_cvt_pk_bf16_f32 v45, v164, v165
    v_cvt_pk_bf16_f32 v53, v180, v181
    v_cvt_pk_bf16_f32 v61, v196, v197
    v_cvt_pk_bf16_f32 v69, v212, v213
    v_fmac_f32 v150, v220, v149
    v_fmac_f32 v166, v221, v165
    v_fmac_f32 v182, v222, v181
    v_fmac_f32 v198, v223, v197
    v_fmac_f32 v214, v224, v213
    v_fmac_f32_dpp v150, v149, v225 row_ror:8 row_mask:0xf bank_mask:0xf
    v_fmac_f32_dpp v166, v165, v226 row_ror:8 row_mask:0xf bank_mask:0xf
    v_fmac_f32_dpp v182, v181, v227 row_ror:8 row_mask:0xf bank_mask:0xf
    v_fmac_f32_dpp v198, v197, v228 row_ror:8 row_mask:0xf bank_mask:0xf
    v_fmac_f32_dpp v214, v213, v229 row_ror:8 row_mask:0xf bank_mask:0xf
    v_fmac_f32 v151, v220, v150
    v_fmac_f32 v167, v221, v166
    v_fmac_f32 v183, v222, v182
    v_fmac_f32 v199, v223, v198
    v_fmac_f32 v215, v224, v214
    v_fmac_f32_dpp v151, v150, v225 row_ror:8 row_mask:0xf bank_mask:0xf
    v_fmac_f32_dpp v167, v166, v226 row_ror:8 row_mask:0xf bank_mask:0xf
    v_fmac_f32_dpp v183, v182, v227 row_ror:8 row_mask:0xf bank_mask:0xf
    v_fmac_f32_dpp v199, v198, v228 row_ror:8 row_mask:0xf bank_mask:0xf
    v_fmac_f32_dpp v215, v214, v229 row_ror:8 row_mask:0xf bank_mask:0xf
    v_cvt_pk_bf16_f32 v38, v150, v151
    v_cvt_pk_bf16_f32 v46, v166, v167
    v_cvt_pk_bf16_f32 v54, v182, v183
    v_cvt_pk_bf16_f32 v62, v198, v199
    v_cvt_pk_bf16_f32 v70, v214, v215
    s_waitcnt lgkmcnt(0)
    buffer_store_dwordx4 v[76:79], v10, s[60:63], s68 offen offset:0 sc1
    buffer_store_dwordx4 v[80:83], v10, s[60:63], s69 offen offset:0 sc1
    buffer_store_dwordx4 v[84:87], v10, s[60:63], s70 offen offset:0 sc1
    buffer_store_dwordx4 v[88:91], v10, s[60:63], s71 offen offset:0 sc1
    buffer_store_dwordx4 v[92:95], v10, s[60:63], s79 offen offset:0 sc1
    v_fmac_f32 v152, v220, v151
    v_fmac_f32 v168, v221, v167
    v_fmac_f32 v184, v222, v183
    v_fmac_f32 v200, v223, v199
    v_fmac_f32 v216, v224, v215
    v_fmac_f32_dpp v152, v151, v225 row_ror:8 row_mask:0xf bank_mask:0xf
    v_fmac_f32_dpp v168, v167, v226 row_ror:8 row_mask:0xf bank_mask:0xf
    v_fmac_f32_dpp v184, v183, v227 row_ror:8 row_mask:0xf bank_mask:0xf
    v_fmac_f32_dpp v200, v199, v228 row_ror:8 row_mask:0xf bank_mask:0xf
    v_fmac_f32_dpp v216, v215, v229 row_ror:8 row_mask:0xf bank_mask:0xf
    v_fmac_f32 v153, v220, v152
    v_fmac_f32 v169, v221, v168
    v_fmac_f32 v185, v222, v184
    v_fmac_f32 v201, v223, v200
    v_fmac_f32 v217, v224, v216
    v_fmac_f32_dpp v153, v152, v225 row_ror:8 row_mask:0xf bank_mask:0xf
    v_fmac_f32_dpp v169, v168, v226 row_ror:8 row_mask:0xf bank_mask:0xf
    v_fmac_f32_dpp v185, v184, v227 row_ror:8 row_mask:0xf bank_mask:0xf
    v_fmac_f32_dpp v201, v200, v228 row_ror:8 row_mask:0xf bank_mask:0xf
    v_fmac_f32_dpp v217, v216, v229 row_ror:8 row_mask:0xf bank_mask:0xf
    v_cvt_pk_bf16_f32 v39, v152, v153
    v_cvt_pk_bf16_f32 v47, v168, v169
    v_cvt_pk_bf16_f32 v55, v184, v185
    v_cvt_pk_bf16_f32 v63, v200, v201
    v_cvt_pk_bf16_f32 v71, v216, v217
    ds_write_b128 v7, v[36:39] offset:16
    ds_write_b128 v7, v[44:47] offset:2320
    ds_write_b128 v7, v[52:55] offset:4624
    ds_write_b128 v7, v[60:63] offset:6928
    ds_write_b128 v7, v[68:71] offset:9232
    ds_read_b64_tr_b16 v[96:97], v6 offset:16
    ds_read_b64_tr_b16 v[98:99], v6 offset:592
    ds_read_b64_tr_b16 v[100:101], v6 offset:2320
    ds_read_b64_tr_b16 v[102:103], v6 offset:2896
    ds_read_b64_tr_b16 v[104:105], v6 offset:4624
    ds_read_b64_tr_b16 v[106:107], v6 offset:5200
    ds_read_b64_tr_b16 v[108:109], v6 offset:6928
    ds_read_b64_tr_b16 v[110:111], v6 offset:7504
    ds_read_b64_tr_b16 v[112:113], v6 offset:9232
    ds_read_b64_tr_b16 v[114:115], v6 offset:9808
    s_waitcnt lgkmcnt(8)
    buffer_store_dwordx4 v[96:99], v10, s[60:63], s68 offen offset:2048 sc1
    s_waitcnt lgkmcnt(6)
    buffer_store_dwordx4 v[100:103], v10, s[60:63], s69 offen offset:2048 sc1
    s_waitcnt lgkmcnt(4)
    buffer_store_dwordx4 v[104:107], v10, s[60:63], s70 offen offset:2048 sc1
    s_waitcnt lgkmcnt(2)
    buffer_store_dwordx4 v[108:111], v10, s[60:63], s71 offen offset:2048 sc1
    s_waitcnt lgkmcnt(0)
    buffer_store_dwordx4 v[112:115], v10, s[60:63], s79 offen offset:2048 sc1
    s_lshl_b32 s9, s81, 2
    s_lshr_b32 s10, s7, 1
    s_add_u32 s9, s9, s10
    s_mul_i32 s9, s9, 4224
    s_and_b32 s10, s7, 1
    s_lshl_b32 s10, s10, 1
    s_add_u32 s10, s10, s5
    s_mul_i32 s10, s10, 4
    s_add_u32 s9, s9, s10
    s_add_u32 s9, s9, 0x1160020
    v_mov_b32 v6, s9
    v_mov_b32 v7, s82
    s_waitcnt vmcnt(0)
    s_mov_b64 exec, 1
    buffer_store_dword v7, v6, s[60:63], 0 offen sc1
    s_mov_b64 exec, -1
L_k1_base:
    s_and_b32 s9, s2, 7
    s_lshr_b32 s10, s2, 3
    s_lshr_b32 s12, s9, 1
    s_lshl_b32 s12, s12, 3
    s_and_b32 s11, s10, 7
    s_add_u32 s12, s12, s11
    s_and_b32 s9, s9, 1
    s_lshl_b32 s9, s9, 2
    s_lshr_b32 s11, s10, 3
    s_add_u32 s9, s9, s11
    s_mul_i32 s9, s9, 160
    s_lshl_b32 s12, s12, 6
    s_lshl_b32 s10, s3, 2
    s_add_u32 s12, s12, s10
    v_add_u32 v185, 0, v1
    v_add_u32 v186, 64, v1
    v_add_u32 v187, 128, v1
    v_add_u32 v188, 192, v1
    v_add_u32 v189, 256, v1
    v_mul_u32_u24 v170, 205, v185
    v_mul_u32_u24 v171, 205, v186
    v_mul_u32_u24 v172, 205, v187
    v_mul_u32_u24 v173, 205, v188
    v_mul_u32_u24 v174, 205, v189
    v_lshrrev_b32 v170, 12, v170
    v_lshrrev_b32 v171, 12, v171
    v_lshrrev_b32 v172, 12, v172
    v_lshrrev_b32 v173, 12, v173
    v_lshrrev_b32 v174, 12, v174
    v_mul_u32_u24 v175, 20, v170
    v_bfe_u32 v180, v170, 1, 2
    v_mul_u32_u24 v176, 20, v171
    v_bfe_u32 v181, v171, 1, 2
    v_mul_u32_u24 v177, 20, v172
    v_bfe_u32 v182, v172, 1, 2
    v_mul_u32_u24 v178, 20, v173
    v_bfe_u32 v183, v173, 1, 2
    v_mul_u32_u24 v179, 20, v174
    v_bfe_u32 v184, v174, 1, 2
    v_sub_u32 v175, v185, v175
    v_sub_u32 v176, v186, v176
    v_sub_u32 v177, v187, v177
    v_sub_u32 v178, v188, v178
    v_sub_u32 v179, v189, v179
    v_xor_b32 v175, v175, v180
    v_lshrrev_b32 v180, 2, v170
    v_xor_b32 v176, v176, v181
    v_lshrrev_b32 v181, 2, v171
    v_xor_b32 v177, v177, v182
    v_lshrrev_b32 v182, 2, v172
    v_xor_b32 v178, v178, v183
    v_lshrrev_b32 v183, 2, v173
    v_xor_b32 v179, v179, v184
    v_lshrrev_b32 v184, 2, v174
    v_mad_u32_u24 v170, v180, 12, v170
    v_lshl_add_u32 v175, v175, 3, s9
    v_mad_u32_u24 v171, v181, 12, v171
    v_lshl_add_u32 v176, v176, 3, s9
    v_mad_u32_u24 v172, v182, 12, v172
    v_lshl_add_u32 v177, v177, 3, s9
    v_mad_u32_u24 v173, v183, 12, v173
    v_lshl_add_u32 v178, v178, 3, s9
    v_mad_u32_u24 v174, v184, 12, v174
    v_lshl_add_u32 v179, v179, 3, s9
    v_add_u32 v170, s12, v170
    v_add_u32 v171, s12, v171
    v_add_u32 v172, s12, v172
    v_add_u32 v173, s12, v173
    v_add_u32 v174, s12, v174
    v_mul_u32_u24 v180, 1280, v170
    v_lshlrev_b32 v170, 3, v170
    v_mul_u32_u24 v181, 1280, v171
    v_lshlrev_b32 v171, 3, v171
    v_mul_u32_u24 v182, 1280, v172
    v_lshlrev_b32 v172, 3, v172
    v_mul_u32_u24 v183, 1280, v173
    v_lshlrev_b32 v173, 3, v173
    v_mul_u32_u24 v184, 1280, v174
    v_lshlrev_b32 v174, 3, v174
    v_add_u32 v180, v180, v175
    v_add_u32 v181, v181, v176
    v_add_u32 v182, v182, v177
    v_add_u32 v183, v183, v178
    v_add_u32 v184, v184, v179
    s_mov_b32 s72, 0x1100000
    global_load_dwordx2 v[140:141], v180, s[48:49]
    global_load_dwordx2 v[150:151], v175, s[50:51]
    global_load_dwordx2 v[142:143], v181, s[48:49]
    global_load_dwordx2 v[152:153], v176, s[50:51]
    global_load_dwordx2 v[144:145], v182, s[48:49]
    global_load_dwordx2 v[154:155], v177, s[50:51]
    global_load_dwordx2 v[146:147], v183, s[48:49]
    global_load_dwordx2 v[156:157], v178, s[50:51]
    global_load_dwordx2 v[148:149], v184, s[48:49]
    global_load_dwordx2 v[158:159], v179, s[50:51]
    s_mov_b32 s12, 0
L_k1_bt:
    buffer_load_dwordx2 v[160:161], v170, s[60:63], s72 offen sc1
    buffer_load_dwordx2 v[162:163], v171, s[60:63], s72 offen sc1
    buffer_load_dwordx2 v[164:165], v172, s[60:63], s72 offen sc1
    buffer_load_dwordx2 v[166:167], v173, s[60:63], s72 offen sc1
    buffer_load_dwordx2 v[168:169], v174, s[60:63], s72 offen sc1
L_k1_base2:
    s_setprio 0
    s_waitcnt vmcnt(0)
    v_xor_b32 v232, s82, v161
    v_xor_b32 v233, s82, v163
    v_or_b32 v232, v232, v233
    v_xor_b32 v233, s82, v165
    v_or_b32 v232, v232, v233
    v_xor_b32 v233, s82, v167
    v_or_b32 v232, v232, v233
    v_xor_b32 v233, s82, v169
    v_or_b32 v232, v232, v233
    v_cmp_ne_u32 vcc, 0, v232
    s_add_u32 s12, s12, 1
    s_cbranch_vccz L_k1_bto
    s_sleep 8
    s_cmp_lt_u32 s12, 0x40000
    s_cbranch_scc1 L_k1_bt
L_k1_bto:
    s_mul_i32 s9, s3, 11520
    s_add_u32 s9, s9, 53248
    v_lshl_add_u32 v190, v1, 4, s9
    v_mov_b32 v191, 162304
L_k1_bw140:
    ds_read2st64_b32 v[184:185], v191 offset0:0 offset1:1
    ds_read2st64_b32 v[186:187], v191 offset0:2 offset1:3
    s_waitcnt lgkmcnt(0)
    v_min_u32 v184, v184, v185
    v_min3_u32 v184, v184, v186, v187
    s_nop 0
    v_readfirstlane_b32 s9, v184
    s_nop 0
    s_cmp_ge_i32 s9, 16
    s_cbranch_scc1 L_k1_bw140_ok
    s_sleep 1
    s_branch L_k1_bw140
L_k1_bw140_ok:
    v_and_b32 v161, s13, v160
    v_lshlrev_b32 v160, 16, v160
    v_and_b32 v163, s13, v162
    v_lshlrev_b32 v162, 16, v162
    v_and_b32 v165, s13, v164
    v_lshlrev_b32 v164, 16, v164
    v_and_b32 v167, s13, v166
    v_lshlrev_b32 v166, 16, v166
    v_and_b32 v169, s13, v168
    v_lshlrev_b32 v168, 16, v168
    v_rcp_f32 v161, v161
    v_rcp_f32 v163, v163
    v_rcp_f32 v165, v165
    v_rcp_f32 v167, v167
    v_rcp_f32 v169, v169
    v_lshlrev_b32 v192, 16, v140
    v_and_b32 v193, s13, v140
    v_lshlrev_b32 v212, 16, v150
    v_and_b32 v213, s13, v150
    v_lshlrev_b32 v194, 16, v141
    v_and_b32 v195, s13, v141
    v_lshlrev_b32 v214, 16, v151
    v_and_b32 v215, s13, v151
    v_lshlrev_b32 v196, 16, v142
    v_and_b32 v197, s13, v142
    v_lshlrev_b32 v216, 16, v152
    v_and_b32 v217, s13, v152
    v_lshlrev_b32 v198, 16, v143
    v_and_b32 v199, s13, v143
    v_lshlrev_b32 v218, 16, v153
    v_and_b32 v219, s13, v153
    v_lshlrev_b32 v200, 16, v144
    v_and_b32 v201, s13, v144
    v_lshlrev_b32 v220, 16, v154
    v_and_b32 v221, s13, v154
    v_lshlrev_b32 v202, 16, v145
    v_and_b32 v203, s13, v145
    v_lshlrev_b32 v222, 16, v155
    v_and_b32 v223, s13, v155
    v_lshlrev_b32 v204, 16, v146
    v_and_b32 v205, s13, v146
    v_lshlrev_b32 v224, 16, v156
    v_and_b32 v225, s13, v156
    v_lshlrev_b32 v206, 16, v147
    v_and_b32 v207, s13, v147
    v_lshlrev_b32 v226, 16, v157
    v_and_b32 v227, s13, v157
    v_lshlrev_b32 v208, 16, v148
    v_and_b32 v209, s13, v148
    v_lshlrev_b32 v228, 16, v158
    v_and_b32 v229, s13, v158
    v_lshlrev_b32 v210, 16, v149
    v_and_b32 v211, s13, v149
    v_lshlrev_b32 v230, 16, v159
    v_and_b32 v231, s13, v159
    v_sub_f32 v232, v192, v160
    v_sub_f32 v233, v193, v160
    v_sub_f32 v234, v194, v160
    v_sub_f32 v235, v195, v160
    v_sub_f32 v236, v196, v162
    v_sub_f32 v237, v197, v162
    v_sub_f32 v238, v198, v162
    v_sub_f32 v239, v199, v162
    v_sub_f32 v240, v200, v164
    v_sub_f32 v241, v201, v164
    v_sub_f32 v242, v202, v164
    v_sub_f32 v243, v203, v164
    v_sub_f32 v244, v204, v166
    v_sub_f32 v245, v205, v166
    v_sub_f32 v246, v206, v166
    v_sub_f32 v247, v207, v166
    v_sub_f32 v248, v208, v168
    v_sub_f32 v249, v209, v168
    v_sub_f32 v250, v210, v168
    v_sub_f32 v251, v211, v168
    v_cvt_pk_bf16_f32 v170, v232, v233
    v_cvt_pk_bf16_f32 v171, v234, v235
    v_cvt_pk_bf16_f32 v172, v236, v237
    v_cvt_pk_bf16_f32 v173, v238, v239
    v_cvt_pk_bf16_f32 v174, v240, v241
    v_cvt_pk_bf16_f32 v175, v242, v243
    v_cvt_pk_bf16_f32 v176, v244, v245
    v_cvt_pk_bf16_f32 v177, v246, v247
    v_cvt_pk_bf16_f32 v178, v248, v249
    v_cvt_pk_bf16_f32 v179, v250, v251
    v_lshlrev_b32 v232, 16, v170
    v_and_b32 v233, s13, v170
    v_lshlrev_b32 v234, 16, v171
    v_and_b32 v235, s13, v171
    v_lshlrev_b32 v236, 16, v172
    v_and_b32 v237, s13, v172
    v_lshlrev_b32 v238, 16, v173
    v_and_b32 v239, s13, v173
    v_lshlrev_b32 v240, 16, v174
    v_and_b32 v241, s13, v174
    v_lshlrev_b32 v242, 16, v175
    v_and_b32 v243, s13, v175
    v_lshlrev_b32 v244, 16, v176
    v_and_b32 v245, s13, v176
    v_lshlrev_b32 v246, 16, v177
    v_and_b32 v247, s13, v177
    v_lshlrev_b32 v248, 16, v178
    v_and_b32 v249, s13, v178
    v_lshlrev_b32 v250, 16, v179
    v_and_b32 v251, s13, v179
    v_mul_f32 v232, v232, v161
    v_mul_f32 v233, v233, v161
    v_mul_f32 v234, v234, v161
    v_mul_f32 v235, v235, v161
    v_mul_f32 v236, v236, v163
    v_mul_f32 v237, v237, v163
    v_mul_f32 v238, v238, v163
    v_mul_f32 v239, v239, v163
    v_mul_f32 v240, v240, v165
    v_mul_f32 v241, v241, v165
    v_mul_f32 v242, v242, v165
    v_mul_f32 v243, v243, v165
    v_mul_f32 v244, v244, v167
    v_mul_f32 v245, v245, v167
    v_mul_f32 v246, v246, v167
    v_mul_f32 v247, v247, v167
    v_mul_f32 v248, v248, v169
    v_mul_f32 v249, v249, v169
    v_mul_f32 v250, v250, v169
    v_mul_f32 v251, v251, v169
    v_cvt_pk_bf16_f32 v170, v232, v233
    v_cvt_pk_bf16_f32 v171, v234, v235
    v_cvt_pk_bf16_f32 v172, v236, v237
    v_cvt_pk_bf16_f32 v173, v238, v239
    v_cvt_pk_bf16_f32 v174, v240, v241
    v_cvt_pk_bf16_f32 v175, v242, v243
    v_cvt_pk_bf16_f32 v176, v244, v245
    v_cvt_pk_bf16_f32 v177, v246, v247
    v_cvt_pk_bf16_f32 v178, v248, v249
    v_cvt_pk_bf16_f32 v179, v250, v251
    v_lshlrev_b32 v232, 16, v170
    v_and_b32 v233, s13, v170
    v_lshlrev_b32 v234, 16, v171
    v_and_b32 v235, s13, v171
    v_lshlrev_b32 v236, 16, v172
    v_and_b32 v237, s13, v172
    v_lshlrev_b32 v238, 16, v173
    v_and_b32 v239, s13, v173
    v_lshlrev_b32 v240, 16, v174
    v_and_b32 v241, s13, v174
    v_lshlrev_b32 v242, 16, v175
    v_and_b32 v243, s13, v175
    v_lshlrev_b32 v244, 16, v176
    v_and_b32 v245, s13, v176
    v_lshlrev_b32 v246, 16, v177
    v_and_b32 v247, s13, v177
    v_lshlrev_b32 v248, 16, v178
    v_and_b32 v249, s13, v178
    v_lshlrev_b32 v250, 16, v179
    v_and_b32 v251, s13, v179
    v_mul_f32 v232, v232, v212
    v_mul_f32 v233, v233, v213
    v_mul_f32 v234, v234, v214
    v_mul_f32 v235, v235, v215
    v_mul_f32 v236, v236, v216
    v_mul_f32 v237, v237, v217
    v_mul_f32 v238, v238, v218
    v_mul_f32 v239, v239, v219
    v_mul_f32 v240, v240, v220
    v_mul_f32 v241, v241, v221
    v_mul_f32 v242, v242, v222
    v_mul_f32 v243, v243, v223
    v_mul_f32 v244, v244, v224
    v_mul_f32 v245, v245, v225
    v_mul_f32 v246, v246, v226
    v_mul_f32 v247, v247, v227
    v_mul_f32 v248, v248, v228
    v_mul_f32 v249, v249, v229
    v_mul_f32 v250, v250, v230
    v_mul_f32 v251, v251, v231
    v_cvt_pk_bf16_f32 v170, v232, v233
    v_cvt_pk_bf16_f32 v171, v234, v235
    v_cvt_pk_bf16_f32 v172, v236, v237
    v_cvt_pk_bf16_f32 v173, v238, v239
    v_cvt_pk_bf16_f32 v174, v240, v241
    v_cvt_pk_bf16_f32 v175, v242, v243
    v_cvt_pk_bf16_f32 v176, v244, v245
    v_cvt_pk_bf16_f32 v177, v246, v247
    v_cvt_pk_bf16_f32 v178, v248, v249
    v_cvt_pk_bf16_f32 v179, v250, v251
    v_lshlrev_b32 v232, 16, v170
    v_and_b32 v233, s13, v170
    v_lshlrev_b32 v234, 16, v171
    v_and_b32 v235, s13, v171
    v_lshlrev_b32 v236, 16, v172
    v_and_b32 v237, s13, v172
    v_lshlrev_b32 v238, 16, v173
    v_and_b32 v239, s13, v173
    v_lshlrev_b32 v240, 16, v174
    v_and_b32 v241, s13, v174
    v_lshlrev_b32 v242, 16, v175
    v_and_b32 v243, s13, v175
    v_lshlrev_b32 v244, 16, v176
    v_and_b32 v245, s13, v176
    v_lshlrev_b32 v246, 16, v177
    v_and_b32 v247, s13, v177
    v_lshlrev_b32 v248, 16, v178
    v_and_b32 v249, s13, v178
    v_lshlrev_b32 v250, 16, v179
    v_and_b32 v251, s13, v179
    v_add_f32 v232, v232, v192
    v_add_f32 v233, v233, v193
    v_add_f32 v234, v234, v194
    v_add_f32 v235, v235, v195
    v_add_f32 v236, v236, v196
    v_add_f32 v237, v237, v197
    v_add_f32 v238, v238, v198
    v_add_f32 v239, v239, v199
    v_add_f32 v240, v240, v200
    v_add_f32 v241, v241, v201
    v_add_f32 v242, v242, v202
    v_add_f32 v243, v243, v203
    v_add_f32 v244, v244, v204
    v_add_f32 v245, v245, v205
    v_add_f32 v246, v246, v206
    v_add_f32 v247, v247, v207
    v_add_f32 v248, v248, v208
    v_add_f32 v249, v249, v209
    v_add_f32 v250, v250, v210
    v_add_f32 v251, v251, v211
    ds_write_b128 v190, v[232:235] offset:0
    ds_write_b128 v190, v[236:239] offset:1024
    ds_write_b128 v190, v[240:243] offset:2048
    ds_write_b128 v190, v[244:247] offset:3072
    ds_write_b128 v190, v[248:251] offset:4096
    s_waitcnt lgkmcnt(0)
    s_endpgm
L_k1_end:
    s_endpgm
    .p2align 7
    .type L_k1_tab,@object
L_k1_tab:
    .long 0, 1, 2, 3, 4, 5, 6, 7, 8, 9, 10, 11, 12, 13, 14, 15, 16, 17, 18, 19, 20, 21, 22, 23, 24, 25, 26, 27, 28, 29, 30, 31
    .size L_k1_tab, 128
.section .rodata,"a"
.p2align 6
.amdhsa_kernel parallel_sum__ssm_conv_s5__geglu_ffn__prompt_kernel
  .amdhsa_next_free_vgpr 256
  .amdhsa_next_free_sgpr 102
  .amdhsa_accum_offset 256
  .amdhsa_group_segment_fixed_size 0
  .amdhsa_kernarg_size 128
  .amdhsa_user_sgpr_count 2
  .amdhsa_user_sgpr_kernarg_segment_ptr 1
  .amdhsa_system_sgpr_workgroup_id_x 1
.end_amdhsa_kernel
```
